```python
import torch

def _softmax(x, axis=-1):
    return torch.softmax(x, dim=axis)
def _gelu(x):
    return torch.nn.functional.gelu(x, approximate="tanh")
def _silu(x):
    return torch.nn.functional.silu(x)
def _sigmoid(x):
    return torch.sigmoid(x)
def _layernorm(x, axis=-1, eps=1e-5):
    m = x.mean(dim=axis, keepdim=True)
    v = x.var(dim=axis, keepdim=True, unbiased=False)
    return (x - m) / torch.sqrt(v + eps)
def _scatter_add(tgt, idx, src, axis=0):
    return tgt.clone().index_add_(axis, idx, src)
def _segment_sum(src, seg, n):
    out = torch.zeros((n,) + src.shape[1:], dtype=src.dtype)
    return out.index_add_(0, seg, src)
def _pad(x, pw):
    flat = tuple(v for pair in reversed(pw) for v in pair)
    return torch.nn.functional.pad(x, flat)

kernel_name = 'gated_mix__grouped_kv_mqa__dense_activation_mish__prompt'

def setup_inputs():

    _w = (lambda a: (lambda t: t.to(torch.bfloat16) if t.is_floating_point() else t)(torch.as_tensor(a)))
    def _A_setup():
        B, S, D, H = 1, 2048, 512, 32
        Dh = D // H
        return {
            "x": _w((lambda *s: torch.randn(*s, dtype=torch.bfloat16) * 0.05)(B, S, D)),
            "wq": _w((lambda *s: torch.randn(*s, dtype=torch.bfloat16) * 0.8)(D, H * Dh)),
            "wk": _w((lambda *s: torch.randn(*s, dtype=torch.bfloat16) * 0.8)(D, Dh)),
            "wv": _w((lambda *s: torch.randn(*s, dtype=torch.bfloat16) * 0.05)(D, Dh)),
            "wo": _w((lambda *s: torch.randn(*s, dtype=torch.bfloat16) * 0.05)(H * Dh, D)),
        }
    _A_in = _A_setup()

    def _B_setup():
        B, S, D, F = 1, 2048, 512, 1792
        return {
            "x": _w((lambda *s: torch.randn(*s, dtype=torch.bfloat16) * 0.05)(B, S, D)),
            "w1": _w((lambda *s: torch.randn(*s, dtype=torch.bfloat16) * 3.2)(D, F) * (D ** -0.5)),
            "b1": _w((lambda *s: torch.randn(*s, dtype=torch.bfloat16) * 0.05)(F)),
            "w2": _w((lambda *s: torch.randn(*s, dtype=torch.bfloat16) * 0.05)(F, D) * (F ** -0.5)),
        }
    _B_in = _B_setup()

    return {
        "A_x": _A_in["x"],
        "A_wq": _A_in["wq"],
        "A_wk": _A_in["wk"],
        "A_wv": _A_in["wv"],
        "A_wo": _A_in["wo"],
        "B_x": _B_in["x"],
        "B_w1": _B_in["w1"],
        "B_b1": _B_in["b1"],
        "B_w2": _B_in["w2"],
        "gate_w": _w((lambda *s: torch.randn(*s, dtype=torch.bfloat16) * 0.05)(512) * 16.0),
    }

def reference(A_x, A_wq, A_wk, A_wv, A_wo, B_x, B_w1, B_b1, B_w2, gate_w):
    def _A_ref(x, wq, wk, wv, wo):
        B, S, D = x.shape
        H = 32
        Dh = D // H
        q = (lambda x, *d: x.permute(*d))((x @ wq).reshape(B, S, H, Dh), 0, 2, 1, 3)
        k = x @ wk
        v = x @ wv
        scores = torch.einsum("bhqd,bkd->bhqk", q, k) * (Dh ** -0.5)
        p = _softmax(scores, axis=-1)
        o = torch.einsum("bhqk,bkd->bhqd", p, v)
        return (lambda x, *d: x.permute(*d))(o, 0, 2, 1, 3).reshape(B, S, H * Dh) @ wo

    def _B_ref(x, w1, b1, w2):
        h = torch.einsum("bsd,df->bsf", x, w1) + b1
        sp = torch.log1p(torch.exp(-torch.abs(h))) + torch.where(h > 0, h, torch.zeros_like(h))
        act = h * torch.tanh(sp)
        return torch.einsum("bsf,fd->bsd", act, w2)

    x = A_x
    g = _sigmoid((x * gate_w).sum(-1, keepdims=True))
    a = _A_ref(x, A_wq, A_wk, A_wv, A_wo)
    b = _B_ref(x, B_w1, B_b1, B_w2)
    return g * a + (1 - g) * b
```

```asm
; @launch kernel=gm_k1_kernel grid=(256,1,1) block=(256,1,1) lds=163840
; @launch kernel=gm_k2_kernel grid=(256,1,1) block=(512,1,1) lds=163840
; @launch kernel=gm_k3_kernel grid=(256,1,1) block=(256,1,1) lds=139264
.amdgcn_target "amdgcn-amd-amdhsa--gfx950"
.text
.globl gm_k1_kernel
.p2align 8
.type gm_k1_kernel,@function
gm_k1_kernel:
    s_cmp_ge_u32 s2, 256
    s_cbranch_scc1 K1_END
    s_load_dwordx2 s[8:9], s[0:1], 0
    s_mov_b32 s10, 2097152
    s_mov_b32 s11, 0x00020000
    s_load_dwordx2 s[12:13], s[0:1], 48
    s_mov_b32 s14, 1835008
    s_mov_b32 s15, 0x00020000
    s_load_dwordx2 s[16:17], s[0:1], 8
    s_mov_b32 s18, 524288
    s_mov_b32 s19, 0x00020000
    s_load_dwordx2 s[20:21], s[0:1], 96
    s_mov_b32 s22, 16777216
    s_mov_b32 s23, 0x00020000
    s_load_dwordx2 s[24:25], s[0:1], 56
    s_mov_b32 s26, 3584
    s_mov_b32 s27, 0x00020000
    s_load_dwordx2 s[32:33], s[0:1], 64
    s_mov_b32 s34, 1835008
    s_mov_b32 s35, 0x00020000
    s_load_dwordx2 s[36:37], s[0:1], 32
    s_mov_b32 s38, 524288
    s_mov_b32 s39, 0x00020000
    s_load_dwordx2 s[76:77], s[0:1], 16
    s_load_dwordx2 s[78:79], s[0:1], 24
    s_load_dwordx2 s[80:81], s[0:1], 72
    v_lshrrev_b32 v15, 6, v0
    v_and_b32 v0, 63, v0
    v_readfirstlane_b32 s44, v15
    s_and_b32 s48, s2, 3
    s_lshl_b32 s48, s48, 2
    s_lshr_b32 s49, s2, 3
    s_and_b32 s45, s49, 3
    s_add_u32 s45, s45, s48
    s_mov_b32 s74, s45
    s_lshr_b32 s49, s49, 2
    s_and_b32 s47, s2, 4
    s_lshl_b32 s47, s47, 1
    s_add_u32 s47, s47, s49
    s_lshl_b32 s45, s45, 2
    s_add_u32 s45, s45, s44
    s_add_u32 s46, s44, 1
    s_lshl_b32 s46, s46, 15
    s_lshl_b32 s50, s45, 15
    s_add_u32 s51, s50, 8192
    s_add_u32 s52, s50, 16384
    s_add_u32 s53, s50, 24576
    s_mul_i32 s71, s44, 458752
    s_lshl_b32 s72, s44, 17
    s_lshl_b32 s70, s2, 2
    s_add_u32 s70, s70, s44
    s_mov_b32 s60, 0x3fb8aa3b
    s_mov_b32 s61, 0x3fb8aa3b
    s_mov_b32 s62, 0x3eb8aa3b
    s_mov_b32 s63, 0x3eb8aa3b
    v_lshlrev_b32 v1, 4, v0
    v_lshrrev_b32 v15, 4, v0
    v_and_b32 v2, 7, v0
    v_xor_b32 v2, v2, v15
    v_lshlrev_b32 v2, 4, v2
    v_lshrrev_b32 v15, 3, v0
    v_lshl_or_b32 v2, v15, 10, v2
    v_xor_b32 v3, 64, v2
    v_lshrrev_b32 v15, 2, v0
    v_and_b32 v5, 3, v0
    v_lshlrev_b32 v5, 4, v5
    s_movk_i32 s48, 3584
    v_mad_u32_u24 v4, v15, s48, v5
    v_bfe_u32 v15, v0, 4, 1
    v_lshlrev_b32 v15, 2, v15
    v_and_b32 v5, 7, v0
    v_xor_b32 v5, v5, v15
    v_lshlrev_b32 v5, 4, v5
    v_lshrrev_b32 v15, 3, v0
    v_mad_u32_u24 v170, v15, s48, v5
    v_lshl_or_b32 v5, v15, 10, v5
    s_mul_i32 s59, s44, 114688
    s_lshl_b32 s82, s44, 12
    v_and_b32 v15, 31, v0
    v_lshlrev_b32 v92, 7, v15
    v_add_u32 v92, s46, v92
    v_bfe_u32 v93, v0, 1, 3
    v_lshrrev_b32 v94, 5, v0
    v_xor_b32 v93, v93, v94
    v_xor_b32 v95, 0, v93
    v_lshl_add_u32 v6, v95, 4, v92
    v_xor_b32 v95, 2, v93
    v_lshl_add_u32 v7, v95, 4, v92
    v_xor_b32 v95, 4, v93
    v_lshl_add_u32 v8, v95, 4, v92
    v_xor_b32 v95, 6, v93
    v_lshl_add_u32 v9, v95, 4, v92
    v_bfe_u32 v95, v0, 2, 2
    v_lshl_add_u32 v95, v94, 3, v95
    v_lshlrev_b32 v10, 6, v95
    v_bfe_u32 v96, v0, 4, 1
    v_lshl_add_u32 v10, v96, 5, v10
    v_and_b32 v96, 3, v0
    v_lshl_add_u32 v10, v96, 3, v10
    v_add_u32 v11, 0x10000, v10
    v_add_u32 v12, 0x20000, v10
    v_lshlrev_b32 v164, 7, v95
    v_lshl_add_u32 v164, v96, 3, v164
    v_bfe_u32 v96, v0, 4, 1
    v_lshl_add_u32 v164, v96, 5, v164
    v_bfe_u32 v96, v0, 3, 1
    v_lshl_add_u32 v164, v96, 6, v164
    v_xor_b32 v167, 64, v164
    v_add_u32 v165, 0x10000, v164
    v_add_u32 v166, 0x20000, v164
    v_add_u32 v168, 0x10000, v167
    v_add_u32 v169, 0x20000, v167
    v_lshlrev_b32 v13, 1, v15
    v_lshl_or_b32 v13, v94, 20, v13
    v_mov_b32 v21, 0
    v_mov_b32 v25, 0
    v_mov_b32 v22, 0
    v_mov_b32 v26, 0
    v_mov_b32 v23, 0
    v_mov_b32 v27, 0
    v_mov_b32 v24, 0x3f80
    v_cmp_gt_u32 vcc, 32, v0
    s_nop 1
    v_cndmask_b32 v24, 0, v24, vcc
    v_lshlrev_b32 v14, 1, v15
    v_lshl_or_b32 v14, v94, 12, v14
    s_waitcnt lgkmcnt(0)
    s_cmp_ge_u32 s47, 8
    s_cbranch_scc1 K1_B
    s_lshl_b32 s55, s47, 7
    s_add_u32 s55, s55, 2048
    s_lshl_b32 s73, s47, 6
    s_add_u32 s73, s73, 3072
    s_lshl_b32 s56, s47, 7
    s_mov_b32 m0, s46
    s_nop 0
    buffer_load_dwordx4 v2, s[8:11], s50 offen lds
    s_add_u32 m0, s46, 1024
    s_nop 0
    buffer_load_dwordx4 v3, s[8:11], s51 offen lds
    s_add_u32 m0, s46, 2048
    s_nop 0
    buffer_load_dwordx4 v2, s[8:11], s52 offen lds
    s_add_u32 m0, s46, 3072
    s_nop 0
    buffer_load_dwordx4 v3, s[8:11], s53 offen lds
    s_add_u32 m0, s46, 3968
    s_nop 0
    buffer_load_dwordx4 v2, s[8:11], s50 offen offset:128 lds
    s_add_u32 m0, s46, 4992
    s_nop 0
    buffer_load_dwordx4 v3, s[8:11], s51 offen offset:128 lds
    s_add_u32 m0, s46, 6016
    s_nop 0
    buffer_load_dwordx4 v2, s[8:11], s52 offen offset:128 lds
    s_add_u32 m0, s46, 7040
    s_nop 0
    buffer_load_dwordx4 v3, s[8:11], s53 offen offset:128 lds
    s_add_u32 s54, s55, s59
    s_mov_b32 m0, s82
    s_nop 0
    buffer_load_dwordx4 v170, s[12:15], s54 offen lds
    s_add_u32 s54, s54, 28672
    s_add_u32 m0, s82, 1024
    s_nop 0
    buffer_load_dwordx4 v170, s[12:15], s54 offen lds
    s_add_u32 s54, s54, 28672
    s_add_u32 m0, s82, 2048
    s_nop 0
    buffer_load_dwordx4 v170, s[12:15], s54 offen lds
    s_add_u32 s54, s54, 28672
    s_add_u32 m0, s82, 3072
    s_nop 0
    buffer_load_dwordx4 v170, s[12:15], s54 offen lds
    buffer_load_ushort v16, v13, s[24:27], s55 offen
    buffer_load_ushort v17, v13, s[24:27], s55 offen offset:64
    buffer_load_ushort v18, v13, s[24:27], s73 offen
    s_add_u32 m0, s46, 7936
    s_nop 0
    buffer_load_dwordx4 v2, s[8:11], s50 offen offset:256 lds
    s_add_u32 m0, s46, 8960
    s_nop 0
    buffer_load_dwordx4 v3, s[8:11], s51 offen offset:256 lds
    s_add_u32 m0, s46, 9984
    s_nop 0
    buffer_load_dwordx4 v2, s[8:11], s52 offen offset:256 lds
    s_add_u32 m0, s46, 11008
    s_nop 0
    buffer_load_dwordx4 v3, s[8:11], s53 offen offset:256 lds
    s_add_u32 m0, s46, 11904
    s_nop 0
    buffer_load_dwordx4 v2, s[8:11], s50 offen offset:384 lds
    s_add_u32 m0, s46, 12928
    s_nop 0
    buffer_load_dwordx4 v3, s[8:11], s51 offen offset:384 lds
    s_add_u32 m0, s46, 13952
    s_nop 0
    buffer_load_dwordx4 v2, s[8:11], s52 offen offset:384 lds
    s_add_u32 m0, s46, 14976
    s_nop 0
    buffer_load_dwordx4 v3, s[8:11], s53 offen offset:384 lds
    s_add_u32 s54, s55, s59
    s_add_u32 s54, s54, 458752
    s_add_u32 m0, s82, 16384
    s_nop 0
    buffer_load_dwordx4 v170, s[12:15], s54 offen lds
    s_add_u32 s54, s54, 28672
    s_add_u32 m0, s82, 17408
    s_nop 0
    buffer_load_dwordx4 v170, s[12:15], s54 offen lds
    s_add_u32 s54, s54, 28672
    s_add_u32 m0, s82, 18432
    s_nop 0
    buffer_load_dwordx4 v170, s[12:15], s54 offen lds
    s_add_u32 s54, s54, 28672
    s_add_u32 m0, s82, 19456
    s_nop 0
    buffer_load_dwordx4 v170, s[12:15], s54 offen lds
    s_mul_i32 s57, s45, 114688
    s_add_u32 s57, s57, 4718592
    s_lshl_b32 s48, s73, 5
    s_add_u32 s75, s57, s48
    s_lshl_b32 s48, s55, 5
    s_add_u32 s57, s57, s48
    s_lshl_b32 s58, s45, 15
    s_lshl_b32 s48, s56, 5
    s_add_u32 s58, s58, s48
    s_waitcnt vmcnt(12)
    s_barrier
    ds_read_b128 a[0:3], v6 offset:0
    ds_read_b128 a[4:7], v7 offset:0
    ds_read_b128 a[8:11], v8 offset:0
    ds_read_b128 a[12:15], v9 offset:0
    ds_read_b128 a[16:19], v6 offset:4096
    ds_read_b128 a[20:23], v7 offset:4096
    ds_read_b128 a[24:27], v8 offset:4096
    ds_read_b128 a[28:31], v9 offset:4096
    ds_read_b64_tr_b16 v[108:109], v164 offset:0
    ds_read_b64_tr_b16 v[110:111], v164 offset:512
    ds_read_b64_tr_b16 v[112:113], v167 offset:0
    ds_read_b64_tr_b16 v[114:115], v167 offset:512
    ds_read_b64_tr_b16 v[116:117], v164 offset:2048
    ds_read_b64_tr_b16 v[118:119], v164 offset:2560
    ds_read_b64_tr_b16 v[120:121], v167 offset:2048
    ds_read_b64_tr_b16 v[122:123], v167 offset:2560
    ds_read_b64_tr_b16 v[124:125], v164 offset:4096
    ds_read_b64_tr_b16 v[126:127], v164 offset:4608
    ds_read_b64_tr_b16 v[128:129], v167 offset:4096
    ds_read_b64_tr_b16 v[130:131], v167 offset:4608
    ds_read_b64_tr_b16 v[132:133], v164 offset:6144
    ds_read_b64_tr_b16 v[134:135], v164 offset:6656
    v_mov_b32 v20, v16
    s_nop 1
    v_mfma_f32_32x32x16_bf16 v[44:59], v[20:23], v[24:27], 0
    s_waitcnt lgkmcnt(6)
    v_mfma_f32_32x32x16_bf16 v[44:59], v[108:111], a[0:3], v[44:59]
    ds_read_b64_tr_b16 v[136:137], v167 offset:6144
    ds_read_b64_tr_b16 v[138:139], v167 offset:6656
    s_add_u32 m0, s46, 15872
    s_nop 0
    buffer_load_dwordx4 v2, s[8:11], s50 offen offset:512 lds
    s_add_u32 m0, s46, 16896
    s_nop 0
    buffer_load_dwordx4 v3, s[8:11], s51 offen offset:512 lds
    v_mov_b32 v20, v17
    s_nop 1
    v_mfma_f32_32x32x16_bf16 v[60:75], v[20:23], v[24:27], 0
    v_mfma_f32_32x32x16_bf16 v[60:75], v[112:115], a[0:3], v[60:75]
    ds_read_b64_tr_b16 v[108:109], v164 offset:8192
    ds_read_b64_tr_b16 v[110:111], v164 offset:8704
    s_add_u32 m0, s46, 17920
    s_nop 0
    buffer_load_dwordx4 v2, s[8:11], s52 offen offset:512 lds
    s_add_u32 m0, s46, 18944
    s_nop 0
    buffer_load_dwordx4 v3, s[8:11], s53 offen offset:512 lds
    v_mfma_f32_32x32x16_bf16 v[44:59], v[116:119], a[4:7], v[44:59]
    ds_read_b64_tr_b16 v[112:113], v167 offset:8192
    ds_read_b64_tr_b16 v[114:115], v167 offset:8704
    s_add_u32 m0, s46, 19840
    s_nop 0
    buffer_load_dwordx4 v2, s[8:11], s50 offen offset:640 lds
    s_add_u32 m0, s46, 20864
    s_nop 0
    buffer_load_dwordx4 v3, s[8:11], s51 offen offset:640 lds
    s_add_u32 s64, s70, 0
    s_lshr_b32 s48, s64, 4
    s_cmp_ge_u32 s48, 112
    s_cselect_b32 s40, s36, s32
    s_cselect_b32 s41, s37, s33
    s_cselect_b32 s42, s38, s34
    s_mov_b32 s43, 0x00020000
    s_cselect_b32 s49, 112, 0
    s_sub_u32 s48, s48, s49
    s_lshl_b32 s48, s48, 14
    s_and_b32 s49, s64, 15
    s_lshl_b32 s49, s49, 6
    s_add_u32 s65, s48, s49
    s_add_u32 s66, s65, 8192
    s_lshl_b32 s67, s64, 10
    s_add_u32 s67, s67, 2359296
    v_mfma_f32_32x32x16_bf16 v[60:75], v[120:123], a[4:7], v[60:75]
    ds_read_b64_tr_b16 v[116:117], v164 offset:10240
    ds_read_b64_tr_b16 v[118:119], v164 offset:10752
    s_add_u32 m0, s46, 21888
    s_nop 0
    buffer_load_dwordx4 v2, s[8:11], s52 offen offset:640 lds
    s_add_u32 m0, s46, 22912
    s_nop 0
    buffer_load_dwordx4 v3, s[8:11], s53 offen offset:640 lds
    buffer_load_ushort v92, v14, s[40:43], s65 offen
    s_waitcnt lgkmcnt(6)
    v_mfma_f32_32x32x16_bf16 v[44:59], v[124:127], a[8:11], v[44:59]
    ds_read_b64_tr_b16 v[120:121], v167 offset:10240
    ds_read_b64_tr_b16 v[122:123], v167 offset:10752
    s_add_u32 s54, s55, s59
    s_add_u32 s54, s54, 917504
    s_add_u32 m0, s46, 24576
    s_nop 0
    buffer_load_dwordx4 v170, s[12:15], s54 offen lds
    s_add_u32 s54, s54, 28672
    s_add_u32 m0, s46, 25600
    s_nop 0
    buffer_load_dwordx4 v170, s[12:15], s54 offen lds
    buffer_load_ushort v93, v14, s[40:43], s65 offen offset:1024
    v_mfma_f32_32x32x16_bf16 v[60:75], v[128:131], a[8:11], v[60:75]
    ds_read_b64_tr_b16 v[124:125], v164 offset:12288
    ds_read_b64_tr_b16 v[126:127], v164 offset:12800
    s_add_u32 s54, s54, 28672
    s_add_u32 m0, s46, 26624
    s_nop 0
    buffer_load_dwordx4 v170, s[12:15], s54 offen lds
    s_add_u32 s54, s54, 28672
    s_add_u32 m0, s46, 27648
    s_nop 0
    buffer_load_dwordx4 v170, s[12:15], s54 offen lds
    buffer_load_ushort v94, v14, s[40:43], s65 offen offset:2048
    v_mfma_f32_32x32x16_bf16 v[44:59], v[132:135], a[12:15], v[44:59]
    ds_read_b64_tr_b16 v[128:129], v167 offset:12288
    ds_read_b64_tr_b16 v[130:131], v167 offset:12800
    s_sub_u32 m0, s46, 768
    s_nop 0
    buffer_load_dwordx4 v2, s[8:11], s50 offen offset:768 lds
    s_add_u32 m0, s46, 256
    s_nop 0
    buffer_load_dwordx4 v3, s[8:11], s51 offen offset:768 lds
    buffer_load_ushort v95, v14, s[40:43], s65 offen offset:3072
    v_mfma_f32_32x32x16_bf16 v[60:75], v[136:139], a[12:15], v[60:75]
    ds_read_b64_tr_b16 v[132:133], v164 offset:14336
    ds_read_b64_tr_b16 v[134:135], v164 offset:14848
    s_add_u32 m0, s46, 1280
    s_nop 0
    buffer_load_dwordx4 v2, s[8:11], s52 offen offset:768 lds
    s_add_u32 m0, s46, 2304
    s_nop 0
    buffer_load_dwordx4 v3, s[8:11], s53 offen offset:768 lds
    buffer_load_ushort v96, v14, s[40:43], s66 offen
    s_waitcnt lgkmcnt(6)
    v_mfma_f32_32x32x16_bf16 v[44:59], v[108:111], a[16:19], v[44:59]
    ds_read_b64_tr_b16 v[136:137], v167 offset:14336
    ds_read_b64_tr_b16 v[138:139], v167 offset:14848
    s_add_u32 m0, s46, 3200
    s_nop 0
    buffer_load_dwordx4 v2, s[8:11], s50 offen offset:896 lds
    s_add_u32 m0, s46, 4224
    s_nop 0
    buffer_load_dwordx4 v3, s[8:11], s51 offen offset:896 lds
    buffer_load_ushort v97, v14, s[40:43], s66 offen offset:1024
    s_waitcnt vmcnt(24)
    s_barrier
    ds_read_b128 a[32:35], v6 offset:8192
    ds_read_b128 a[36:39], v7 offset:8192
    ds_read_b128 a[40:43], v8 offset:8192
    ds_read_b128 a[44:47], v9 offset:8192
    ds_read_b128 a[48:51], v6 offset:12288
    ds_read_b128 a[52:55], v7 offset:12288
    ds_read_b128 a[56:59], v8 offset:12288
    ds_read_b128 a[60:63], v9 offset:12288
    v_mfma_f32_32x32x16_bf16 v[60:75], v[112:115], a[16:19], v[60:75]
    ds_read_b64_tr_b16 v[108:109], v164 offset:16384
    ds_read_b64_tr_b16 v[110:111], v164 offset:16896
    s_add_u32 m0, s46, 5248
    s_nop 0
    buffer_load_dwordx4 v2, s[8:11], s52 offen offset:896 lds
    s_add_u32 m0, s46, 6272
    s_nop 0
    buffer_load_dwordx4 v3, s[8:11], s53 offen offset:896 lds
    buffer_load_ushort v98, v14, s[40:43], s66 offen offset:2048
    v_mfma_f32_32x32x16_bf16 v[44:59], v[116:119], a[20:23], v[44:59]
    ds_read_b64_tr_b16 v[112:113], v167 offset:16384
    ds_read_b64_tr_b16 v[114:115], v167 offset:16896
    s_add_u32 s54, s55, s59
    s_add_u32 s54, s54, 1376256
    s_add_u32 m0, s46, 28672
    s_nop 0
    buffer_load_dwordx4 v170, s[12:15], s54 offen lds
    s_add_u32 s54, s54, 28672
    s_add_u32 m0, s46, 29696
    s_nop 0
    buffer_load_dwordx4 v170, s[12:15], s54 offen lds
    buffer_load_ushort v99, v14, s[40:43], s66 offen offset:3072
    v_mfma_f32_32x32x16_bf16 v[60:75], v[120:123], a[20:23], v[60:75]
    ds_read_b64_tr_b16 v[116:117], v164 offset:18432
    ds_read_b64_tr_b16 v[118:119], v164 offset:18944
    s_add_u32 s54, s54, 28672
    s_add_u32 m0, s46, 30720
    s_nop 0
    buffer_load_dwordx4 v170, s[12:15], s54 offen lds
    s_add_u32 s54, s54, 28672
    s_add_u32 m0, s46, 31744
    s_nop 0
    buffer_load_dwordx4 v170, s[12:15], s54 offen lds
    s_waitcnt lgkmcnt(14)
    v_mfma_f32_32x32x16_bf16 v[44:59], v[124:127], a[24:27], v[44:59]
    ds_read_b64_tr_b16 v[120:121], v167 offset:18432
    ds_read_b64_tr_b16 v[122:123], v167 offset:18944
    v_mfma_f32_32x32x16_bf16 v[60:75], v[128:131], a[24:27], v[60:75]
    ds_read_b64_tr_b16 v[124:125], v164 offset:20480
    ds_read_b64_tr_b16 v[126:127], v164 offset:20992
    v_mfma_f32_32x32x16_bf16 v[44:59], v[132:135], a[28:31], v[44:59]
    ds_read_b64_tr_b16 v[128:129], v167 offset:20480
    ds_read_b64_tr_b16 v[130:131], v167 offset:20992
    v_mfma_f32_32x32x16_bf16 v[60:75], v[136:139], a[28:31], v[60:75]
    ds_read_b64_tr_b16 v[132:133], v164 offset:22528
    ds_read_b64_tr_b16 v[134:135], v164 offset:23040
    s_waitcnt lgkmcnt(6)
    v_mfma_f32_32x32x16_bf16 v[44:59], v[108:111], a[32:35], v[44:59]
    ds_read_b64_tr_b16 v[136:137], v167 offset:22528
    ds_read_b64_tr_b16 v[138:139], v167 offset:23040
    s_add_u32 s54, s73, s71
    s_add_u32 m0, s46, 8192
    s_nop 0
    buffer_load_dwordx4 v4, s[12:15], s54 offen lds
    s_add_u32 s54, s54, 57344
    s_add_u32 m0, s46, 9216
    s_nop 0
    buffer_load_dwordx4 v4, s[12:15], s54 offen lds
    v_mfma_f32_32x32x16_bf16 v[60:75], v[112:115], a[32:35], v[60:75]
    ds_read_b64_tr_b16 v[108:109], v164 offset:24576
    ds_read_b64_tr_b16 v[110:111], v164 offset:25088
    s_add_u32 s54, s54, 57344
    s_add_u32 m0, s46, 10240
    s_nop 0
    buffer_load_dwordx4 v4, s[12:15], s54 offen lds
    s_add_u32 s54, s54, 57344
    s_add_u32 m0, s46, 11264
    s_nop 0
    buffer_load_dwordx4 v4, s[12:15], s54 offen lds
    v_mfma_f32_32x32x16_bf16 v[44:59], v[116:119], a[36:39], v[44:59]
    ds_read_b64_tr_b16 v[112:113], v167 offset:24576
    ds_read_b64_tr_b16 v[114:115], v167 offset:25088
    s_add_u32 s54, s54, 57344
    s_add_u32 m0, s46, 12288
    s_nop 0
    buffer_load_dwordx4 v4, s[12:15], s54 offen lds
    s_add_u32 s54, s54, 57344
    s_add_u32 m0, s46, 13312
    s_nop 0
    buffer_load_dwordx4 v4, s[12:15], s54 offen lds
    v_mfma_f32_32x32x16_bf16 v[60:75], v[120:123], a[36:39], v[60:75]
    ds_read_b64_tr_b16 v[116:117], v164 offset:26624
    ds_read_b64_tr_b16 v[118:119], v164 offset:27136
    s_add_u32 s54, s54, 57344
    s_add_u32 m0, s46, 14336
    s_nop 0
    buffer_load_dwordx4 v4, s[12:15], s54 offen lds
    s_add_u32 s54, s54, 57344
    s_add_u32 m0, s46, 15360
    s_nop 0
    buffer_load_dwordx4 v4, s[12:15], s54 offen lds
    s_waitcnt lgkmcnt(6)
    v_mfma_f32_32x32x16_bf16 v[44:59], v[124:127], a[40:43], v[44:59]
    ds_read_b64_tr_b16 v[120:121], v167 offset:26624
    ds_read_b64_tr_b16 v[122:123], v167 offset:27136
    v_mfma_f32_32x32x16_bf16 v[60:75], v[128:131], a[40:43], v[60:75]
    ds_read_b64_tr_b16 v[124:125], v164 offset:28672
    ds_read_b64_tr_b16 v[126:127], v164 offset:29184
    v_mfma_f32_32x32x16_bf16 v[44:59], v[132:135], a[44:47], v[44:59]
    ds_read_b64_tr_b16 v[128:129], v167 offset:28672
    ds_read_b64_tr_b16 v[130:131], v167 offset:29184
    s_waitcnt vmcnt(10)
    v_lshl_or_b32 v100, v93, 16, v92
    v_lshl_or_b32 v101, v95, 16, v94
    v_lshl_or_b32 v102, v97, 16, v96
    v_lshl_or_b32 v103, v99, 16, v98
    buffer_store_dwordx4 v[100:103], v1, s[20:23], s67 offen sc0 sc1
    s_add_u32 s64, s70, 1024
    s_lshr_b32 s48, s64, 4
    s_cmp_ge_u32 s48, 112
    s_cselect_b32 s40, s36, s32
    s_cselect_b32 s41, s37, s33
    s_cselect_b32 s42, s38, s34
    s_mov_b32 s43, 0x00020000
    s_cselect_b32 s49, 112, 0
    s_sub_u32 s48, s48, s49
    s_lshl_b32 s48, s48, 14
    s_and_b32 s49, s64, 15
    s_lshl_b32 s49, s49, 6
    s_add_u32 s65, s48, s49
    s_add_u32 s66, s65, 8192
    s_lshl_b32 s67, s64, 10
    s_add_u32 s67, s67, 2359296
    v_mfma_f32_32x32x16_bf16 v[60:75], v[136:139], a[44:47], v[60:75]
    ds_read_b64_tr_b16 v[132:133], v164 offset:30720
    ds_read_b64_tr_b16 v[134:135], v164 offset:31232
    buffer_load_ushort v92, v14, s[40:43], s65 offen
    s_waitcnt lgkmcnt(6)
    v_mfma_f32_32x32x16_bf16 v[44:59], v[108:111], a[48:51], v[44:59]
    ds_read_b64_tr_b16 v[136:137], v167 offset:30720
    ds_read_b64_tr_b16 v[138:139], v167 offset:31232
    buffer_load_ushort v93, v14, s[40:43], s65 offen offset:1024
    s_barrier
    ds_read_b128 a[64:67], v6 offset:16384
    ds_read_b128 a[68:71], v7 offset:16384
    ds_read_b128 a[72:75], v8 offset:16384
    ds_read_b128 a[76:79], v9 offset:16384
    ds_read_b128 a[80:83], v6 offset:20480
    ds_read_b128 a[84:87], v7 offset:20480
    ds_read_b128 a[88:91], v8 offset:20480
    ds_read_b128 a[92:95], v9 offset:20480
    v_mfma_f32_32x32x16_bf16 v[60:75], v[112:115], a[48:51], v[60:75]
    ds_read_b64_tr_b16 v[108:109], v164 offset:57344
    ds_read_b64_tr_b16 v[110:111], v164 offset:57856
    buffer_load_ushort v94, v14, s[40:43], s65 offen offset:2048
    v_mfma_f32_32x32x16_bf16 v[44:59], v[116:119], a[52:55], v[44:59]
    ds_read_b64_tr_b16 v[112:113], v167 offset:57344
    ds_read_b64_tr_b16 v[114:115], v167 offset:57856
    buffer_load_ushort v95, v14, s[40:43], s65 offen offset:3072
    v_mfma_f32_32x32x16_bf16 v[60:75], v[120:123], a[52:55], v[60:75]
    ds_read_b64_tr_b16 v[116:117], v164 offset:59392
    ds_read_b64_tr_b16 v[118:119], v164 offset:59904
    buffer_load_ushort v96, v14, s[40:43], s66 offen
    s_waitcnt lgkmcnt(14)
    v_mfma_f32_32x32x16_bf16 v[44:59], v[124:127], a[56:59], v[44:59]
    ds_read_b64_tr_b16 v[120:121], v167 offset:59392
    ds_read_b64_tr_b16 v[122:123], v167 offset:59904
    buffer_load_ushort v97, v14, s[40:43], s66 offen offset:1024
    v_mfma_f32_32x32x16_bf16 v[60:75], v[128:131], a[56:59], v[60:75]
    ds_read_b64_tr_b16 v[124:125], v165 offset:24576
    ds_read_b64_tr_b16 v[126:127], v165 offset:25088
    buffer_load_ushort v98, v14, s[40:43], s66 offen offset:2048
    v_mfma_f32_32x32x16_bf16 v[44:59], v[132:135], a[60:63], v[44:59]
    ds_read_b64_tr_b16 v[128:129], v168 offset:24576
    ds_read_b64_tr_b16 v[130:131], v168 offset:25088
    buffer_load_ushort v99, v14, s[40:43], s66 offen offset:3072
    v_mfma_f32_32x32x16_bf16 v[60:75], v[136:139], a[60:63], v[60:75]
    ds_read_b64_tr_b16 v[132:133], v165 offset:26624
    ds_read_b64_tr_b16 v[134:135], v165 offset:27136
    s_waitcnt lgkmcnt(6)
    v_mfma_f32_32x32x16_bf16 v[44:59], v[108:111], a[64:67], v[44:59]
    ds_read_b64_tr_b16 v[136:137], v168 offset:26624
    ds_read_b64_tr_b16 v[138:139], v168 offset:27136
    s_add_u32 s54, s56, s72
    s_add_u32 m0, s46, 16384
    s_nop 0
    buffer_load_dwordx4 v5, s[16:19], s54 offen lds
    s_add_u32 s54, s54, 8192
    s_add_u32 m0, s46, 17408
    s_nop 0
    buffer_load_dwordx4 v5, s[16:19], s54 offen lds
    v_mfma_f32_32x32x16_bf16 v[60:75], v[112:115], a[64:67], v[60:75]
    ds_read_b64_tr_b16 v[108:109], v165 offset:57344
    ds_read_b64_tr_b16 v[110:111], v165 offset:57856
    s_add_u32 s54, s54, 8192
    s_add_u32 m0, s46, 18432
    s_nop 0
    buffer_load_dwordx4 v5, s[16:19], s54 offen lds
    s_add_u32 s54, s54, 8192
    s_add_u32 m0, s46, 19456
    s_nop 0
    buffer_load_dwordx4 v5, s[16:19], s54 offen lds
    v_mfma_f32_32x32x16_bf16 v[44:59], v[116:119], a[68:71], v[44:59]
    ds_read_b64_tr_b16 v[112:113], v168 offset:57344
    ds_read_b64_tr_b16 v[114:115], v168 offset:57856
    s_add_u32 s54, s54, 8192
    s_add_u32 m0, s46, 20480
    s_nop 0
    buffer_load_dwordx4 v5, s[16:19], s54 offen lds
    s_add_u32 s54, s54, 8192
    s_add_u32 m0, s46, 21504
    s_nop 0
    buffer_load_dwordx4 v5, s[16:19], s54 offen lds
    v_mfma_f32_32x32x16_bf16 v[60:75], v[120:123], a[68:71], v[60:75]
    ds_read_b64_tr_b16 v[116:117], v165 offset:59392
    ds_read_b64_tr_b16 v[118:119], v165 offset:59904
    s_add_u32 s54, s54, 8192
    s_add_u32 m0, s46, 22528
    s_nop 0
    buffer_load_dwordx4 v5, s[16:19], s54 offen lds
    s_add_u32 s54, s54, 8192
    s_add_u32 m0, s46, 23552
    s_nop 0
    buffer_load_dwordx4 v5, s[16:19], s54 offen lds
    s_waitcnt lgkmcnt(6)
    v_mfma_f32_32x32x16_bf16 v[44:59], v[124:127], a[72:75], v[44:59]
    ds_read_b64_tr_b16 v[120:121], v168 offset:59392
    ds_read_b64_tr_b16 v[122:123], v168 offset:59904
    v_mfma_f32_32x32x16_bf16 v[60:75], v[128:131], a[72:75], v[60:75]
    ds_read_b64_tr_b16 v[124:125], v166 offset:24576
    ds_read_b64_tr_b16 v[126:127], v166 offset:25088
    v_mfma_f32_32x32x16_bf16 v[44:59], v[132:135], a[76:79], v[44:59]
    ds_read_b64_tr_b16 v[128:129], v169 offset:24576
    ds_read_b64_tr_b16 v[130:131], v169 offset:25088
    v_mfma_f32_32x32x16_bf16 v[60:75], v[136:139], a[76:79], v[60:75]
    ds_read_b64_tr_b16 v[132:133], v166 offset:26624
    ds_read_b64_tr_b16 v[134:135], v166 offset:27136
    s_waitcnt lgkmcnt(6)
    v_mfma_f32_32x32x16_bf16 v[44:59], v[108:111], a[80:83], v[44:59]
    ds_read_b64_tr_b16 v[136:137], v169 offset:26624
    ds_read_b64_tr_b16 v[138:139], v169 offset:27136
    s_waitcnt vmcnt(25)
    s_barrier
    ds_read_b128 a[96:99], v6 offset:0
    ds_read_b128 a[100:103], v7 offset:0
    ds_read_b128 a[104:107], v8 offset:0
    ds_read_b128 a[108:111], v9 offset:0
    ds_read_b128 a[112:115], v6 offset:4096
    ds_read_b128 a[116:119], v7 offset:4096
    ds_read_b128 a[120:123], v8 offset:4096
    ds_read_b128 a[124:127], v9 offset:4096
    v_mfma_f32_32x32x16_bf16 v[60:75], v[112:115], a[80:83], v[60:75]
    ds_read_b64_tr_b16 v[108:109], v164 offset:61440
    ds_read_b64_tr_b16 v[110:111], v164 offset:61952
    v_mfma_f32_32x32x16_bf16 v[44:59], v[116:119], a[84:87], v[44:59]
    ds_read_b64_tr_b16 v[112:113], v167 offset:61440
    ds_read_b64_tr_b16 v[114:115], v167 offset:61952
    s_waitcnt vmcnt(8)
    v_lshl_or_b32 v100, v93, 16, v92
    v_lshl_or_b32 v101, v95, 16, v94
    v_lshl_or_b32 v102, v97, 16, v96
    v_lshl_or_b32 v103, v99, 16, v98
    buffer_store_dwordx4 v[100:103], v1, s[20:23], s67 offen sc0 sc1
    v_mfma_f32_32x32x16_bf16 v[60:75], v[120:123], a[84:87], v[60:75]
    ds_read_b64_tr_b16 v[116:117], v164 offset:63488
    ds_read_b64_tr_b16 v[118:119], v164 offset:64000
    s_waitcnt lgkmcnt(14)
    v_mfma_f32_32x32x16_bf16 v[44:59], v[124:127], a[88:91], v[44:59]
    ds_read_b64_tr_b16 v[120:121], v167 offset:63488
    ds_read_b64_tr_b16 v[122:123], v167 offset:64000
    v_mfma_f32_32x32x16_bf16 v[60:75], v[128:131], a[88:91], v[60:75]
    ds_read_b64_tr_b16 v[124:125], v165 offset:28672
    ds_read_b64_tr_b16 v[126:127], v165 offset:29184
    v_mfma_f32_32x32x16_bf16 v[44:59], v[132:135], a[92:95], v[44:59]
    ds_read_b64_tr_b16 v[128:129], v168 offset:28672
    ds_read_b64_tr_b16 v[130:131], v168 offset:29184
    v_mfma_f32_32x32x16_bf16 v[60:75], v[136:139], a[92:95], v[60:75]
    ds_read_b64_tr_b16 v[132:133], v165 offset:30720
    ds_read_b64_tr_b16 v[134:135], v165 offset:31232
    s_waitcnt lgkmcnt(6)
    v_mfma_f32_32x32x16_bf16 v[44:59], v[108:111], a[96:99], v[44:59]
    ds_read_b64_tr_b16 v[136:137], v168 offset:30720
    ds_read_b64_tr_b16 v[138:139], v168 offset:31232
    s_add_u32 s54, s54, 8192
    s_mov_b32 m0, s46
    s_nop 0
    buffer_load_dwordx4 v5, s[16:19], s54 offen lds
    s_add_u32 s54, s54, 8192
    s_add_u32 m0, s46, 1024
    s_nop 0
    buffer_load_dwordx4 v5, s[16:19], s54 offen lds
    v_mfma_f32_32x32x16_bf16 v[60:75], v[112:115], a[96:99], v[60:75]
    ds_read_b64_tr_b16 v[108:109], v165 offset:61440
    ds_read_b64_tr_b16 v[110:111], v165 offset:61952
    s_add_u32 s54, s54, 8192
    s_add_u32 m0, s46, 2048
    s_nop 0
    buffer_load_dwordx4 v5, s[16:19], s54 offen lds
    s_add_u32 s54, s54, 8192
    s_add_u32 m0, s46, 3072
    s_nop 0
    buffer_load_dwordx4 v5, s[16:19], s54 offen lds
    v_mfma_f32_32x32x16_bf16 v[44:59], v[116:119], a[100:103], v[44:59]
    ds_read_b64_tr_b16 v[112:113], v168 offset:61440
    ds_read_b64_tr_b16 v[114:115], v168 offset:61952
    s_add_u32 s54, s54, 8192
    s_add_u32 m0, s46, 4096
    s_nop 0
    buffer_load_dwordx4 v5, s[16:19], s54 offen lds
    s_add_u32 s54, s54, 8192
    s_add_u32 m0, s46, 5120
    s_nop 0
    buffer_load_dwordx4 v5, s[16:19], s54 offen lds
    v_mfma_f32_32x32x16_bf16 v[60:75], v[120:123], a[100:103], v[60:75]
    ds_read_b64_tr_b16 v[116:117], v165 offset:63488
    ds_read_b64_tr_b16 v[118:119], v165 offset:64000
    s_add_u32 s54, s54, 8192
    s_add_u32 m0, s46, 6144
    s_nop 0
    buffer_load_dwordx4 v5, s[16:19], s54 offen lds
    s_add_u32 s54, s54, 8192
    s_add_u32 m0, s46, 7168
    s_nop 0
    buffer_load_dwordx4 v5, s[16:19], s54 offen lds
    s_waitcnt lgkmcnt(6)
    v_mfma_f32_32x32x16_bf16 v[44:59], v[124:127], a[104:107], v[44:59]
    ds_read_b64_tr_b16 v[120:121], v168 offset:63488
    ds_read_b64_tr_b16 v[122:123], v168 offset:64000
    v_mfma_f32_32x32x16_bf16 v[60:75], v[128:131], a[104:107], v[60:75]
    ds_read_b64_tr_b16 v[124:125], v166 offset:28672
    ds_read_b64_tr_b16 v[126:127], v166 offset:29184
    v_mfma_f32_32x32x16_bf16 v[44:59], v[132:135], a[108:111], v[44:59]
    ds_read_b64_tr_b16 v[128:129], v169 offset:28672
    ds_read_b64_tr_b16 v[130:131], v169 offset:29184
    v_mfma_f32_32x32x16_bf16 v[60:75], v[136:139], a[108:111], v[60:75]
    ds_read_b64_tr_b16 v[132:133], v166 offset:30720
    ds_read_b64_tr_b16 v[134:135], v166 offset:31232
    s_waitcnt lgkmcnt(6)
    v_mfma_f32_32x32x16_bf16 v[44:59], v[108:111], a[112:115], v[44:59]
    ds_read_b64_tr_b16 v[136:137], v169 offset:30720
    ds_read_b64_tr_b16 v[138:139], v169 offset:31232
    s_barrier
    v_mfma_f32_32x32x16_bf16 v[60:75], v[112:115], a[112:115], v[60:75]
    ds_read_b64_tr_b16 v[108:109], v10 offset:40960
    ds_read_b64_tr_b16 v[110:111], v10 offset:41216
    v_mfma_f32_32x32x16_bf16 v[44:59], v[116:119], a[116:119], v[44:59]
    ds_read_b64_tr_b16 v[112:113], v10 offset:41984
    ds_read_b64_tr_b16 v[114:115], v10 offset:42240
    v_mfma_f32_32x32x16_bf16 v[60:75], v[120:123], a[116:119], v[60:75]
    ds_read_b64_tr_b16 v[116:117], v10 offset:43008
    ds_read_b64_tr_b16 v[118:119], v10 offset:43264
    s_waitcnt lgkmcnt(6)
    v_mfma_f32_32x32x16_bf16 v[44:59], v[124:127], a[120:123], v[44:59]
    ds_read_b64_tr_b16 v[120:121], v10 offset:44032
    ds_read_b64_tr_b16 v[122:123], v10 offset:44288
    v_mfma_f32_32x32x16_bf16 v[60:75], v[128:131], a[120:123], v[60:75]
    ds_read_b64_tr_b16 v[124:125], v10 offset:45056
    ds_read_b64_tr_b16 v[126:127], v10 offset:45312
    v_mfma_f32_32x32x16_bf16 v[44:59], v[132:135], a[124:127], v[44:59]
    ds_read_b64_tr_b16 v[128:129], v10 offset:46080
    ds_read_b64_tr_b16 v[130:131], v10 offset:46336
    v_mfma_f32_32x32x16_bf16 v[60:75], v[136:139], a[124:127], v[60:75]
    ds_read_b64_tr_b16 v[132:133], v10 offset:47104
    ds_read_b64_tr_b16 v[134:135], v10 offset:47360
    v_mov_b32 v20, v18
    s_nop 1
    v_mfma_f32_32x32x16_bf16 v[140:155], v[20:23], v[24:27], 0
    s_waitcnt lgkmcnt(6)
    v_mfma_f32_32x32x16_bf16 v[140:155], v[108:111], a[0:3], v[140:155]
    ds_read_b64_tr_b16 v[136:137], v10 offset:48128
    ds_read_b64_tr_b16 v[138:139], v10 offset:48384
    v_mul_f32 v84, s60, v44
    v_mul_f32 v85, s60, v45
    v_exp_f32 v84, v84
    v_mfma_f32_32x32x16_bf16 v[140:155], v[112:115], a[4:7], v[140:155]
    ds_read_b64_tr_b16 v[108:109], v11 offset:8192
    ds_read_b64_tr_b16 v[110:111], v11 offset:8448
    v_exp_f32 v85, v85
    v_fma_f32 v86, v84, -0.5, -1.0
    v_fma_f32 v87, v85, -0.5, -1.0
    v_fma_f32 v86, v84, v86, -1.0
    v_mfma_f32_32x32x16_bf16 v[140:155], v[116:119], a[8:11], v[140:155]
    ds_read_b64_tr_b16 v[112:113], v11 offset:9216
    ds_read_b64_tr_b16 v[114:115], v11 offset:9472
    v_fma_f32 v87, v85, v87, -1.0
    v_rcp_f32 v86, v86
    v_rcp_f32 v87, v87
    v_mfma_f32_32x32x16_bf16 v[140:155], v[120:123], a[12:15], v[140:155]
    ds_read_b64_tr_b16 v[116:117], v11 offset:10240
    ds_read_b64_tr_b16 v[118:119], v11 offset:10496
    v_fma_f32 v86, v44, v86, v44
    v_fma_f32 v87, v45, v87, v45
    v_cvt_pk_bf16_f32 v76, v86, v87
    s_waitcnt lgkmcnt(6)
    v_mfma_f32_32x32x16_bf16 v[140:155], v[124:127], a[16:19], v[140:155]
    ds_read_b64_tr_b16 v[120:121], v11 offset:11264
    ds_read_b64_tr_b16 v[122:123], v11 offset:11520
    v_mul_f32 v88, s60, v46
    v_mul_f32 v89, s60, v47
    v_exp_f32 v88, v88
    v_mfma_f32_32x32x16_bf16 v[140:155], v[128:131], a[20:23], v[140:155]
    ds_read_b64_tr_b16 v[124:125], v11 offset:12288
    ds_read_b64_tr_b16 v[126:127], v11 offset:12544
    v_exp_f32 v89, v89
    v_fma_f32 v90, v88, -0.5, -1.0
    v_fma_f32 v91, v89, -0.5, -1.0
    v_fma_f32 v90, v88, v90, -1.0
    v_mfma_f32_32x32x16_bf16 v[140:155], v[132:135], a[24:27], v[140:155]
    ds_read_b64_tr_b16 v[128:129], v11 offset:13312
    ds_read_b64_tr_b16 v[130:131], v11 offset:13568
    v_fma_f32 v91, v89, v91, -1.0
    v_rcp_f32 v90, v90
    v_rcp_f32 v91, v91
    v_mfma_f32_32x32x16_bf16 v[140:155], v[136:139], a[28:31], v[140:155]
    ds_read_b64_tr_b16 v[132:133], v11 offset:14336
    ds_read_b64_tr_b16 v[134:135], v11 offset:14592
    v_fma_f32 v90, v46, v90, v46
    v_fma_f32 v91, v47, v91, v47
    v_cvt_pk_bf16_f32 v77, v90, v91
    s_waitcnt lgkmcnt(6)
    v_mfma_f32_32x32x16_bf16 v[140:155], v[108:111], a[32:35], v[140:155]
    ds_read_b64_tr_b16 v[136:137], v11 offset:15360
    ds_read_b64_tr_b16 v[138:139], v11 offset:15616
    v_mul_f32 v84, s60, v48
    v_mul_f32 v85, s60, v49
    v_exp_f32 v84, v84
    v_mfma_f32_32x32x16_bf16 v[140:155], v[112:115], a[36:39], v[140:155]
    ds_read_b64_tr_b16 v[108:109], v11 offset:40960
    ds_read_b64_tr_b16 v[110:111], v11 offset:41216
    v_exp_f32 v85, v85
    v_fma_f32 v86, v84, -0.5, -1.0
    v_fma_f32 v87, v85, -0.5, -1.0
    v_fma_f32 v86, v84, v86, -1.0
    v_mfma_f32_32x32x16_bf16 v[140:155], v[116:119], a[40:43], v[140:155]
    ds_read_b64_tr_b16 v[112:113], v11 offset:41984
    ds_read_b64_tr_b16 v[114:115], v11 offset:42240
    v_fma_f32 v87, v85, v87, -1.0
    v_rcp_f32 v86, v86
    v_rcp_f32 v87, v87
    v_mfma_f32_32x32x16_bf16 v[140:155], v[120:123], a[44:47], v[140:155]
    ds_read_b64_tr_b16 v[116:117], v11 offset:43008
    ds_read_b64_tr_b16 v[118:119], v11 offset:43264
    v_fma_f32 v86, v48, v86, v48
    v_fma_f32 v87, v49, v87, v49
    v_cvt_pk_bf16_f32 v78, v86, v87
    s_waitcnt lgkmcnt(6)
    v_mfma_f32_32x32x16_bf16 v[140:155], v[124:127], a[48:51], v[140:155]
    ds_read_b64_tr_b16 v[120:121], v11 offset:44032
    ds_read_b64_tr_b16 v[122:123], v11 offset:44288
    v_mul_f32 v88, s60, v50
    v_mul_f32 v89, s60, v51
    v_exp_f32 v88, v88
    v_mfma_f32_32x32x16_bf16 v[140:155], v[128:131], a[52:55], v[140:155]
    ds_read_b64_tr_b16 v[124:125], v11 offset:45056
    ds_read_b64_tr_b16 v[126:127], v11 offset:45312
    v_exp_f32 v89, v89
    v_fma_f32 v90, v88, -0.5, -1.0
    v_fma_f32 v91, v89, -0.5, -1.0
    v_fma_f32 v90, v88, v90, -1.0
    v_mfma_f32_32x32x16_bf16 v[140:155], v[132:135], a[56:59], v[140:155]
    ds_read_b64_tr_b16 v[128:129], v11 offset:46080
    ds_read_b64_tr_b16 v[130:131], v11 offset:46336
    v_fma_f32 v91, v89, v91, -1.0
    v_rcp_f32 v90, v90
    v_rcp_f32 v91, v91
    v_mfma_f32_32x32x16_bf16 v[140:155], v[136:139], a[60:63], v[140:155]
    ds_read_b64_tr_b16 v[132:133], v11 offset:47104
    ds_read_b64_tr_b16 v[134:135], v11 offset:47360
    v_fma_f32 v90, v50, v90, v50
    v_fma_f32 v91, v51, v91, v51
    v_cvt_pk_bf16_f32 v79, v90, v91
    s_add_u32 s69, s57, 0
    buffer_store_dwordx4 v[76:79], v1, s[20:23], s69 offen sc0 sc1
    s_waitcnt lgkmcnt(6)
    v_mfma_f32_32x32x16_bf16 v[140:155], v[108:111], a[64:67], v[140:155]
    ds_read_b64_tr_b16 v[136:137], v11 offset:48128
    ds_read_b64_tr_b16 v[138:139], v11 offset:48384
    v_mul_f32 v84, s60, v52
    v_mul_f32 v85, s60, v53
    v_exp_f32 v84, v84
    v_mfma_f32_32x32x16_bf16 v[140:155], v[112:115], a[68:71], v[140:155]
    ds_read_b64_tr_b16 v[108:109], v12 offset:8192
    ds_read_b64_tr_b16 v[110:111], v12 offset:8448
    v_exp_f32 v85, v85
    v_fma_f32 v86, v84, -0.5, -1.0
    v_fma_f32 v87, v85, -0.5, -1.0
    v_fma_f32 v86, v84, v86, -1.0
    v_mfma_f32_32x32x16_bf16 v[140:155], v[116:119], a[72:75], v[140:155]
    ds_read_b64_tr_b16 v[112:113], v12 offset:9216
    ds_read_b64_tr_b16 v[114:115], v12 offset:9472
    v_fma_f32 v87, v85, v87, -1.0
    v_rcp_f32 v86, v86
    v_rcp_f32 v87, v87
    v_mfma_f32_32x32x16_bf16 v[140:155], v[120:123], a[76:79], v[140:155]
    ds_read_b64_tr_b16 v[116:117], v12 offset:10240
    ds_read_b64_tr_b16 v[118:119], v12 offset:10496
    v_fma_f32 v86, v52, v86, v52
    v_fma_f32 v87, v53, v87, v53
    v_cvt_pk_bf16_f32 v80, v86, v87
    s_waitcnt lgkmcnt(6)
    v_mfma_f32_32x32x16_bf16 v[140:155], v[124:127], a[80:83], v[140:155]
    ds_read_b64_tr_b16 v[120:121], v12 offset:11264
    ds_read_b64_tr_b16 v[122:123], v12 offset:11520
    v_mul_f32 v88, s60, v54
    v_mul_f32 v89, s60, v55
    v_exp_f32 v88, v88
    v_mfma_f32_32x32x16_bf16 v[140:155], v[128:131], a[84:87], v[140:155]
    ds_read_b64_tr_b16 v[124:125], v12 offset:12288
    ds_read_b64_tr_b16 v[126:127], v12 offset:12544
    v_exp_f32 v89, v89
    v_fma_f32 v90, v88, -0.5, -1.0
    v_fma_f32 v91, v89, -0.5, -1.0
    v_fma_f32 v90, v88, v90, -1.0
    v_mfma_f32_32x32x16_bf16 v[140:155], v[132:135], a[88:91], v[140:155]
    ds_read_b64_tr_b16 v[128:129], v12 offset:13312
    ds_read_b64_tr_b16 v[130:131], v12 offset:13568
    v_fma_f32 v91, v89, v91, -1.0
    v_rcp_f32 v90, v90
    v_rcp_f32 v91, v91
    v_mfma_f32_32x32x16_bf16 v[140:155], v[136:139], a[92:95], v[140:155]
    ds_read_b64_tr_b16 v[132:133], v12 offset:14336
    ds_read_b64_tr_b16 v[134:135], v12 offset:14592
    v_fma_f32 v90, v54, v90, v54
    v_fma_f32 v91, v55, v91, v55
    v_cvt_pk_bf16_f32 v81, v90, v91
    s_waitcnt lgkmcnt(6)
    v_mfma_f32_32x32x16_bf16 v[140:155], v[108:111], a[96:99], v[140:155]
    ds_read_b64_tr_b16 v[136:137], v12 offset:15360
    ds_read_b64_tr_b16 v[138:139], v12 offset:15616
    v_mul_f32 v84, s60, v56
    v_mul_f32 v85, s60, v57
    v_exp_f32 v84, v84
    s_waitcnt vmcnt(1)
    s_barrier
    v_mfma_f32_32x32x16_bf16 v[140:155], v[112:115], a[100:103], v[140:155]
    ds_read_b64_tr_b16 v[108:109], v164 offset:49152
    ds_read_b64_tr_b16 v[110:111], v164 offset:49664
    v_exp_f32 v85, v85
    v_fma_f32 v86, v84, -0.5, -1.0
    v_fma_f32 v87, v85, -0.5, -1.0
    v_fma_f32 v86, v84, v86, -1.0
    v_mfma_f32_32x32x16_bf16 v[140:155], v[116:119], a[104:107], v[140:155]
    ds_read_b64_tr_b16 v[112:113], v164 offset:51200
    ds_read_b64_tr_b16 v[114:115], v164 offset:51712
    v_fma_f32 v87, v85, v87, -1.0
    v_rcp_f32 v86, v86
    v_rcp_f32 v87, v87
    v_mfma_f32_32x32x16_bf16 v[140:155], v[120:123], a[108:111], v[140:155]
    ds_read_b64_tr_b16 v[116:117], v164 offset:53248
    ds_read_b64_tr_b16 v[118:119], v164 offset:53760
    v_fma_f32 v86, v56, v86, v56
    v_fma_f32 v87, v57, v87, v57
    v_cvt_pk_bf16_f32 v82, v86, v87
    s_waitcnt lgkmcnt(6)
    v_mfma_f32_32x32x16_bf16 v[140:155], v[124:127], a[112:115], v[140:155]
    ds_read_b64_tr_b16 v[120:121], v164 offset:55296
    ds_read_b64_tr_b16 v[122:123], v164 offset:55808
    v_mul_f32 v88, s60, v58
    v_mul_f32 v89, s60, v59
    v_exp_f32 v88, v88
    v_mfma_f32_32x32x16_bf16 v[140:155], v[128:131], a[116:119], v[140:155]
    ds_read_b64_tr_b16 v[124:125], v164 offset:32768
    ds_read_b64_tr_b16 v[126:127], v164 offset:33280
    v_exp_f32 v89, v89
    v_fma_f32 v90, v88, -0.5, -1.0
    v_fma_f32 v91, v89, -0.5, -1.0
    v_fma_f32 v90, v88, v90, -1.0
    v_mfma_f32_32x32x16_bf16 v[140:155], v[132:135], a[120:123], v[140:155]
    ds_read_b64_tr_b16 v[128:129], v164 offset:34816
    ds_read_b64_tr_b16 v[130:131], v164 offset:35328
    v_fma_f32 v91, v89, v91, -1.0
    v_rcp_f32 v90, v90
    v_rcp_f32 v91, v91
    v_mfma_f32_32x32x16_bf16 v[140:155], v[136:139], a[124:127], v[140:155]
    ds_read_b64_tr_b16 v[132:133], v164 offset:36864
    ds_read_b64_tr_b16 v[134:135], v164 offset:37376
    v_fma_f32 v90, v58, v90, v58
    v_fma_f32 v91, v59, v91, v59
    v_cvt_pk_bf16_f32 v83, v90, v91
    s_add_u32 s69, s57, 1024
    buffer_store_dwordx4 v[80:83], v1, s[20:23], s69 offen sc0 sc1
    s_waitcnt lgkmcnt(6)
    v_mfma_f32_32x32x16_bf16 v[44:59], v[108:111], a[0:3], 0
    ds_read_b64_tr_b16 v[136:137], v164 offset:38912
    ds_read_b64_tr_b16 v[138:139], v164 offset:39424
    v_mul_f32 v84, s60, v60
    v_mul_f32 v85, s60, v61
    v_exp_f32 v84, v84
    v_mfma_f32_32x32x16_bf16 v[44:59], v[112:115], a[4:7], v[44:59]
    ds_read_b64_tr_b16 v[108:109], v165 offset:16384
    ds_read_b64_tr_b16 v[110:111], v165 offset:16896
    v_exp_f32 v85, v85
    v_fma_f32 v86, v84, -0.5, -1.0
    v_fma_f32 v87, v85, -0.5, -1.0
    v_fma_f32 v86, v84, v86, -1.0
    v_mfma_f32_32x32x16_bf16 v[44:59], v[116:119], a[8:11], v[44:59]
    ds_read_b64_tr_b16 v[112:113], v165 offset:18432
    ds_read_b64_tr_b16 v[114:115], v165 offset:18944
    v_fma_f32 v87, v85, v87, -1.0
    v_rcp_f32 v86, v86
    v_rcp_f32 v87, v87
    v_mfma_f32_32x32x16_bf16 v[44:59], v[120:123], a[12:15], v[44:59]
    ds_read_b64_tr_b16 v[116:117], v165 offset:20480
    ds_read_b64_tr_b16 v[118:119], v165 offset:20992
    v_fma_f32 v86, v60, v86, v60
    v_fma_f32 v87, v61, v87, v61
    v_cvt_pk_bf16_f32 v76, v86, v87
    s_waitcnt lgkmcnt(6)
    v_mfma_f32_32x32x16_bf16 v[44:59], v[124:127], a[16:19], v[44:59]
    ds_read_b64_tr_b16 v[120:121], v165 offset:22528
    ds_read_b64_tr_b16 v[122:123], v165 offset:23040
    v_mul_f32 v88, s60, v62
    v_mul_f32 v89, s60, v63
    v_exp_f32 v88, v88
    v_mfma_f32_32x32x16_bf16 v[44:59], v[128:131], a[20:23], v[44:59]
    ds_read_b64_tr_b16 v[124:125], v165 offset:0
    ds_read_b64_tr_b16 v[126:127], v165 offset:512
    v_exp_f32 v89, v89
    v_fma_f32 v90, v88, -0.5, -1.0
    v_fma_f32 v91, v89, -0.5, -1.0
    v_fma_f32 v90, v88, v90, -1.0
    v_mfma_f32_32x32x16_bf16 v[44:59], v[132:135], a[24:27], v[44:59]
    ds_read_b64_tr_b16 v[128:129], v165 offset:2048
    ds_read_b64_tr_b16 v[130:131], v165 offset:2560
    v_fma_f32 v91, v89, v91, -1.0
    v_rcp_f32 v90, v90
    v_rcp_f32 v91, v91
    v_mfma_f32_32x32x16_bf16 v[44:59], v[136:139], a[28:31], v[44:59]
    ds_read_b64_tr_b16 v[132:133], v165 offset:4096
    ds_read_b64_tr_b16 v[134:135], v165 offset:4608
    v_fma_f32 v90, v62, v90, v62
    v_fma_f32 v91, v63, v91, v63
    v_cvt_pk_bf16_f32 v77, v90, v91
    s_waitcnt lgkmcnt(6)
    v_mfma_f32_32x32x16_bf16 v[44:59], v[108:111], a[32:35], v[44:59]
    ds_read_b64_tr_b16 v[136:137], v165 offset:6144
    ds_read_b64_tr_b16 v[138:139], v165 offset:6656
    v_mul_f32 v84, s60, v64
    v_mul_f32 v85, s60, v65
    v_exp_f32 v84, v84
    v_mfma_f32_32x32x16_bf16 v[44:59], v[112:115], a[36:39], v[44:59]
    ds_read_b64_tr_b16 v[108:109], v165 offset:49152
    ds_read_b64_tr_b16 v[110:111], v165 offset:49664
    v_exp_f32 v85, v85
    v_fma_f32 v86, v84, -0.5, -1.0
    v_fma_f32 v87, v85, -0.5, -1.0
    v_fma_f32 v86, v84, v86, -1.0
    v_mfma_f32_32x32x16_bf16 v[44:59], v[116:119], a[40:43], v[44:59]
    ds_read_b64_tr_b16 v[112:113], v165 offset:51200
    ds_read_b64_tr_b16 v[114:115], v165 offset:51712
    v_fma_f32 v87, v85, v87, -1.0
    v_rcp_f32 v86, v86
    v_rcp_f32 v87, v87
    v_mfma_f32_32x32x16_bf16 v[44:59], v[120:123], a[44:47], v[44:59]
    ds_read_b64_tr_b16 v[116:117], v165 offset:53248
    ds_read_b64_tr_b16 v[118:119], v165 offset:53760
    v_fma_f32 v86, v64, v86, v64
    v_fma_f32 v87, v65, v87, v65
    v_cvt_pk_bf16_f32 v78, v86, v87
    s_waitcnt lgkmcnt(6)
    v_mfma_f32_32x32x16_bf16 v[44:59], v[124:127], a[48:51], v[44:59]
    ds_read_b64_tr_b16 v[120:121], v165 offset:55296
    ds_read_b64_tr_b16 v[122:123], v165 offset:55808
    v_mul_f32 v88, s60, v66
    v_mul_f32 v89, s60, v67
    v_exp_f32 v88, v88
    v_mfma_f32_32x32x16_bf16 v[44:59], v[128:131], a[52:55], v[44:59]
    ds_read_b64_tr_b16 v[124:125], v165 offset:32768
    ds_read_b64_tr_b16 v[126:127], v165 offset:33280
    v_exp_f32 v89, v89
    v_fma_f32 v90, v88, -0.5, -1.0
    v_fma_f32 v91, v89, -0.5, -1.0
    v_fma_f32 v90, v88, v90, -1.0
    v_mfma_f32_32x32x16_bf16 v[44:59], v[132:135], a[56:59], v[44:59]
    ds_read_b64_tr_b16 v[128:129], v165 offset:34816
    ds_read_b64_tr_b16 v[130:131], v165 offset:35328
    v_fma_f32 v91, v89, v91, -1.0
    v_rcp_f32 v90, v90
    v_rcp_f32 v91, v91
    v_mfma_f32_32x32x16_bf16 v[44:59], v[136:139], a[60:63], v[44:59]
    ds_read_b64_tr_b16 v[132:133], v165 offset:36864
    ds_read_b64_tr_b16 v[134:135], v165 offset:37376
    v_fma_f32 v90, v66, v90, v66
    v_fma_f32 v91, v67, v91, v67
    v_cvt_pk_bf16_f32 v79, v90, v91
    s_add_u32 s69, s57, 2048
    buffer_store_dwordx4 v[76:79], v1, s[20:23], s69 offen sc0 sc1
    s_waitcnt lgkmcnt(6)
    v_mfma_f32_32x32x16_bf16 v[44:59], v[108:111], a[64:67], v[44:59]
    ds_read_b64_tr_b16 v[136:137], v165 offset:38912
    ds_read_b64_tr_b16 v[138:139], v165 offset:39424
    v_mul_f32 v84, s60, v68
    v_mul_f32 v85, s60, v69
    v_exp_f32 v84, v84
    v_mfma_f32_32x32x16_bf16 v[44:59], v[112:115], a[68:71], v[44:59]
    ds_read_b64_tr_b16 v[108:109], v166 offset:16384
    ds_read_b64_tr_b16 v[110:111], v166 offset:16896
    v_exp_f32 v85, v85
    v_fma_f32 v86, v84, -0.5, -1.0
    v_fma_f32 v87, v85, -0.5, -1.0
    v_fma_f32 v86, v84, v86, -1.0
    v_mfma_f32_32x32x16_bf16 v[44:59], v[116:119], a[72:75], v[44:59]
    ds_read_b64_tr_b16 v[112:113], v166 offset:18432
    ds_read_b64_tr_b16 v[114:115], v166 offset:18944
    v_fma_f32 v87, v85, v87, -1.0
    v_rcp_f32 v86, v86
    v_rcp_f32 v87, v87
    v_mfma_f32_32x32x16_bf16 v[44:59], v[120:123], a[76:79], v[44:59]
    ds_read_b64_tr_b16 v[116:117], v166 offset:20480
    ds_read_b64_tr_b16 v[118:119], v166 offset:20992
    v_fma_f32 v86, v68, v86, v68
    v_fma_f32 v87, v69, v87, v69
    v_cvt_pk_bf16_f32 v80, v86, v87
    s_waitcnt lgkmcnt(6)
    v_mfma_f32_32x32x16_bf16 v[44:59], v[124:127], a[80:83], v[44:59]
    ds_read_b64_tr_b16 v[120:121], v166 offset:22528
    ds_read_b64_tr_b16 v[122:123], v166 offset:23040
    v_mul_f32 v88, s60, v70
    v_mul_f32 v89, s60, v71
    v_exp_f32 v88, v88
    v_mfma_f32_32x32x16_bf16 v[44:59], v[128:131], a[84:87], v[44:59]
    ds_read_b64_tr_b16 v[124:125], v166 offset:0
    ds_read_b64_tr_b16 v[126:127], v166 offset:512
    v_exp_f32 v89, v89
    v_fma_f32 v90, v88, -0.5, -1.0
    v_fma_f32 v91, v89, -0.5, -1.0
    v_fma_f32 v90, v88, v90, -1.0
    v_mfma_f32_32x32x16_bf16 v[44:59], v[132:135], a[88:91], v[44:59]
    ds_read_b64_tr_b16 v[128:129], v166 offset:2048
    ds_read_b64_tr_b16 v[130:131], v166 offset:2560
    v_fma_f32 v91, v89, v91, -1.0
    v_rcp_f32 v90, v90
    v_rcp_f32 v91, v91
    v_mfma_f32_32x32x16_bf16 v[44:59], v[136:139], a[92:95], v[44:59]
    ds_read_b64_tr_b16 v[132:133], v166 offset:4096
    ds_read_b64_tr_b16 v[134:135], v166 offset:4608
    v_fma_f32 v90, v70, v90, v70
    v_fma_f32 v91, v71, v91, v71
    v_cvt_pk_bf16_f32 v81, v90, v91
    s_waitcnt lgkmcnt(6)
    v_mfma_f32_32x32x16_bf16 v[44:59], v[108:111], a[96:99], v[44:59]
    ds_read_b64_tr_b16 v[136:137], v166 offset:6144
    ds_read_b64_tr_b16 v[138:139], v166 offset:6656
    v_mul_f32 v84, s60, v72
    v_mul_f32 v85, s60, v73
    v_exp_f32 v84, v84
    v_mfma_f32_32x32x16_bf16 v[44:59], v[112:115], a[100:103], v[44:59]
    ds_read_b64_tr_b16 v[108:109], v167 offset:49152
    ds_read_b64_tr_b16 v[110:111], v167 offset:49664
    v_exp_f32 v85, v85
    v_fma_f32 v86, v84, -0.5, -1.0
    v_fma_f32 v87, v85, -0.5, -1.0
    v_fma_f32 v86, v84, v86, -1.0
    v_mfma_f32_32x32x16_bf16 v[44:59], v[116:119], a[104:107], v[44:59]
    ds_read_b64_tr_b16 v[112:113], v167 offset:51200
    ds_read_b64_tr_b16 v[114:115], v167 offset:51712
    v_fma_f32 v87, v85, v87, -1.0
    v_rcp_f32 v86, v86
    v_rcp_f32 v87, v87
    v_mfma_f32_32x32x16_bf16 v[44:59], v[120:123], a[108:111], v[44:59]
    ds_read_b64_tr_b16 v[116:117], v167 offset:53248
    ds_read_b64_tr_b16 v[118:119], v167 offset:53760
    v_fma_f32 v86, v72, v86, v72
    v_fma_f32 v87, v73, v87, v73
    v_cvt_pk_bf16_f32 v82, v86, v87
    s_waitcnt lgkmcnt(6)
    v_mfma_f32_32x32x16_bf16 v[44:59], v[124:127], a[112:115], v[44:59]
    ds_read_b64_tr_b16 v[120:121], v167 offset:55296
    ds_read_b64_tr_b16 v[122:123], v167 offset:55808
    v_mul_f32 v88, s60, v74
    v_mul_f32 v89, s60, v75
    v_exp_f32 v88, v88
    v_mfma_f32_32x32x16_bf16 v[44:59], v[128:131], a[116:119], v[44:59]
    ds_read_b64_tr_b16 v[124:125], v167 offset:32768
    ds_read_b64_tr_b16 v[126:127], v167 offset:33280
    v_exp_f32 v89, v89
    v_fma_f32 v90, v88, -0.5, -1.0
    v_fma_f32 v91, v89, -0.5, -1.0
    v_fma_f32 v90, v88, v90, -1.0
    v_mfma_f32_32x32x16_bf16 v[44:59], v[132:135], a[120:123], v[44:59]
    ds_read_b64_tr_b16 v[128:129], v167 offset:34816
    ds_read_b64_tr_b16 v[130:131], v167 offset:35328
    v_fma_f32 v91, v89, v91, -1.0
    v_rcp_f32 v90, v90
    v_rcp_f32 v91, v91
    v_mfma_f32_32x32x16_bf16 v[44:59], v[136:139], a[124:127], v[44:59]
    ds_read_b64_tr_b16 v[132:133], v167 offset:36864
    ds_read_b64_tr_b16 v[134:135], v167 offset:37376
    v_fma_f32 v90, v74, v90, v74
    v_fma_f32 v91, v75, v91, v75
    v_cvt_pk_bf16_f32 v83, v90, v91
    s_add_u32 s69, s57, 3072
    buffer_store_dwordx4 v[80:83], v1, s[20:23], s69 offen sc0 sc1
    s_waitcnt lgkmcnt(6)
    v_mfma_f32_32x32x16_bf16 v[60:75], v[108:111], a[0:3], 0
    ds_read_b64_tr_b16 v[136:137], v167 offset:38912
    ds_read_b64_tr_b16 v[138:139], v167 offset:39424
    v_mul_f32 v84, s60, v140
    v_mul_f32 v85, s60, v141
    v_exp_f32 v84, v84
    v_mfma_f32_32x32x16_bf16 v[60:75], v[112:115], a[4:7], v[60:75]
    ds_read_b64_tr_b16 v[108:109], v168 offset:16384
    ds_read_b64_tr_b16 v[110:111], v168 offset:16896
    v_exp_f32 v85, v85
    v_fma_f32 v86, v84, -0.5, -1.0
    v_fma_f32 v87, v85, -0.5, -1.0
    v_fma_f32 v86, v84, v86, -1.0
    v_mfma_f32_32x32x16_bf16 v[60:75], v[116:119], a[8:11], v[60:75]
    ds_read_b64_tr_b16 v[112:113], v168 offset:18432
    ds_read_b64_tr_b16 v[114:115], v168 offset:18944
    v_fma_f32 v87, v85, v87, -1.0
    v_rcp_f32 v86, v86
    v_rcp_f32 v87, v87
    v_mfma_f32_32x32x16_bf16 v[60:75], v[120:123], a[12:15], v[60:75]
    ds_read_b64_tr_b16 v[116:117], v168 offset:20480
    ds_read_b64_tr_b16 v[118:119], v168 offset:20992
    v_fma_f32 v86, v140, v86, v140
    v_fma_f32 v87, v141, v87, v141
    v_cvt_pk_bf16_f32 v76, v86, v87
    s_waitcnt lgkmcnt(6)
    v_mfma_f32_32x32x16_bf16 v[60:75], v[124:127], a[16:19], v[60:75]
    ds_read_b64_tr_b16 v[120:121], v168 offset:22528
    ds_read_b64_tr_b16 v[122:123], v168 offset:23040
    v_mul_f32 v88, s60, v142
    v_mul_f32 v89, s60, v143
    v_exp_f32 v88, v88
    v_mfma_f32_32x32x16_bf16 v[60:75], v[128:131], a[20:23], v[60:75]
    ds_read_b64_tr_b16 v[124:125], v168 offset:0
    ds_read_b64_tr_b16 v[126:127], v168 offset:512
    v_exp_f32 v89, v89
    v_fma_f32 v90, v88, -0.5, -1.0
    v_fma_f32 v91, v89, -0.5, -1.0
    v_fma_f32 v90, v88, v90, -1.0
    v_mfma_f32_32x32x16_bf16 v[60:75], v[132:135], a[24:27], v[60:75]
    ds_read_b64_tr_b16 v[128:129], v168 offset:2048
    ds_read_b64_tr_b16 v[130:131], v168 offset:2560
    v_fma_f32 v91, v89, v91, -1.0
    v_rcp_f32 v90, v90
    v_rcp_f32 v91, v91
    v_mfma_f32_32x32x16_bf16 v[60:75], v[136:139], a[28:31], v[60:75]
    ds_read_b64_tr_b16 v[132:133], v168 offset:4096
    ds_read_b64_tr_b16 v[134:135], v168 offset:4608
    v_fma_f32 v90, v142, v90, v142
    v_fma_f32 v91, v143, v91, v143
    v_cvt_pk_bf16_f32 v77, v90, v91
    s_waitcnt lgkmcnt(6)
    v_mfma_f32_32x32x16_bf16 v[60:75], v[108:111], a[32:35], v[60:75]
    ds_read_b64_tr_b16 v[136:137], v168 offset:6144
    ds_read_b64_tr_b16 v[138:139], v168 offset:6656
    v_mul_f32 v84, s60, v144
    v_mul_f32 v85, s60, v145
    v_exp_f32 v84, v84
    v_mfma_f32_32x32x16_bf16 v[60:75], v[112:115], a[36:39], v[60:75]
    ds_read_b64_tr_b16 v[108:109], v168 offset:49152
    ds_read_b64_tr_b16 v[110:111], v168 offset:49664
    v_exp_f32 v85, v85
    v_fma_f32 v86, v84, -0.5, -1.0
    v_fma_f32 v87, v85, -0.5, -1.0
    v_fma_f32 v86, v84, v86, -1.0
    v_mul_f32 v44, s62, v44
    v_mul_f32 v45, s62, v45
    v_mfma_f32_32x32x16_bf16 v[60:75], v[116:119], a[40:43], v[60:75]
    ds_read_b64_tr_b16 v[112:113], v168 offset:51200
    ds_read_b64_tr_b16 v[114:115], v168 offset:51712
    v_fma_f32 v87, v85, v87, -1.0
    v_rcp_f32 v86, v86
    v_rcp_f32 v87, v87
    v_cvt_pk_bf16_f32 v156, v44, v45
    v_mfma_f32_32x32x16_bf16 v[60:75], v[120:123], a[44:47], v[60:75]
    ds_read_b64_tr_b16 v[116:117], v168 offset:53248
    ds_read_b64_tr_b16 v[118:119], v168 offset:53760
    v_fma_f32 v86, v144, v86, v144
    v_fma_f32 v87, v145, v87, v145
    v_cvt_pk_bf16_f32 v78, v86, v87
    v_mul_f32 v46, s62, v46
    v_mul_f32 v47, s62, v47
    s_waitcnt lgkmcnt(6)
    v_mfma_f32_32x32x16_bf16 v[60:75], v[124:127], a[48:51], v[60:75]
    ds_read_b64_tr_b16 v[120:121], v168 offset:55296
    ds_read_b64_tr_b16 v[122:123], v168 offset:55808
    v_mul_f32 v88, s60, v146
    v_mul_f32 v89, s60, v147
    v_exp_f32 v88, v88
    v_cvt_pk_bf16_f32 v157, v46, v47
    v_mfma_f32_32x32x16_bf16 v[60:75], v[128:131], a[52:55], v[60:75]
    ds_read_b64_tr_b16 v[124:125], v168 offset:32768
    ds_read_b64_tr_b16 v[126:127], v168 offset:33280
    v_exp_f32 v89, v89
    v_fma_f32 v90, v88, -0.5, -1.0
    v_fma_f32 v91, v89, -0.5, -1.0
    v_fma_f32 v90, v88, v90, -1.0
    v_mul_f32 v48, s62, v48
    v_mul_f32 v49, s62, v49
    v_mfma_f32_32x32x16_bf16 v[60:75], v[132:135], a[56:59], v[60:75]
    ds_read_b64_tr_b16 v[128:129], v168 offset:34816
    ds_read_b64_tr_b16 v[130:131], v168 offset:35328
    v_fma_f32 v91, v89, v91, -1.0
    v_rcp_f32 v90, v90
    v_rcp_f32 v91, v91
    v_cvt_pk_bf16_f32 v158, v48, v49
    v_mfma_f32_32x32x16_bf16 v[60:75], v[136:139], a[60:63], v[60:75]
    ds_read_b64_tr_b16 v[132:133], v168 offset:36864
    ds_read_b64_tr_b16 v[134:135], v168 offset:37376
    v_fma_f32 v90, v146, v90, v146
    v_fma_f32 v91, v147, v91, v147
    v_cvt_pk_bf16_f32 v79, v90, v91
    s_add_u32 s69, s75, 0
    buffer_store_dwordx4 v[76:79], v1, s[20:23], s69 offen sc0 sc1
    v_mul_f32 v50, s62, v50
    v_mul_f32 v51, s62, v51
    s_waitcnt lgkmcnt(6)
    v_mfma_f32_32x32x16_bf16 v[60:75], v[108:111], a[64:67], v[60:75]
    ds_read_b64_tr_b16 v[136:137], v168 offset:38912
    ds_read_b64_tr_b16 v[138:139], v168 offset:39424
    v_mul_f32 v84, s60, v148
    v_mul_f32 v85, s60, v149
    v_exp_f32 v84, v84
    v_cvt_pk_bf16_f32 v159, v50, v51
    buffer_store_dwordx4 v[156:159], v1, s[20:23], s58 offen offset:0 sc0 sc1
    v_mfma_f32_32x32x16_bf16 v[60:75], v[112:115], a[68:71], v[60:75]
    ds_read_b64_tr_b16 v[108:109], v169 offset:16384
    ds_read_b64_tr_b16 v[110:111], v169 offset:16896
    v_exp_f32 v85, v85
    v_fma_f32 v86, v84, -0.5, -1.0
    v_fma_f32 v87, v85, -0.5, -1.0
    v_fma_f32 v86, v84, v86, -1.0
    v_mul_f32 v52, s62, v52
    v_mul_f32 v53, s62, v53
    v_mfma_f32_32x32x16_bf16 v[60:75], v[116:119], a[72:75], v[60:75]
    ds_read_b64_tr_b16 v[112:113], v169 offset:18432
    ds_read_b64_tr_b16 v[114:115], v169 offset:18944
    v_fma_f32 v87, v85, v87, -1.0
    v_rcp_f32 v86, v86
    v_rcp_f32 v87, v87
    v_cvt_pk_bf16_f32 v160, v52, v53
    v_mfma_f32_32x32x16_bf16 v[60:75], v[120:123], a[76:79], v[60:75]
    ds_read_b64_tr_b16 v[116:117], v169 offset:20480
    ds_read_b64_tr_b16 v[118:119], v169 offset:20992
    v_fma_f32 v86, v148, v86, v148
    v_fma_f32 v87, v149, v87, v149
    v_cvt_pk_bf16_f32 v80, v86, v87
    v_mul_f32 v54, s62, v54
    v_mul_f32 v55, s62, v55
    s_waitcnt lgkmcnt(6)
    v_mfma_f32_32x32x16_bf16 v[60:75], v[124:127], a[80:83], v[60:75]
    ds_read_b64_tr_b16 v[120:121], v169 offset:22528
    ds_read_b64_tr_b16 v[122:123], v169 offset:23040
    v_mul_f32 v88, s60, v150
    v_mul_f32 v89, s60, v151
    v_exp_f32 v88, v88
    v_cvt_pk_bf16_f32 v161, v54, v55
    v_mfma_f32_32x32x16_bf16 v[60:75], v[128:131], a[84:87], v[60:75]
    ds_read_b64_tr_b16 v[124:125], v169 offset:0
    ds_read_b64_tr_b16 v[126:127], v169 offset:512
    v_exp_f32 v89, v89
    v_fma_f32 v90, v88, -0.5, -1.0
    v_fma_f32 v91, v89, -0.5, -1.0
    v_fma_f32 v90, v88, v90, -1.0
    v_mul_f32 v56, s62, v56
    v_mul_f32 v57, s62, v57
    v_mfma_f32_32x32x16_bf16 v[60:75], v[132:135], a[88:91], v[60:75]
    ds_read_b64_tr_b16 v[128:129], v169 offset:2048
    ds_read_b64_tr_b16 v[130:131], v169 offset:2560
    v_fma_f32 v91, v89, v91, -1.0
    v_rcp_f32 v90, v90
    v_rcp_f32 v91, v91
    v_cvt_pk_bf16_f32 v162, v56, v57
    v_mfma_f32_32x32x16_bf16 v[60:75], v[136:139], a[92:95], v[60:75]
    ds_read_b64_tr_b16 v[132:133], v169 offset:4096
    ds_read_b64_tr_b16 v[134:135], v169 offset:4608
    v_fma_f32 v90, v150, v90, v150
    v_fma_f32 v91, v151, v91, v151
    v_cvt_pk_bf16_f32 v81, v90, v91
    v_mul_f32 v58, s62, v58
    v_mul_f32 v59, s62, v59
    s_waitcnt lgkmcnt(6)
    v_mfma_f32_32x32x16_bf16 v[60:75], v[108:111], a[96:99], v[60:75]
    ds_read_b64_tr_b16 v[136:137], v169 offset:6144
    ds_read_b64_tr_b16 v[138:139], v169 offset:6656
    v_mul_f32 v84, s60, v152
    v_mul_f32 v85, s60, v153
    v_exp_f32 v84, v84
    v_cvt_pk_bf16_f32 v163, v58, v59
    buffer_store_dwordx4 v[160:163], v1, s[20:23], s58 offen offset:1024 sc0 sc1
    v_mfma_f32_32x32x16_bf16 v[60:75], v[112:115], a[100:103], v[60:75]
    v_exp_f32 v85, v85
    v_fma_f32 v86, v84, -0.5, -1.0
    v_fma_f32 v87, v85, -0.5, -1.0
    v_fma_f32 v86, v84, v86, -1.0
    v_mfma_f32_32x32x16_bf16 v[60:75], v[116:119], a[104:107], v[60:75]
    v_fma_f32 v87, v85, v87, -1.0
    v_rcp_f32 v86, v86
    v_rcp_f32 v87, v87
    v_mfma_f32_32x32x16_bf16 v[60:75], v[120:123], a[108:111], v[60:75]
    v_fma_f32 v86, v152, v86, v152
    v_fma_f32 v87, v153, v87, v153
    v_cvt_pk_bf16_f32 v82, v86, v87
    s_waitcnt lgkmcnt(0)
    v_mfma_f32_32x32x16_bf16 v[60:75], v[124:127], a[112:115], v[60:75]
    v_mul_f32 v88, s60, v154
    v_mul_f32 v89, s60, v155
    v_exp_f32 v88, v88
    v_mfma_f32_32x32x16_bf16 v[60:75], v[128:131], a[116:119], v[60:75]
    v_exp_f32 v89, v89
    v_fma_f32 v90, v88, -0.5, -1.0
    v_fma_f32 v91, v89, -0.5, -1.0
    v_fma_f32 v90, v88, v90, -1.0
    v_mfma_f32_32x32x16_bf16 v[60:75], v[132:135], a[120:123], v[60:75]
    v_fma_f32 v91, v89, v91, -1.0
    v_rcp_f32 v90, v90
    v_rcp_f32 v91, v91
    v_mfma_f32_32x32x16_bf16 v[60:75], v[136:139], a[124:127], v[60:75]
    v_fma_f32 v90, v154, v90, v154
    v_fma_f32 v91, v155, v91, v155
    v_cvt_pk_bf16_f32 v83, v90, v91
    s_add_u32 s69, s75, 1024
    buffer_store_dwordx4 v[80:83], v1, s[20:23], s69 offen sc0 sc1
    s_nop 6
    v_mul_f32 v60, s62, v60
    v_mul_f32 v61, s62, v61
    v_cvt_pk_bf16_f32 v76, v60, v61
    v_mul_f32 v62, s62, v62
    v_mul_f32 v63, s62, v63
    v_cvt_pk_bf16_f32 v77, v62, v63
    v_mul_f32 v64, s62, v64
    v_mul_f32 v65, s62, v65
    v_cvt_pk_bf16_f32 v78, v64, v65
    v_mul_f32 v66, s62, v66
    v_mul_f32 v67, s62, v67
    v_cvt_pk_bf16_f32 v79, v66, v67
    buffer_store_dwordx4 v[76:79], v1, s[20:23], s58 offen offset:2048 sc0 sc1
    v_mul_f32 v68, s62, v68
    v_mul_f32 v69, s62, v69
    v_cvt_pk_bf16_f32 v80, v68, v69
    v_mul_f32 v70, s62, v70
    v_mul_f32 v71, s62, v71
    v_cvt_pk_bf16_f32 v81, v70, v71
    v_mul_f32 v72, s62, v72
    v_mul_f32 v73, s62, v73
    v_cvt_pk_bf16_f32 v82, v72, v73
    v_mul_f32 v74, s62, v74
    v_mul_f32 v75, s62, v75
    v_cvt_pk_bf16_f32 v83, v74, v75
    buffer_store_dwordx4 v[80:83], v1, s[20:23], s58 offen offset:3072 sc0 sc1
    s_endpgm
K1_B:
    s_cmp_eq_u32 s47, 8
    s_cbranch_scc1 K1_BK
    s_cmp_eq_u32 s47, 9
    s_cbranch_scc1 K1_BV
    s_cmp_eq_u32 s47, 10
    s_cbranch_scc1 K1_BG
    s_sub_u32 s48, s47, 8
    s_lshl_b32 s55, s48, 8
    s_add_u32 s73, s55, 128
    s_mov_b32 m0, s46
    s_nop 0
    buffer_load_dwordx4 v2, s[8:11], s50 offen lds
    s_add_u32 m0, s46, 1024
    s_nop 0
    buffer_load_dwordx4 v3, s[8:11], s51 offen lds
    s_add_u32 m0, s46, 2048
    s_nop 0
    buffer_load_dwordx4 v2, s[8:11], s52 offen lds
    s_add_u32 m0, s46, 3072
    s_nop 0
    buffer_load_dwordx4 v3, s[8:11], s53 offen lds
    s_add_u32 m0, s46, 3968
    s_nop 0
    buffer_load_dwordx4 v2, s[8:11], s50 offen offset:128 lds
    s_add_u32 m0, s46, 4992
    s_nop 0
    buffer_load_dwordx4 v3, s[8:11], s51 offen offset:128 lds
    s_add_u32 m0, s46, 6016
    s_nop 0
    buffer_load_dwordx4 v2, s[8:11], s52 offen offset:128 lds
    s_add_u32 m0, s46, 7040
    s_nop 0
    buffer_load_dwordx4 v3, s[8:11], s53 offen offset:128 lds
    s_add_u32 s54, s55, s59
    s_mov_b32 m0, s82
    s_nop 0
    buffer_load_dwordx4 v170, s[12:15], s54 offen lds
    s_add_u32 s54, s54, 28672
    s_add_u32 m0, s82, 1024
    s_nop 0
    buffer_load_dwordx4 v170, s[12:15], s54 offen lds
    s_add_u32 s54, s54, 28672
    s_add_u32 m0, s82, 2048
    s_nop 0
    buffer_load_dwordx4 v170, s[12:15], s54 offen lds
    s_add_u32 s54, s54, 28672
    s_add_u32 m0, s82, 3072
    s_nop 0
    buffer_load_dwordx4 v170, s[12:15], s54 offen lds
    buffer_load_ushort v16, v13, s[24:27], s55 offen
    buffer_load_ushort v17, v13, s[24:27], s55 offen offset:64
    buffer_load_ushort v18, v13, s[24:27], s73 offen
    buffer_load_ushort v19, v13, s[24:27], s73 offen offset:64
    s_add_u32 m0, s46, 7936
    s_nop 0
    buffer_load_dwordx4 v2, s[8:11], s50 offen offset:256 lds
    s_add_u32 m0, s46, 8960
    s_nop 0
    buffer_load_dwordx4 v3, s[8:11], s51 offen offset:256 lds
    s_add_u32 m0, s46, 9984
    s_nop 0
    buffer_load_dwordx4 v2, s[8:11], s52 offen offset:256 lds
    s_add_u32 m0, s46, 11008
    s_nop 0
    buffer_load_dwordx4 v3, s[8:11], s53 offen offset:256 lds
    s_add_u32 m0, s46, 11904
    s_nop 0
    buffer_load_dwordx4 v2, s[8:11], s50 offen offset:384 lds
    s_add_u32 m0, s46, 12928
    s_nop 0
    buffer_load_dwordx4 v3, s[8:11], s51 offen offset:384 lds
    s_add_u32 m0, s46, 13952
    s_nop 0
    buffer_load_dwordx4 v2, s[8:11], s52 offen offset:384 lds
    s_add_u32 m0, s46, 14976
    s_nop 0
    buffer_load_dwordx4 v3, s[8:11], s53 offen offset:384 lds
    s_add_u32 s54, s55, s59
    s_add_u32 s54, s54, 458752
    s_add_u32 m0, s82, 16384
    s_nop 0
    buffer_load_dwordx4 v170, s[12:15], s54 offen lds
    s_add_u32 s54, s54, 28672
    s_add_u32 m0, s82, 17408
    s_nop 0
    buffer_load_dwordx4 v170, s[12:15], s54 offen lds
    s_add_u32 s54, s54, 28672
    s_add_u32 m0, s82, 18432
    s_nop 0
    buffer_load_dwordx4 v170, s[12:15], s54 offen lds
    s_add_u32 s54, s54, 28672
    s_add_u32 m0, s82, 19456
    s_nop 0
    buffer_load_dwordx4 v170, s[12:15], s54 offen lds
    s_mul_i32 s57, s45, 114688
    s_add_u32 s57, s57, 4718592
    s_lshl_b32 s48, s73, 5
    s_add_u32 s75, s57, s48
    s_lshl_b32 s48, s55, 5
    s_add_u32 s57, s57, s48
    s_waitcnt vmcnt(12)
    s_barrier
    ds_read_b128 a[0:3], v6 offset:0
    ds_read_b128 a[4:7], v7 offset:0
    ds_read_b128 a[8:11], v8 offset:0
    ds_read_b128 a[12:15], v9 offset:0
    ds_read_b128 a[16:19], v6 offset:4096
    ds_read_b128 a[20:23], v7 offset:4096
    ds_read_b128 a[24:27], v8 offset:4096
    ds_read_b128 a[28:31], v9 offset:4096
    ds_read_b64_tr_b16 v[108:109], v164 offset:0
    ds_read_b64_tr_b16 v[110:111], v164 offset:512
    ds_read_b64_tr_b16 v[112:113], v167 offset:0
    ds_read_b64_tr_b16 v[114:115], v167 offset:512
    ds_read_b64_tr_b16 v[116:117], v164 offset:2048
    ds_read_b64_tr_b16 v[118:119], v164 offset:2560
    ds_read_b64_tr_b16 v[120:121], v167 offset:2048
    ds_read_b64_tr_b16 v[122:123], v167 offset:2560
    ds_read_b64_tr_b16 v[124:125], v164 offset:4096
    ds_read_b64_tr_b16 v[126:127], v164 offset:4608
    ds_read_b64_tr_b16 v[128:129], v167 offset:4096
    ds_read_b64_tr_b16 v[130:131], v167 offset:4608
    ds_read_b64_tr_b16 v[132:133], v164 offset:6144
    ds_read_b64_tr_b16 v[134:135], v164 offset:6656
    v_mov_b32 v20, v16
    s_nop 1
    v_mfma_f32_32x32x16_bf16 v[44:59], v[20:23], v[24:27], 0
    s_waitcnt lgkmcnt(6)
    v_mfma_f32_32x32x16_bf16 v[44:59], v[108:111], a[0:3], v[44:59]
    ds_read_b64_tr_b16 v[136:137], v167 offset:6144
    ds_read_b64_tr_b16 v[138:139], v167 offset:6656
    s_add_u32 m0, s46, 15872
    s_nop 0
    buffer_load_dwordx4 v2, s[8:11], s50 offen offset:512 lds
    s_add_u32 m0, s46, 16896
    s_nop 0
    buffer_load_dwordx4 v3, s[8:11], s51 offen offset:512 lds
    v_mov_b32 v20, v17
    s_nop 1
    v_mfma_f32_32x32x16_bf16 v[60:75], v[20:23], v[24:27], 0
    v_mfma_f32_32x32x16_bf16 v[60:75], v[112:115], a[0:3], v[60:75]
    ds_read_b64_tr_b16 v[108:109], v164 offset:8192
    ds_read_b64_tr_b16 v[110:111], v164 offset:8704
    s_add_u32 m0, s46, 17920
    s_nop 0
    buffer_load_dwordx4 v2, s[8:11], s52 offen offset:512 lds
    s_add_u32 m0, s46, 18944
    s_nop 0
    buffer_load_dwordx4 v3, s[8:11], s53 offen offset:512 lds
    v_mfma_f32_32x32x16_bf16 v[44:59], v[116:119], a[4:7], v[44:59]
    ds_read_b64_tr_b16 v[112:113], v167 offset:8192
    ds_read_b64_tr_b16 v[114:115], v167 offset:8704
    s_add_u32 m0, s46, 19840
    s_nop 0
    buffer_load_dwordx4 v2, s[8:11], s50 offen offset:640 lds
    s_add_u32 m0, s46, 20864
    s_nop 0
    buffer_load_dwordx4 v3, s[8:11], s51 offen offset:640 lds
    s_add_u32 s64, s70, 0
    s_lshr_b32 s48, s64, 4
    s_cmp_ge_u32 s48, 112
    s_cselect_b32 s40, s36, s32
    s_cselect_b32 s41, s37, s33
    s_cselect_b32 s42, s38, s34
    s_mov_b32 s43, 0x00020000
    s_cselect_b32 s49, 112, 0
    s_sub_u32 s48, s48, s49
    s_lshl_b32 s48, s48, 14
    s_and_b32 s49, s64, 15
    s_lshl_b32 s49, s49, 6
    s_add_u32 s65, s48, s49
    s_add_u32 s66, s65, 8192
    s_lshl_b32 s67, s64, 10
    s_add_u32 s67, s67, 2359296
    v_mfma_f32_32x32x16_bf16 v[60:75], v[120:123], a[4:7], v[60:75]
    ds_read_b64_tr_b16 v[116:117], v164 offset:10240
    ds_read_b64_tr_b16 v[118:119], v164 offset:10752
    s_add_u32 m0, s46, 21888
    s_nop 0
    buffer_load_dwordx4 v2, s[8:11], s52 offen offset:640 lds
    s_add_u32 m0, s46, 22912
    s_nop 0
    buffer_load_dwordx4 v3, s[8:11], s53 offen offset:640 lds
    buffer_load_ushort v92, v14, s[40:43], s65 offen
    s_waitcnt lgkmcnt(6)
    v_mfma_f32_32x32x16_bf16 v[44:59], v[124:127], a[8:11], v[44:59]
    ds_read_b64_tr_b16 v[120:121], v167 offset:10240
    ds_read_b64_tr_b16 v[122:123], v167 offset:10752
    s_add_u32 s54, s55, s59
    s_add_u32 s54, s54, 917504
    s_add_u32 m0, s46, 24576
    s_nop 0
    buffer_load_dwordx4 v170, s[12:15], s54 offen lds
    s_add_u32 s54, s54, 28672
    s_add_u32 m0, s46, 25600
    s_nop 0
    buffer_load_dwordx4 v170, s[12:15], s54 offen lds
    buffer_load_ushort v93, v14, s[40:43], s65 offen offset:1024
    v_mfma_f32_32x32x16_bf16 v[60:75], v[128:131], a[8:11], v[60:75]
    ds_read_b64_tr_b16 v[124:125], v164 offset:12288
    ds_read_b64_tr_b16 v[126:127], v164 offset:12800
    s_add_u32 s54, s54, 28672
    s_add_u32 m0, s46, 26624
    s_nop 0
    buffer_load_dwordx4 v170, s[12:15], s54 offen lds
    s_add_u32 s54, s54, 28672
    s_add_u32 m0, s46, 27648
    s_nop 0
    buffer_load_dwordx4 v170, s[12:15], s54 offen lds
    buffer_load_ushort v94, v14, s[40:43], s65 offen offset:2048
    v_mfma_f32_32x32x16_bf16 v[44:59], v[132:135], a[12:15], v[44:59]
    ds_read_b64_tr_b16 v[128:129], v167 offset:12288
    ds_read_b64_tr_b16 v[130:131], v167 offset:12800
    s_sub_u32 m0, s46, 768
    s_nop 0
    buffer_load_dwordx4 v2, s[8:11], s50 offen offset:768 lds
    s_add_u32 m0, s46, 256
    s_nop 0
    buffer_load_dwordx4 v3, s[8:11], s51 offen offset:768 lds
    buffer_load_ushort v95, v14, s[40:43], s65 offen offset:3072
    v_mfma_f32_32x32x16_bf16 v[60:75], v[136:139], a[12:15], v[60:75]
    ds_read_b64_tr_b16 v[132:133], v164 offset:14336
    ds_read_b64_tr_b16 v[134:135], v164 offset:14848
    s_add_u32 m0, s46, 1280
    s_nop 0
    buffer_load_dwordx4 v2, s[8:11], s52 offen offset:768 lds
    s_add_u32 m0, s46, 2304
    s_nop 0
    buffer_load_dwordx4 v3, s[8:11], s53 offen offset:768 lds
    buffer_load_ushort v96, v14, s[40:43], s66 offen
    s_waitcnt lgkmcnt(6)
    v_mfma_f32_32x32x16_bf16 v[44:59], v[108:111], a[16:19], v[44:59]
    ds_read_b64_tr_b16 v[136:137], v167 offset:14336
    ds_read_b64_tr_b16 v[138:139], v167 offset:14848
    s_add_u32 m0, s46, 3200
    s_nop 0
    buffer_load_dwordx4 v2, s[8:11], s50 offen offset:896 lds
    s_add_u32 m0, s46, 4224
    s_nop 0
    buffer_load_dwordx4 v3, s[8:11], s51 offen offset:896 lds
    buffer_load_ushort v97, v14, s[40:43], s66 offen offset:1024
    s_waitcnt vmcnt(24)
    s_barrier
    ds_read_b128 a[32:35], v6 offset:8192
    ds_read_b128 a[36:39], v7 offset:8192
    ds_read_b128 a[40:43], v8 offset:8192
    ds_read_b128 a[44:47], v9 offset:8192
    ds_read_b128 a[48:51], v6 offset:12288
    ds_read_b128 a[52:55], v7 offset:12288
    ds_read_b128 a[56:59], v8 offset:12288
    ds_read_b128 a[60:63], v9 offset:12288
    v_mfma_f32_32x32x16_bf16 v[60:75], v[112:115], a[16:19], v[60:75]
    ds_read_b64_tr_b16 v[108:109], v164 offset:16384
    ds_read_b64_tr_b16 v[110:111], v164 offset:16896
    s_add_u32 m0, s46, 5248
    s_nop 0
    buffer_load_dwordx4 v2, s[8:11], s52 offen offset:896 lds
    s_add_u32 m0, s46, 6272
    s_nop 0
    buffer_load_dwordx4 v3, s[8:11], s53 offen offset:896 lds
    buffer_load_ushort v98, v14, s[40:43], s66 offen offset:2048
    v_mfma_f32_32x32x16_bf16 v[44:59], v[116:119], a[20:23], v[44:59]
    ds_read_b64_tr_b16 v[112:113], v167 offset:16384
    ds_read_b64_tr_b16 v[114:115], v167 offset:16896
    s_add_u32 s54, s55, s59
    s_add_u32 s54, s54, 1376256
    s_add_u32 m0, s46, 28672
    s_nop 0
    buffer_load_dwordx4 v170, s[12:15], s54 offen lds
    s_add_u32 s54, s54, 28672
    s_add_u32 m0, s46, 29696
    s_nop 0
    buffer_load_dwordx4 v170, s[12:15], s54 offen lds
    buffer_load_ushort v99, v14, s[40:43], s66 offen offset:3072
    v_mfma_f32_32x32x16_bf16 v[60:75], v[120:123], a[20:23], v[60:75]
    ds_read_b64_tr_b16 v[116:117], v164 offset:18432
    ds_read_b64_tr_b16 v[118:119], v164 offset:18944
    s_add_u32 s54, s54, 28672
    s_add_u32 m0, s46, 30720
    s_nop 0
    buffer_load_dwordx4 v170, s[12:15], s54 offen lds
    s_add_u32 s54, s54, 28672
    s_add_u32 m0, s46, 31744
    s_nop 0
    buffer_load_dwordx4 v170, s[12:15], s54 offen lds
    s_waitcnt lgkmcnt(14)
    v_mfma_f32_32x32x16_bf16 v[44:59], v[124:127], a[24:27], v[44:59]
    ds_read_b64_tr_b16 v[120:121], v167 offset:18432
    ds_read_b64_tr_b16 v[122:123], v167 offset:18944
    v_mfma_f32_32x32x16_bf16 v[60:75], v[128:131], a[24:27], v[60:75]
    ds_read_b64_tr_b16 v[124:125], v164 offset:20480
    ds_read_b64_tr_b16 v[126:127], v164 offset:20992
    v_mfma_f32_32x32x16_bf16 v[44:59], v[132:135], a[28:31], v[44:59]
    ds_read_b64_tr_b16 v[128:129], v167 offset:20480
    ds_read_b64_tr_b16 v[130:131], v167 offset:20992
    v_mfma_f32_32x32x16_bf16 v[60:75], v[136:139], a[28:31], v[60:75]
    ds_read_b64_tr_b16 v[132:133], v164 offset:22528
    ds_read_b64_tr_b16 v[134:135], v164 offset:23040
    s_waitcnt lgkmcnt(6)
    v_mfma_f32_32x32x16_bf16 v[44:59], v[108:111], a[32:35], v[44:59]
    ds_read_b64_tr_b16 v[136:137], v167 offset:22528
    ds_read_b64_tr_b16 v[138:139], v167 offset:23040
    s_add_u32 s54, s73, s71
    s_add_u32 m0, s46, 8192
    s_nop 0
    buffer_load_dwordx4 v170, s[12:15], s54 offen lds
    s_add_u32 s54, s54, 28672
    s_add_u32 m0, s46, 9216
    s_nop 0
    buffer_load_dwordx4 v170, s[12:15], s54 offen lds
    v_mfma_f32_32x32x16_bf16 v[60:75], v[112:115], a[32:35], v[60:75]
    ds_read_b64_tr_b16 v[108:109], v164 offset:24576
    ds_read_b64_tr_b16 v[110:111], v164 offset:25088
    s_add_u32 s54, s54, 28672
    s_add_u32 m0, s46, 10240
    s_nop 0
    buffer_load_dwordx4 v170, s[12:15], s54 offen lds
    s_add_u32 s54, s54, 28672
    s_add_u32 m0, s46, 11264
    s_nop 0
    buffer_load_dwordx4 v170, s[12:15], s54 offen lds
    v_mfma_f32_32x32x16_bf16 v[44:59], v[116:119], a[36:39], v[44:59]
    ds_read_b64_tr_b16 v[112:113], v167 offset:24576
    ds_read_b64_tr_b16 v[114:115], v167 offset:25088
    s_add_u32 s54, s54, 28672
    s_add_u32 m0, s46, 12288
    s_nop 0
    buffer_load_dwordx4 v170, s[12:15], s54 offen lds
    s_add_u32 s54, s54, 28672
    s_add_u32 m0, s46, 13312
    s_nop 0
    buffer_load_dwordx4 v170, s[12:15], s54 offen lds
    v_mfma_f32_32x32x16_bf16 v[60:75], v[120:123], a[36:39], v[60:75]
    ds_read_b64_tr_b16 v[116:117], v164 offset:26624
    ds_read_b64_tr_b16 v[118:119], v164 offset:27136
    s_add_u32 s54, s54, 28672
    s_add_u32 m0, s46, 14336
    s_nop 0
    buffer_load_dwordx4 v170, s[12:15], s54 offen lds
    s_add_u32 s54, s54, 28672
    s_add_u32 m0, s46, 15360
    s_nop 0
    buffer_load_dwordx4 v170, s[12:15], s54 offen lds
    s_waitcnt lgkmcnt(6)
    v_mfma_f32_32x32x16_bf16 v[44:59], v[124:127], a[40:43], v[44:59]
    ds_read_b64_tr_b16 v[120:121], v167 offset:26624
    ds_read_b64_tr_b16 v[122:123], v167 offset:27136
    v_mfma_f32_32x32x16_bf16 v[60:75], v[128:131], a[40:43], v[60:75]
    ds_read_b64_tr_b16 v[124:125], v164 offset:28672
    ds_read_b64_tr_b16 v[126:127], v164 offset:29184
    v_mfma_f32_32x32x16_bf16 v[44:59], v[132:135], a[44:47], v[44:59]
    ds_read_b64_tr_b16 v[128:129], v167 offset:28672
    ds_read_b64_tr_b16 v[130:131], v167 offset:29184
    s_waitcnt vmcnt(10)
    v_lshl_or_b32 v100, v93, 16, v92
    v_lshl_or_b32 v101, v95, 16, v94
    v_lshl_or_b32 v102, v97, 16, v96
    v_lshl_or_b32 v103, v99, 16, v98
    buffer_store_dwordx4 v[100:103], v1, s[20:23], s67 offen sc0 sc1
    s_add_u32 s64, s70, 1024
    s_lshr_b32 s48, s64, 4
    s_cmp_ge_u32 s48, 112
    s_cselect_b32 s40, s36, s32
    s_cselect_b32 s41, s37, s33
    s_cselect_b32 s42, s38, s34
    s_mov_b32 s43, 0x00020000
    s_cselect_b32 s49, 112, 0
    s_sub_u32 s48, s48, s49
    s_lshl_b32 s48, s48, 14
    s_and_b32 s49, s64, 15
    s_lshl_b32 s49, s49, 6
    s_add_u32 s65, s48, s49
    s_add_u32 s66, s65, 8192
    s_lshl_b32 s67, s64, 10
    s_add_u32 s67, s67, 2359296
    v_mfma_f32_32x32x16_bf16 v[60:75], v[136:139], a[44:47], v[60:75]
    ds_read_b64_tr_b16 v[132:133], v164 offset:30720
    ds_read_b64_tr_b16 v[134:135], v164 offset:31232
    buffer_load_ushort v92, v14, s[40:43], s65 offen
    s_waitcnt lgkmcnt(6)
    v_mfma_f32_32x32x16_bf16 v[44:59], v[108:111], a[48:51], v[44:59]
    ds_read_b64_tr_b16 v[136:137], v167 offset:30720
    ds_read_b64_tr_b16 v[138:139], v167 offset:31232
    buffer_load_ushort v93, v14, s[40:43], s65 offen offset:1024
    s_barrier
    ds_read_b128 a[64:67], v6 offset:16384
    ds_read_b128 a[68:71], v7 offset:16384
    ds_read_b128 a[72:75], v8 offset:16384
    ds_read_b128 a[76:79], v9 offset:16384
    ds_read_b128 a[80:83], v6 offset:20480
    ds_read_b128 a[84:87], v7 offset:20480
    ds_read_b128 a[88:91], v8 offset:20480
    ds_read_b128 a[92:95], v9 offset:20480
    v_mfma_f32_32x32x16_bf16 v[60:75], v[112:115], a[48:51], v[60:75]
    ds_read_b64_tr_b16 v[108:109], v164 offset:57344
    ds_read_b64_tr_b16 v[110:111], v164 offset:57856
    buffer_load_ushort v94, v14, s[40:43], s65 offen offset:2048
    v_mfma_f32_32x32x16_bf16 v[44:59], v[116:119], a[52:55], v[44:59]
    ds_read_b64_tr_b16 v[112:113], v167 offset:57344
    ds_read_b64_tr_b16 v[114:115], v167 offset:57856
    buffer_load_ushort v95, v14, s[40:43], s65 offen offset:3072
    v_mfma_f32_32x32x16_bf16 v[60:75], v[120:123], a[52:55], v[60:75]
    ds_read_b64_tr_b16 v[116:117], v164 offset:59392
    ds_read_b64_tr_b16 v[118:119], v164 offset:59904
    buffer_load_ushort v96, v14, s[40:43], s66 offen
    s_waitcnt lgkmcnt(14)
    v_mfma_f32_32x32x16_bf16 v[44:59], v[124:127], a[56:59], v[44:59]
    ds_read_b64_tr_b16 v[120:121], v167 offset:59392
    ds_read_b64_tr_b16 v[122:123], v167 offset:59904
    buffer_load_ushort v97, v14, s[40:43], s66 offen offset:1024
    v_mfma_f32_32x32x16_bf16 v[60:75], v[128:131], a[56:59], v[60:75]
    ds_read_b64_tr_b16 v[124:125], v165 offset:24576
    ds_read_b64_tr_b16 v[126:127], v165 offset:25088
    buffer_load_ushort v98, v14, s[40:43], s66 offen offset:2048
    v_mfma_f32_32x32x16_bf16 v[44:59], v[132:135], a[60:63], v[44:59]
    ds_read_b64_tr_b16 v[128:129], v168 offset:24576
    ds_read_b64_tr_b16 v[130:131], v168 offset:25088
    buffer_load_ushort v99, v14, s[40:43], s66 offen offset:3072
    v_mfma_f32_32x32x16_bf16 v[60:75], v[136:139], a[60:63], v[60:75]
    ds_read_b64_tr_b16 v[132:133], v165 offset:26624
    ds_read_b64_tr_b16 v[134:135], v165 offset:27136
    s_waitcnt lgkmcnt(6)
    v_mfma_f32_32x32x16_bf16 v[44:59], v[108:111], a[64:67], v[44:59]
    ds_read_b64_tr_b16 v[136:137], v168 offset:26624
    ds_read_b64_tr_b16 v[138:139], v168 offset:27136
    s_add_u32 s54, s54, 28672
    s_add_u32 m0, s46, 16384
    s_nop 0
    buffer_load_dwordx4 v170, s[12:15], s54 offen lds
    s_add_u32 s54, s54, 28672
    s_add_u32 m0, s46, 17408
    s_nop 0
    buffer_load_dwordx4 v170, s[12:15], s54 offen lds
    v_mfma_f32_32x32x16_bf16 v[60:75], v[112:115], a[64:67], v[60:75]
    ds_read_b64_tr_b16 v[108:109], v165 offset:57344
    ds_read_b64_tr_b16 v[110:111], v165 offset:57856
    s_add_u32 s54, s54, 28672
    s_add_u32 m0, s46, 18432
    s_nop 0
    buffer_load_dwordx4 v170, s[12:15], s54 offen lds
    s_add_u32 s54, s54, 28672
    s_add_u32 m0, s46, 19456
    s_nop 0
    buffer_load_dwordx4 v170, s[12:15], s54 offen lds
    v_mfma_f32_32x32x16_bf16 v[44:59], v[116:119], a[68:71], v[44:59]
    ds_read_b64_tr_b16 v[112:113], v168 offset:57344
    ds_read_b64_tr_b16 v[114:115], v168 offset:57856
    s_add_u32 s54, s54, 28672
    s_add_u32 m0, s46, 20480
    s_nop 0
    buffer_load_dwordx4 v170, s[12:15], s54 offen lds
    s_add_u32 s54, s54, 28672
    s_add_u32 m0, s46, 21504
    s_nop 0
    buffer_load_dwordx4 v170, s[12:15], s54 offen lds
    v_mfma_f32_32x32x16_bf16 v[60:75], v[120:123], a[68:71], v[60:75]
    ds_read_b64_tr_b16 v[116:117], v165 offset:59392
    ds_read_b64_tr_b16 v[118:119], v165 offset:59904
    s_add_u32 s54, s54, 28672
    s_add_u32 m0, s46, 22528
    s_nop 0
    buffer_load_dwordx4 v170, s[12:15], s54 offen lds
    s_add_u32 s54, s54, 28672
    s_add_u32 m0, s46, 23552
    s_nop 0
    buffer_load_dwordx4 v170, s[12:15], s54 offen lds
    s_waitcnt lgkmcnt(6)
    v_mfma_f32_32x32x16_bf16 v[44:59], v[124:127], a[72:75], v[44:59]
    ds_read_b64_tr_b16 v[120:121], v168 offset:59392
    ds_read_b64_tr_b16 v[122:123], v168 offset:59904
    v_mfma_f32_32x32x16_bf16 v[60:75], v[128:131], a[72:75], v[60:75]
    ds_read_b64_tr_b16 v[124:125], v166 offset:24576
    ds_read_b64_tr_b16 v[126:127], v166 offset:25088
    v_mfma_f32_32x32x16_bf16 v[44:59], v[132:135], a[76:79], v[44:59]
    ds_read_b64_tr_b16 v[128:129], v169 offset:24576
    ds_read_b64_tr_b16 v[130:131], v169 offset:25088
    v_mfma_f32_32x32x16_bf16 v[60:75], v[136:139], a[76:79], v[60:75]
    ds_read_b64_tr_b16 v[132:133], v166 offset:26624
    ds_read_b64_tr_b16 v[134:135], v166 offset:27136
    s_waitcnt lgkmcnt(6)
    v_mfma_f32_32x32x16_bf16 v[44:59], v[108:111], a[80:83], v[44:59]
    ds_read_b64_tr_b16 v[136:137], v169 offset:26624
    ds_read_b64_tr_b16 v[138:139], v169 offset:27136
    s_waitcnt vmcnt(25)
    s_barrier
    ds_read_b128 a[96:99], v6 offset:0
    ds_read_b128 a[100:103], v7 offset:0
    ds_read_b128 a[104:107], v8 offset:0
    ds_read_b128 a[108:111], v9 offset:0
    ds_read_b128 a[112:115], v6 offset:4096
    ds_read_b128 a[116:119], v7 offset:4096
    ds_read_b128 a[120:123], v8 offset:4096
    ds_read_b128 a[124:127], v9 offset:4096
    v_mfma_f32_32x32x16_bf16 v[60:75], v[112:115], a[80:83], v[60:75]
    ds_read_b64_tr_b16 v[108:109], v164 offset:61440
    ds_read_b64_tr_b16 v[110:111], v164 offset:61952
    v_mfma_f32_32x32x16_bf16 v[44:59], v[116:119], a[84:87], v[44:59]
    ds_read_b64_tr_b16 v[112:113], v167 offset:61440
    ds_read_b64_tr_b16 v[114:115], v167 offset:61952
    s_waitcnt vmcnt(8)
    v_lshl_or_b32 v100, v93, 16, v92
    v_lshl_or_b32 v101, v95, 16, v94
    v_lshl_or_b32 v102, v97, 16, v96
    v_lshl_or_b32 v103, v99, 16, v98
    buffer_store_dwordx4 v[100:103], v1, s[20:23], s67 offen sc0 sc1
    v_mfma_f32_32x32x16_bf16 v[60:75], v[120:123], a[84:87], v[60:75]
    ds_read_b64_tr_b16 v[116:117], v164 offset:63488
    ds_read_b64_tr_b16 v[118:119], v164 offset:64000
    s_waitcnt lgkmcnt(14)
    v_mfma_f32_32x32x16_bf16 v[44:59], v[124:127], a[88:91], v[44:59]
    ds_read_b64_tr_b16 v[120:121], v167 offset:63488
    ds_read_b64_tr_b16 v[122:123], v167 offset:64000
    v_mfma_f32_32x32x16_bf16 v[60:75], v[128:131], a[88:91], v[60:75]
    ds_read_b64_tr_b16 v[124:125], v165 offset:28672
    ds_read_b64_tr_b16 v[126:127], v165 offset:29184
    v_mfma_f32_32x32x16_bf16 v[44:59], v[132:135], a[92:95], v[44:59]
    ds_read_b64_tr_b16 v[128:129], v168 offset:28672
    ds_read_b64_tr_b16 v[130:131], v168 offset:29184
    v_mfma_f32_32x32x16_bf16 v[60:75], v[136:139], a[92:95], v[60:75]
    ds_read_b64_tr_b16 v[132:133], v165 offset:30720
    ds_read_b64_tr_b16 v[134:135], v165 offset:31232
    s_waitcnt lgkmcnt(6)
    v_mfma_f32_32x32x16_bf16 v[44:59], v[108:111], a[96:99], v[44:59]
    ds_read_b64_tr_b16 v[136:137], v168 offset:30720
    ds_read_b64_tr_b16 v[138:139], v168 offset:31232
    v_mfma_f32_32x32x16_bf16 v[60:75], v[112:115], a[96:99], v[60:75]
    ds_read_b64_tr_b16 v[108:109], v165 offset:61440
    ds_read_b64_tr_b16 v[110:111], v165 offset:61952
    v_mfma_f32_32x32x16_bf16 v[44:59], v[116:119], a[100:103], v[44:59]
    ds_read_b64_tr_b16 v[112:113], v168 offset:61440
    ds_read_b64_tr_b16 v[114:115], v168 offset:61952
    v_mfma_f32_32x32x16_bf16 v[60:75], v[120:123], a[100:103], v[60:75]
    ds_read_b64_tr_b16 v[116:117], v165 offset:63488
    ds_read_b64_tr_b16 v[118:119], v165 offset:64000
    s_waitcnt lgkmcnt(6)
    v_mfma_f32_32x32x16_bf16 v[44:59], v[124:127], a[104:107], v[44:59]
    ds_read_b64_tr_b16 v[120:121], v168 offset:63488
    ds_read_b64_tr_b16 v[122:123], v168 offset:64000
    v_mfma_f32_32x32x16_bf16 v[60:75], v[128:131], a[104:107], v[60:75]
    ds_read_b64_tr_b16 v[124:125], v166 offset:28672
    ds_read_b64_tr_b16 v[126:127], v166 offset:29184
    v_mfma_f32_32x32x16_bf16 v[44:59], v[132:135], a[108:111], v[44:59]
    ds_read_b64_tr_b16 v[128:129], v169 offset:28672
    ds_read_b64_tr_b16 v[130:131], v169 offset:29184
    v_mfma_f32_32x32x16_bf16 v[60:75], v[136:139], a[108:111], v[60:75]
    ds_read_b64_tr_b16 v[132:133], v166 offset:30720
    ds_read_b64_tr_b16 v[134:135], v166 offset:31232
    s_waitcnt lgkmcnt(6)
    v_mfma_f32_32x32x16_bf16 v[44:59], v[108:111], a[112:115], v[44:59]
    ds_read_b64_tr_b16 v[136:137], v169 offset:30720
    ds_read_b64_tr_b16 v[138:139], v169 offset:31232
    s_waitcnt vmcnt(1)
    s_barrier
    v_mfma_f32_32x32x16_bf16 v[60:75], v[112:115], a[112:115], v[60:75]
    ds_read_b64_tr_b16 v[108:109], v164 offset:40960
    ds_read_b64_tr_b16 v[110:111], v164 offset:41472
    v_mfma_f32_32x32x16_bf16 v[44:59], v[116:119], a[116:119], v[44:59]
    ds_read_b64_tr_b16 v[112:113], v164 offset:43008
    ds_read_b64_tr_b16 v[114:115], v164 offset:43520
    v_mfma_f32_32x32x16_bf16 v[60:75], v[120:123], a[116:119], v[60:75]
    ds_read_b64_tr_b16 v[116:117], v164 offset:45056
    ds_read_b64_tr_b16 v[118:119], v164 offset:45568
    s_waitcnt lgkmcnt(6)
    v_mfma_f32_32x32x16_bf16 v[44:59], v[124:127], a[120:123], v[44:59]
    ds_read_b64_tr_b16 v[120:121], v164 offset:47104
    ds_read_b64_tr_b16 v[122:123], v164 offset:47616
    v_mfma_f32_32x32x16_bf16 v[60:75], v[128:131], a[120:123], v[60:75]
    ds_read_b64_tr_b16 v[124:125], v164 offset:49152
    ds_read_b64_tr_b16 v[126:127], v164 offset:49664
    v_mfma_f32_32x32x16_bf16 v[44:59], v[132:135], a[124:127], v[44:59]
    ds_read_b64_tr_b16 v[128:129], v164 offset:51200
    ds_read_b64_tr_b16 v[130:131], v164 offset:51712
    v_mfma_f32_32x32x16_bf16 v[60:75], v[136:139], a[124:127], v[60:75]
    ds_read_b64_tr_b16 v[132:133], v164 offset:53248
    ds_read_b64_tr_b16 v[134:135], v164 offset:53760
    v_mov_b32 v20, v18
    s_nop 1
    v_mfma_f32_32x32x16_bf16 v[140:155], v[20:23], v[24:27], 0
    s_waitcnt lgkmcnt(6)
    v_mfma_f32_32x32x16_bf16 v[140:155], v[108:111], a[0:3], v[140:155]
    ds_read_b64_tr_b16 v[136:137], v164 offset:55296
    ds_read_b64_tr_b16 v[138:139], v164 offset:55808
    v_mul_f32 v84, s60, v44
    v_mul_f32 v85, s60, v45
    v_exp_f32 v84, v84
    v_mfma_f32_32x32x16_bf16 v[140:155], v[112:115], a[4:7], v[140:155]
    ds_read_b64_tr_b16 v[108:109], v165 offset:8192
    ds_read_b64_tr_b16 v[110:111], v165 offset:8704
    v_exp_f32 v85, v85
    v_fma_f32 v86, v84, -0.5, -1.0
    v_fma_f32 v87, v85, -0.5, -1.0
    v_fma_f32 v86, v84, v86, -1.0
    v_mfma_f32_32x32x16_bf16 v[140:155], v[116:119], a[8:11], v[140:155]
    ds_read_b64_tr_b16 v[112:113], v165 offset:10240
    ds_read_b64_tr_b16 v[114:115], v165 offset:10752
    v_fma_f32 v87, v85, v87, -1.0
    v_rcp_f32 v86, v86
    v_rcp_f32 v87, v87
    v_mfma_f32_32x32x16_bf16 v[140:155], v[120:123], a[12:15], v[140:155]
    ds_read_b64_tr_b16 v[116:117], v165 offset:12288
    ds_read_b64_tr_b16 v[118:119], v165 offset:12800
    v_fma_f32 v86, v44, v86, v44
    v_fma_f32 v87, v45, v87, v45
    v_cvt_pk_bf16_f32 v76, v86, v87
    s_waitcnt lgkmcnt(6)
    v_mfma_f32_32x32x16_bf16 v[140:155], v[124:127], a[16:19], v[140:155]
    ds_read_b64_tr_b16 v[120:121], v165 offset:14336
    ds_read_b64_tr_b16 v[122:123], v165 offset:14848
    v_mul_f32 v88, s60, v46
    v_mul_f32 v89, s60, v47
    v_exp_f32 v88, v88
    v_mfma_f32_32x32x16_bf16 v[140:155], v[128:131], a[20:23], v[140:155]
    ds_read_b64_tr_b16 v[124:125], v165 offset:16384
    ds_read_b64_tr_b16 v[126:127], v165 offset:16896
    v_exp_f32 v89, v89
    v_fma_f32 v90, v88, -0.5, -1.0
    v_fma_f32 v91, v89, -0.5, -1.0
    v_fma_f32 v90, v88, v90, -1.0
    v_mfma_f32_32x32x16_bf16 v[140:155], v[132:135], a[24:27], v[140:155]
    ds_read_b64_tr_b16 v[128:129], v165 offset:18432
    ds_read_b64_tr_b16 v[130:131], v165 offset:18944
    v_fma_f32 v91, v89, v91, -1.0
    v_rcp_f32 v90, v90
    v_rcp_f32 v91, v91
    v_mfma_f32_32x32x16_bf16 v[140:155], v[136:139], a[28:31], v[140:155]
    ds_read_b64_tr_b16 v[132:133], v165 offset:20480
    ds_read_b64_tr_b16 v[134:135], v165 offset:20992
    v_fma_f32 v90, v46, v90, v46
    v_fma_f32 v91, v47, v91, v47
    v_cvt_pk_bf16_f32 v77, v90, v91
    s_waitcnt lgkmcnt(6)
    v_mfma_f32_32x32x16_bf16 v[140:155], v[108:111], a[32:35], v[140:155]
    ds_read_b64_tr_b16 v[136:137], v165 offset:22528
    ds_read_b64_tr_b16 v[138:139], v165 offset:23040
    v_mul_f32 v84, s60, v48
    v_mul_f32 v85, s60, v49
    v_exp_f32 v84, v84
    v_mfma_f32_32x32x16_bf16 v[140:155], v[112:115], a[36:39], v[140:155]
    ds_read_b64_tr_b16 v[108:109], v165 offset:40960
    ds_read_b64_tr_b16 v[110:111], v165 offset:41472
    v_exp_f32 v85, v85
    v_fma_f32 v86, v84, -0.5, -1.0
    v_fma_f32 v87, v85, -0.5, -1.0
    v_fma_f32 v86, v84, v86, -1.0
    v_mfma_f32_32x32x16_bf16 v[140:155], v[116:119], a[40:43], v[140:155]
    ds_read_b64_tr_b16 v[112:113], v165 offset:43008
    ds_read_b64_tr_b16 v[114:115], v165 offset:43520
    v_fma_f32 v87, v85, v87, -1.0
    v_rcp_f32 v86, v86
    v_rcp_f32 v87, v87
    v_mfma_f32_32x32x16_bf16 v[140:155], v[120:123], a[44:47], v[140:155]
    ds_read_b64_tr_b16 v[116:117], v165 offset:45056
    ds_read_b64_tr_b16 v[118:119], v165 offset:45568
    v_fma_f32 v86, v48, v86, v48
    v_fma_f32 v87, v49, v87, v49
    v_cvt_pk_bf16_f32 v78, v86, v87
    s_waitcnt lgkmcnt(6)
    v_mfma_f32_32x32x16_bf16 v[140:155], v[124:127], a[48:51], v[140:155]
    ds_read_b64_tr_b16 v[120:121], v165 offset:47104
    ds_read_b64_tr_b16 v[122:123], v165 offset:47616
    v_mul_f32 v88, s60, v50
    v_mul_f32 v89, s60, v51
    v_exp_f32 v88, v88
    v_mfma_f32_32x32x16_bf16 v[140:155], v[128:131], a[52:55], v[140:155]
    ds_read_b64_tr_b16 v[124:125], v165 offset:49152
    ds_read_b64_tr_b16 v[126:127], v165 offset:49664
    v_exp_f32 v89, v89
    v_fma_f32 v90, v88, -0.5, -1.0
    v_fma_f32 v91, v89, -0.5, -1.0
    v_fma_f32 v90, v88, v90, -1.0
    v_mfma_f32_32x32x16_bf16 v[140:155], v[132:135], a[56:59], v[140:155]
    ds_read_b64_tr_b16 v[128:129], v165 offset:51200
    ds_read_b64_tr_b16 v[130:131], v165 offset:51712
    v_fma_f32 v91, v89, v91, -1.0
    v_rcp_f32 v90, v90
    v_rcp_f32 v91, v91
    v_mfma_f32_32x32x16_bf16 v[140:155], v[136:139], a[60:63], v[140:155]
    ds_read_b64_tr_b16 v[132:133], v165 offset:53248
    ds_read_b64_tr_b16 v[134:135], v165 offset:53760
    v_fma_f32 v90, v50, v90, v50
    v_fma_f32 v91, v51, v91, v51
    v_cvt_pk_bf16_f32 v79, v90, v91
    s_add_u32 s69, s57, 0
    buffer_store_dwordx4 v[76:79], v1, s[20:23], s69 offen sc0 sc1
    s_waitcnt lgkmcnt(6)
    v_mfma_f32_32x32x16_bf16 v[140:155], v[108:111], a[64:67], v[140:155]
    ds_read_b64_tr_b16 v[136:137], v165 offset:55296
    ds_read_b64_tr_b16 v[138:139], v165 offset:55808
    v_mul_f32 v84, s60, v52
    v_mul_f32 v85, s60, v53
    v_exp_f32 v84, v84
    v_mfma_f32_32x32x16_bf16 v[140:155], v[112:115], a[68:71], v[140:155]
    ds_read_b64_tr_b16 v[108:109], v166 offset:8192
    ds_read_b64_tr_b16 v[110:111], v166 offset:8704
    v_exp_f32 v85, v85
    v_fma_f32 v86, v84, -0.5, -1.0
    v_fma_f32 v87, v85, -0.5, -1.0
    v_fma_f32 v86, v84, v86, -1.0
    v_mfma_f32_32x32x16_bf16 v[140:155], v[116:119], a[72:75], v[140:155]
    ds_read_b64_tr_b16 v[112:113], v166 offset:10240
    ds_read_b64_tr_b16 v[114:115], v166 offset:10752
    v_fma_f32 v87, v85, v87, -1.0
    v_rcp_f32 v86, v86
    v_rcp_f32 v87, v87
    v_mfma_f32_32x32x16_bf16 v[140:155], v[120:123], a[76:79], v[140:155]
    ds_read_b64_tr_b16 v[116:117], v166 offset:12288
    ds_read_b64_tr_b16 v[118:119], v166 offset:12800
    v_fma_f32 v86, v52, v86, v52
    v_fma_f32 v87, v53, v87, v53
    v_cvt_pk_bf16_f32 v80, v86, v87
    s_waitcnt lgkmcnt(6)
    v_mfma_f32_32x32x16_bf16 v[140:155], v[124:127], a[80:83], v[140:155]
    ds_read_b64_tr_b16 v[120:121], v166 offset:14336
    ds_read_b64_tr_b16 v[122:123], v166 offset:14848
    v_mul_f32 v88, s60, v54
    v_mul_f32 v89, s60, v55
    v_exp_f32 v88, v88
    v_mfma_f32_32x32x16_bf16 v[140:155], v[128:131], a[84:87], v[140:155]
    ds_read_b64_tr_b16 v[124:125], v166 offset:16384
    ds_read_b64_tr_b16 v[126:127], v166 offset:16896
    v_exp_f32 v89, v89
    v_fma_f32 v90, v88, -0.5, -1.0
    v_fma_f32 v91, v89, -0.5, -1.0
    v_fma_f32 v90, v88, v90, -1.0
    v_mfma_f32_32x32x16_bf16 v[140:155], v[132:135], a[88:91], v[140:155]
    ds_read_b64_tr_b16 v[128:129], v166 offset:18432
    ds_read_b64_tr_b16 v[130:131], v166 offset:18944
    v_fma_f32 v91, v89, v91, -1.0
    v_rcp_f32 v90, v90
    v_rcp_f32 v91, v91
    v_mfma_f32_32x32x16_bf16 v[140:155], v[136:139], a[92:95], v[140:155]
    ds_read_b64_tr_b16 v[132:133], v166 offset:20480
    ds_read_b64_tr_b16 v[134:135], v166 offset:20992
    v_fma_f32 v90, v54, v90, v54
    v_fma_f32 v91, v55, v91, v55
    v_cvt_pk_bf16_f32 v81, v90, v91
    s_waitcnt lgkmcnt(6)
    v_mfma_f32_32x32x16_bf16 v[140:155], v[108:111], a[96:99], v[140:155]
    ds_read_b64_tr_b16 v[136:137], v166 offset:22528
    ds_read_b64_tr_b16 v[138:139], v166 offset:23040
    v_mul_f32 v84, s60, v56
    v_mul_f32 v85, s60, v57
    v_exp_f32 v84, v84
    v_mfma_f32_32x32x16_bf16 v[140:155], v[112:115], a[100:103], v[140:155]
    ds_read_b64_tr_b16 v[108:109], v167 offset:40960
    ds_read_b64_tr_b16 v[110:111], v167 offset:41472
    v_exp_f32 v85, v85
    v_fma_f32 v86, v84, -0.5, -1.0
    v_fma_f32 v87, v85, -0.5, -1.0
    v_fma_f32 v86, v84, v86, -1.0
    v_mfma_f32_32x32x16_bf16 v[140:155], v[116:119], a[104:107], v[140:155]
    ds_read_b64_tr_b16 v[112:113], v167 offset:43008
    ds_read_b64_tr_b16 v[114:115], v167 offset:43520
    v_fma_f32 v87, v85, v87, -1.0
    v_rcp_f32 v86, v86
    v_rcp_f32 v87, v87
    v_mfma_f32_32x32x16_bf16 v[140:155], v[120:123], a[108:111], v[140:155]
    ds_read_b64_tr_b16 v[116:117], v167 offset:45056
    ds_read_b64_tr_b16 v[118:119], v167 offset:45568
    v_fma_f32 v86, v56, v86, v56
    v_fma_f32 v87, v57, v87, v57
    v_cvt_pk_bf16_f32 v82, v86, v87
    s_waitcnt lgkmcnt(6)
    v_mfma_f32_32x32x16_bf16 v[140:155], v[124:127], a[112:115], v[140:155]
    ds_read_b64_tr_b16 v[120:121], v167 offset:47104
    ds_read_b64_tr_b16 v[122:123], v167 offset:47616
    v_mul_f32 v88, s60, v58
    v_mul_f32 v89, s60, v59
    v_exp_f32 v88, v88
    v_mfma_f32_32x32x16_bf16 v[140:155], v[128:131], a[116:119], v[140:155]
    ds_read_b64_tr_b16 v[124:125], v167 offset:49152
    ds_read_b64_tr_b16 v[126:127], v167 offset:49664
    v_exp_f32 v89, v89
    v_fma_f32 v90, v88, -0.5, -1.0
    v_fma_f32 v91, v89, -0.5, -1.0
    v_fma_f32 v90, v88, v90, -1.0
    v_mfma_f32_32x32x16_bf16 v[140:155], v[132:135], a[120:123], v[140:155]
    ds_read_b64_tr_b16 v[128:129], v167 offset:51200
    ds_read_b64_tr_b16 v[130:131], v167 offset:51712
    v_fma_f32 v91, v89, v91, -1.0
    v_rcp_f32 v90, v90
    v_rcp_f32 v91, v91
    v_mfma_f32_32x32x16_bf16 v[140:155], v[136:139], a[124:127], v[140:155]
    ds_read_b64_tr_b16 v[132:133], v167 offset:53248
    ds_read_b64_tr_b16 v[134:135], v167 offset:53760
    v_fma_f32 v90, v58, v90, v58
    v_fma_f32 v91, v59, v91, v59
    v_cvt_pk_bf16_f32 v83, v90, v91
    s_add_u32 s69, s57, 1024
    buffer_store_dwordx4 v[80:83], v1, s[20:23], s69 offen sc0 sc1
    v_mov_b32 v20, v19
    s_nop 1
    v_mfma_f32_32x32x16_bf16 v[44:59], v[20:23], v[24:27], 0
    s_waitcnt lgkmcnt(6)
    v_mfma_f32_32x32x16_bf16 v[44:59], v[108:111], a[0:3], v[44:59]
    ds_read_b64_tr_b16 v[136:137], v167 offset:55296
    ds_read_b64_tr_b16 v[138:139], v167 offset:55808
    v_mul_f32 v84, s60, v60
    v_mul_f32 v85, s60, v61
    v_exp_f32 v84, v84
    s_sub_u32 s64, s47, 11
    s_lshl_b32 s64, s64, 4
    s_add_u32 s64, s64, s74
    s_lshl_b32 s64, s64, 2
    s_add_u32 s64, s64, s44
    s_min_u32 s64, s64, 255
    s_add_u32 s64, s64, 2048
    s_lshr_b32 s48, s64, 4
    s_cmp_ge_u32 s48, 112
    s_cselect_b32 s40, s36, s32
    s_cselect_b32 s41, s37, s33
    s_cselect_b32 s42, s38, s34
    s_mov_b32 s43, 0x00020000
    s_cselect_b32 s49, 112, 0
    s_sub_u32 s48, s48, s49
    s_lshl_b32 s48, s48, 14
    s_and_b32 s49, s64, 15
    s_lshl_b32 s49, s49, 6
    s_add_u32 s65, s48, s49
    s_add_u32 s66, s65, 8192
    s_lshl_b32 s67, s64, 10
    s_add_u32 s67, s67, 2359296
    v_mfma_f32_32x32x16_bf16 v[44:59], v[112:115], a[4:7], v[44:59]
    ds_read_b64_tr_b16 v[108:109], v168 offset:8192
    ds_read_b64_tr_b16 v[110:111], v168 offset:8704
    v_exp_f32 v85, v85
    v_fma_f32 v86, v84, -0.5, -1.0
    v_fma_f32 v87, v85, -0.5, -1.0
    v_fma_f32 v86, v84, v86, -1.0
    buffer_load_ushort v92, v14, s[40:43], s65 offen
    v_mfma_f32_32x32x16_bf16 v[44:59], v[116:119], a[8:11], v[44:59]
    ds_read_b64_tr_b16 v[112:113], v168 offset:10240
    ds_read_b64_tr_b16 v[114:115], v168 offset:10752
    v_fma_f32 v87, v85, v87, -1.0
    v_rcp_f32 v86, v86
    v_rcp_f32 v87, v87
    buffer_load_ushort v93, v14, s[40:43], s65 offen offset:1024
    v_mfma_f32_32x32x16_bf16 v[44:59], v[120:123], a[12:15], v[44:59]
    ds_read_b64_tr_b16 v[116:117], v168 offset:12288
    ds_read_b64_tr_b16 v[118:119], v168 offset:12800
    v_fma_f32 v86, v60, v86, v60
    v_fma_f32 v87, v61, v87, v61
    v_cvt_pk_bf16_f32 v76, v86, v87
    buffer_load_ushort v94, v14, s[40:43], s65 offen offset:2048
    s_waitcnt lgkmcnt(6)
    v_mfma_f32_32x32x16_bf16 v[44:59], v[124:127], a[16:19], v[44:59]
    ds_read_b64_tr_b16 v[120:121], v168 offset:14336
    ds_read_b64_tr_b16 v[122:123], v168 offset:14848
    v_mul_f32 v88, s60, v62
    v_mul_f32 v89, s60, v63
    v_exp_f32 v88, v88
    buffer_load_ushort v95, v14, s[40:43], s65 offen offset:3072
    v_mfma_f32_32x32x16_bf16 v[44:59], v[128:131], a[20:23], v[44:59]
    ds_read_b64_tr_b16 v[124:125], v168 offset:16384
    ds_read_b64_tr_b16 v[126:127], v168 offset:16896
    v_exp_f32 v89, v89
    v_fma_f32 v90, v88, -0.5, -1.0
    v_fma_f32 v91, v89, -0.5, -1.0
    v_fma_f32 v90, v88, v90, -1.0
    buffer_load_ushort v96, v14, s[40:43], s66 offen
    v_mfma_f32_32x32x16_bf16 v[44:59], v[132:135], a[24:27], v[44:59]
    ds_read_b64_tr_b16 v[128:129], v168 offset:18432
    ds_read_b64_tr_b16 v[130:131], v168 offset:18944
    v_fma_f32 v91, v89, v91, -1.0
    v_rcp_f32 v90, v90
    v_rcp_f32 v91, v91
    buffer_load_ushort v97, v14, s[40:43], s66 offen offset:1024
    v_mfma_f32_32x32x16_bf16 v[44:59], v[136:139], a[28:31], v[44:59]
    ds_read_b64_tr_b16 v[132:133], v168 offset:20480
    ds_read_b64_tr_b16 v[134:135], v168 offset:20992
    v_fma_f32 v90, v62, v90, v62
    v_fma_f32 v91, v63, v91, v63
    v_cvt_pk_bf16_f32 v77, v90, v91
    buffer_load_ushort v98, v14, s[40:43], s66 offen offset:2048
    s_waitcnt lgkmcnt(6)
    v_mfma_f32_32x32x16_bf16 v[44:59], v[108:111], a[32:35], v[44:59]
    ds_read_b64_tr_b16 v[136:137], v168 offset:22528
    ds_read_b64_tr_b16 v[138:139], v168 offset:23040
    v_mul_f32 v84, s60, v64
    v_mul_f32 v85, s60, v65
    v_exp_f32 v84, v84
    buffer_load_ushort v99, v14, s[40:43], s66 offen offset:3072
    v_mfma_f32_32x32x16_bf16 v[44:59], v[112:115], a[36:39], v[44:59]
    ds_read_b64_tr_b16 v[108:109], v168 offset:40960
    ds_read_b64_tr_b16 v[110:111], v168 offset:41472
    v_exp_f32 v85, v85
    v_fma_f32 v86, v84, -0.5, -1.0
    v_fma_f32 v87, v85, -0.5, -1.0
    v_fma_f32 v86, v84, v86, -1.0
    v_mfma_f32_32x32x16_bf16 v[44:59], v[116:119], a[40:43], v[44:59]
    ds_read_b64_tr_b16 v[112:113], v168 offset:43008
    ds_read_b64_tr_b16 v[114:115], v168 offset:43520
    v_fma_f32 v87, v85, v87, -1.0
    v_rcp_f32 v86, v86
    v_rcp_f32 v87, v87
    v_mfma_f32_32x32x16_bf16 v[44:59], v[120:123], a[44:47], v[44:59]
    ds_read_b64_tr_b16 v[116:117], v168 offset:45056
    ds_read_b64_tr_b16 v[118:119], v168 offset:45568
    v_fma_f32 v86, v64, v86, v64
    v_fma_f32 v87, v65, v87, v65
    v_cvt_pk_bf16_f32 v78, v86, v87
    s_waitcnt lgkmcnt(6)
    v_mfma_f32_32x32x16_bf16 v[44:59], v[124:127], a[48:51], v[44:59]
    ds_read_b64_tr_b16 v[120:121], v168 offset:47104
    ds_read_b64_tr_b16 v[122:123], v168 offset:47616
    v_mul_f32 v88, s60, v66
    v_mul_f32 v89, s60, v67
    v_exp_f32 v88, v88
    v_mfma_f32_32x32x16_bf16 v[44:59], v[128:131], a[52:55], v[44:59]
    ds_read_b64_tr_b16 v[124:125], v168 offset:49152
    ds_read_b64_tr_b16 v[126:127], v168 offset:49664
    v_exp_f32 v89, v89
    v_fma_f32 v90, v88, -0.5, -1.0
    v_fma_f32 v91, v89, -0.5, -1.0
    v_fma_f32 v90, v88, v90, -1.0
    v_mfma_f32_32x32x16_bf16 v[44:59], v[132:135], a[56:59], v[44:59]
    ds_read_b64_tr_b16 v[128:129], v168 offset:51200
    ds_read_b64_tr_b16 v[130:131], v168 offset:51712
    v_fma_f32 v91, v89, v91, -1.0
    v_rcp_f32 v90, v90
    v_rcp_f32 v91, v91
    v_mfma_f32_32x32x16_bf16 v[44:59], v[136:139], a[60:63], v[44:59]
    ds_read_b64_tr_b16 v[132:133], v168 offset:53248
    ds_read_b64_tr_b16 v[134:135], v168 offset:53760
    v_fma_f32 v90, v66, v90, v66
    v_fma_f32 v91, v67, v91, v67
    v_cvt_pk_bf16_f32 v79, v90, v91
    s_add_u32 s69, s57, 2048
    buffer_store_dwordx4 v[76:79], v1, s[20:23], s69 offen sc0 sc1
    s_waitcnt lgkmcnt(6)
    v_mfma_f32_32x32x16_bf16 v[44:59], v[108:111], a[64:67], v[44:59]
    ds_read_b64_tr_b16 v[136:137], v168 offset:55296
    ds_read_b64_tr_b16 v[138:139], v168 offset:55808
    v_mul_f32 v84, s60, v68
    v_mul_f32 v85, s60, v69
    v_exp_f32 v84, v84
    v_mfma_f32_32x32x16_bf16 v[44:59], v[112:115], a[68:71], v[44:59]
    ds_read_b64_tr_b16 v[108:109], v169 offset:8192
    ds_read_b64_tr_b16 v[110:111], v169 offset:8704
    v_exp_f32 v85, v85
    v_fma_f32 v86, v84, -0.5, -1.0
    v_fma_f32 v87, v85, -0.5, -1.0
    v_fma_f32 v86, v84, v86, -1.0
    v_mfma_f32_32x32x16_bf16 v[44:59], v[116:119], a[72:75], v[44:59]
    ds_read_b64_tr_b16 v[112:113], v169 offset:10240
    ds_read_b64_tr_b16 v[114:115], v169 offset:10752
    v_fma_f32 v87, v85, v87, -1.0
    v_rcp_f32 v86, v86
    v_rcp_f32 v87, v87
    v_mfma_f32_32x32x16_bf16 v[44:59], v[120:123], a[76:79], v[44:59]
    ds_read_b64_tr_b16 v[116:117], v169 offset:12288
    ds_read_b64_tr_b16 v[118:119], v169 offset:12800
    v_fma_f32 v86, v68, v86, v68
    v_fma_f32 v87, v69, v87, v69
    v_cvt_pk_bf16_f32 v80, v86, v87
    s_waitcnt lgkmcnt(6)
    v_mfma_f32_32x32x16_bf16 v[44:59], v[124:127], a[80:83], v[44:59]
    ds_read_b64_tr_b16 v[120:121], v169 offset:14336
    ds_read_b64_tr_b16 v[122:123], v169 offset:14848
    v_mul_f32 v88, s60, v70
    v_mul_f32 v89, s60, v71
    v_exp_f32 v88, v88
    s_waitcnt vmcnt(1)
    v_lshl_or_b32 v100, v93, 16, v92
    v_lshl_or_b32 v101, v95, 16, v94
    v_lshl_or_b32 v102, v97, 16, v96
    v_lshl_or_b32 v103, v99, 16, v98
    buffer_store_dwordx4 v[100:103], v1, s[20:23], s67 offen sc0 sc1
    v_mfma_f32_32x32x16_bf16 v[44:59], v[128:131], a[84:87], v[44:59]
    ds_read_b64_tr_b16 v[124:125], v169 offset:16384
    ds_read_b64_tr_b16 v[126:127], v169 offset:16896
    v_exp_f32 v89, v89
    v_fma_f32 v90, v88, -0.5, -1.0
    v_fma_f32 v91, v89, -0.5, -1.0
    v_fma_f32 v90, v88, v90, -1.0
    v_mfma_f32_32x32x16_bf16 v[44:59], v[132:135], a[88:91], v[44:59]
    ds_read_b64_tr_b16 v[128:129], v169 offset:18432
    ds_read_b64_tr_b16 v[130:131], v169 offset:18944
    v_fma_f32 v91, v89, v91, -1.0
    v_rcp_f32 v90, v90
    v_rcp_f32 v91, v91
    v_mfma_f32_32x32x16_bf16 v[44:59], v[136:139], a[92:95], v[44:59]
    ds_read_b64_tr_b16 v[132:133], v169 offset:20480
    ds_read_b64_tr_b16 v[134:135], v169 offset:20992
    v_fma_f32 v90, v70, v90, v70
    v_fma_f32 v91, v71, v91, v71
    v_cvt_pk_bf16_f32 v81, v90, v91
    s_waitcnt lgkmcnt(6)
    v_mfma_f32_32x32x16_bf16 v[44:59], v[108:111], a[96:99], v[44:59]
    ds_read_b64_tr_b16 v[136:137], v169 offset:22528
    ds_read_b64_tr_b16 v[138:139], v169 offset:23040
    v_mul_f32 v84, s60, v72
    v_mul_f32 v85, s60, v73
    v_exp_f32 v84, v84
    v_mfma_f32_32x32x16_bf16 v[44:59], v[112:115], a[100:103], v[44:59]
    v_exp_f32 v85, v85
    v_fma_f32 v86, v84, -0.5, -1.0
    v_fma_f32 v87, v85, -0.5, -1.0
    v_fma_f32 v86, v84, v86, -1.0
    v_mfma_f32_32x32x16_bf16 v[44:59], v[116:119], a[104:107], v[44:59]
    v_fma_f32 v87, v85, v87, -1.0
    v_rcp_f32 v86, v86
    v_rcp_f32 v87, v87
    v_mfma_f32_32x32x16_bf16 v[44:59], v[120:123], a[108:111], v[44:59]
    v_fma_f32 v86, v72, v86, v72
    v_fma_f32 v87, v73, v87, v73
    v_cvt_pk_bf16_f32 v82, v86, v87
    s_waitcnt lgkmcnt(0)
    v_mfma_f32_32x32x16_bf16 v[44:59], v[124:127], a[112:115], v[44:59]
    v_mul_f32 v88, s60, v74
    v_mul_f32 v89, s60, v75
    v_exp_f32 v88, v88
    v_mfma_f32_32x32x16_bf16 v[44:59], v[128:131], a[116:119], v[44:59]
    v_exp_f32 v89, v89
    v_fma_f32 v90, v88, -0.5, -1.0
    v_fma_f32 v91, v89, -0.5, -1.0
    v_fma_f32 v90, v88, v90, -1.0
    v_mfma_f32_32x32x16_bf16 v[44:59], v[132:135], a[120:123], v[44:59]
    v_fma_f32 v91, v89, v91, -1.0
    v_rcp_f32 v90, v90
    v_rcp_f32 v91, v91
    v_mfma_f32_32x32x16_bf16 v[44:59], v[136:139], a[124:127], v[44:59]
    v_fma_f32 v90, v74, v90, v74
    v_fma_f32 v91, v75, v91, v75
    v_cvt_pk_bf16_f32 v83, v90, v91
    s_add_u32 s69, s57, 3072
    buffer_store_dwordx4 v[80:83], v1, s[20:23], s69 offen sc0 sc1
    v_mul_f32 v84, s60, v140
    v_mul_f32 v85, s60, v141
    v_exp_f32 v84, v84
    v_exp_f32 v85, v85
    v_fma_f32 v86, v84, -0.5, -1.0
    v_fma_f32 v87, v85, -0.5, -1.0
    v_fma_f32 v86, v84, v86, -1.0
    v_fma_f32 v87, v85, v87, -1.0
    v_rcp_f32 v86, v86
    v_rcp_f32 v87, v87
    v_fma_f32 v86, v140, v86, v140
    v_fma_f32 v87, v141, v87, v141
    v_cvt_pk_bf16_f32 v76, v86, v87
    v_mul_f32 v88, s60, v142
    v_mul_f32 v89, s60, v143
    v_exp_f32 v88, v88
    v_exp_f32 v89, v89
    v_fma_f32 v90, v88, -0.5, -1.0
    v_fma_f32 v91, v89, -0.5, -1.0
    v_fma_f32 v90, v88, v90, -1.0
    v_fma_f32 v91, v89, v91, -1.0
    v_rcp_f32 v90, v90
    v_rcp_f32 v91, v91
    v_fma_f32 v90, v142, v90, v142
    v_fma_f32 v91, v143, v91, v143
    v_cvt_pk_bf16_f32 v77, v90, v91
    v_mul_f32 v84, s60, v144
    v_mul_f32 v85, s60, v145
    v_exp_f32 v84, v84
    v_exp_f32 v85, v85
    v_fma_f32 v86, v84, -0.5, -1.0
    v_fma_f32 v87, v85, -0.5, -1.0
    v_fma_f32 v86, v84, v86, -1.0
    v_fma_f32 v87, v85, v87, -1.0
    v_rcp_f32 v86, v86
    v_rcp_f32 v87, v87
    v_fma_f32 v86, v144, v86, v144
    v_fma_f32 v87, v145, v87, v145
    v_cvt_pk_bf16_f32 v78, v86, v87
    v_mul_f32 v88, s60, v146
    v_mul_f32 v89, s60, v147
    v_exp_f32 v88, v88
    v_exp_f32 v89, v89
    v_fma_f32 v90, v88, -0.5, -1.0
    v_fma_f32 v91, v89, -0.5, -1.0
    v_fma_f32 v90, v88, v90, -1.0
    v_fma_f32 v91, v89, v91, -1.0
    v_rcp_f32 v90, v90
    v_rcp_f32 v91, v91
    v_fma_f32 v90, v146, v90, v146
    v_fma_f32 v91, v147, v91, v147
    v_cvt_pk_bf16_f32 v79, v90, v91
    s_add_u32 s69, s75, 0
    buffer_store_dwordx4 v[76:79], v1, s[20:23], s69 offen sc0 sc1
    v_mul_f32 v84, s60, v148
    v_mul_f32 v85, s60, v149
    v_exp_f32 v84, v84
    v_exp_f32 v85, v85
    v_fma_f32 v86, v84, -0.5, -1.0
    v_fma_f32 v87, v85, -0.5, -1.0
    v_fma_f32 v86, v84, v86, -1.0
    v_fma_f32 v87, v85, v87, -1.0
    v_rcp_f32 v86, v86
    v_rcp_f32 v87, v87
    v_fma_f32 v86, v148, v86, v148
    v_fma_f32 v87, v149, v87, v149
    v_cvt_pk_bf16_f32 v80, v86, v87
    v_mul_f32 v88, s60, v150
    v_mul_f32 v89, s60, v151
    v_exp_f32 v88, v88
    v_exp_f32 v89, v89
    v_fma_f32 v90, v88, -0.5, -1.0
    v_fma_f32 v91, v89, -0.5, -1.0
    v_fma_f32 v90, v88, v90, -1.0
    v_fma_f32 v91, v89, v91, -1.0
    v_rcp_f32 v90, v90
    v_rcp_f32 v91, v91
    v_fma_f32 v90, v150, v90, v150
    v_fma_f32 v91, v151, v91, v151
    v_cvt_pk_bf16_f32 v81, v90, v91
    v_mul_f32 v84, s60, v152
    v_mul_f32 v85, s60, v153
    v_exp_f32 v84, v84
    v_exp_f32 v85, v85
    v_fma_f32 v86, v84, -0.5, -1.0
    v_fma_f32 v87, v85, -0.5, -1.0
    v_fma_f32 v86, v84, v86, -1.0
    v_fma_f32 v87, v85, v87, -1.0
    v_rcp_f32 v86, v86
    v_rcp_f32 v87, v87
    v_fma_f32 v86, v152, v86, v152
    v_fma_f32 v87, v153, v87, v153
    v_cvt_pk_bf16_f32 v82, v86, v87
    v_mul_f32 v88, s60, v154
    v_mul_f32 v89, s60, v155
    v_exp_f32 v88, v88
    v_exp_f32 v89, v89
    v_fma_f32 v90, v88, -0.5, -1.0
    v_fma_f32 v91, v89, -0.5, -1.0
    v_fma_f32 v90, v88, v90, -1.0
    v_fma_f32 v91, v89, v91, -1.0
    v_rcp_f32 v90, v90
    v_rcp_f32 v91, v91
    v_fma_f32 v90, v154, v90, v154
    v_fma_f32 v91, v155, v91, v155
    v_cvt_pk_bf16_f32 v83, v90, v91
    s_add_u32 s69, s75, 1024
    buffer_store_dwordx4 v[80:83], v1, s[20:23], s69 offen sc0 sc1
    v_mul_f32 v84, s60, v44
    v_mul_f32 v85, s60, v45
    v_exp_f32 v84, v84
    v_exp_f32 v85, v85
    v_fma_f32 v86, v84, -0.5, -1.0
    v_fma_f32 v87, v85, -0.5, -1.0
    v_fma_f32 v86, v84, v86, -1.0
    v_fma_f32 v87, v85, v87, -1.0
    v_rcp_f32 v86, v86
    v_rcp_f32 v87, v87
    v_fma_f32 v86, v44, v86, v44
    v_fma_f32 v87, v45, v87, v45
    v_cvt_pk_bf16_f32 v76, v86, v87
    v_mul_f32 v88, s60, v46
    v_mul_f32 v89, s60, v47
    v_exp_f32 v88, v88
    v_exp_f32 v89, v89
    v_fma_f32 v90, v88, -0.5, -1.0
    v_fma_f32 v91, v89, -0.5, -1.0
    v_fma_f32 v90, v88, v90, -1.0
    v_fma_f32 v91, v89, v91, -1.0
    v_rcp_f32 v90, v90
    v_rcp_f32 v91, v91
    v_fma_f32 v90, v46, v90, v46
    v_fma_f32 v91, v47, v91, v47
    v_cvt_pk_bf16_f32 v77, v90, v91
    v_mul_f32 v84, s60, v48
    v_mul_f32 v85, s60, v49
    v_exp_f32 v84, v84
    v_exp_f32 v85, v85
    v_fma_f32 v86, v84, -0.5, -1.0
    v_fma_f32 v87, v85, -0.5, -1.0
    v_fma_f32 v86, v84, v86, -1.0
    v_fma_f32 v87, v85, v87, -1.0
    v_rcp_f32 v86, v86
    v_rcp_f32 v87, v87
    v_fma_f32 v86, v48, v86, v48
    v_fma_f32 v87, v49, v87, v49
    v_cvt_pk_bf16_f32 v78, v86, v87
    v_mul_f32 v88, s60, v50
    v_mul_f32 v89, s60, v51
    v_exp_f32 v88, v88
    v_exp_f32 v89, v89
    v_fma_f32 v90, v88, -0.5, -1.0
    v_fma_f32 v91, v89, -0.5, -1.0
    v_fma_f32 v90, v88, v90, -1.0
    v_fma_f32 v91, v89, v91, -1.0
    v_rcp_f32 v90, v90
    v_rcp_f32 v91, v91
    v_fma_f32 v90, v50, v90, v50
    v_fma_f32 v91, v51, v91, v51
    v_cvt_pk_bf16_f32 v79, v90, v91
    s_add_u32 s69, s75, 2048
    buffer_store_dwordx4 v[76:79], v1, s[20:23], s69 offen sc0 sc1
    v_mul_f32 v84, s60, v52
    v_mul_f32 v85, s60, v53
    v_exp_f32 v84, v84
    v_exp_f32 v85, v85
    v_fma_f32 v86, v84, -0.5, -1.0
    v_fma_f32 v87, v85, -0.5, -1.0
    v_fma_f32 v86, v84, v86, -1.0
    v_fma_f32 v87, v85, v87, -1.0
    v_rcp_f32 v86, v86
    v_rcp_f32 v87, v87
    v_fma_f32 v86, v52, v86, v52
    v_fma_f32 v87, v53, v87, v53
    v_cvt_pk_bf16_f32 v80, v86, v87
    v_mul_f32 v88, s60, v54
    v_mul_f32 v89, s60, v55
    v_exp_f32 v88, v88
    v_exp_f32 v89, v89
    v_fma_f32 v90, v88, -0.5, -1.0
    v_fma_f32 v91, v89, -0.5, -1.0
    v_fma_f32 v90, v88, v90, -1.0
    v_fma_f32 v91, v89, v91, -1.0
    v_rcp_f32 v90, v90
    v_rcp_f32 v91, v91
    v_fma_f32 v90, v54, v90, v54
    v_fma_f32 v91, v55, v91, v55
    v_cvt_pk_bf16_f32 v81, v90, v91
    v_mul_f32 v84, s60, v56
    v_mul_f32 v85, s60, v57
    v_exp_f32 v84, v84
    v_exp_f32 v85, v85
    v_fma_f32 v86, v84, -0.5, -1.0
    v_fma_f32 v87, v85, -0.5, -1.0
    v_fma_f32 v86, v84, v86, -1.0
    v_fma_f32 v87, v85, v87, -1.0
    v_rcp_f32 v86, v86
    v_rcp_f32 v87, v87
    v_fma_f32 v86, v56, v86, v56
    v_fma_f32 v87, v57, v87, v57
    v_cvt_pk_bf16_f32 v82, v86, v87
    v_mul_f32 v88, s60, v58
    v_mul_f32 v89, s60, v59
    v_exp_f32 v88, v88
    v_exp_f32 v89, v89
    v_fma_f32 v90, v88, -0.5, -1.0
    v_fma_f32 v91, v89, -0.5, -1.0
    v_fma_f32 v90, v88, v90, -1.0
    v_fma_f32 v91, v89, v91, -1.0
    v_rcp_f32 v90, v90
    v_rcp_f32 v91, v91
    v_fma_f32 v90, v58, v90, v58
    v_fma_f32 v91, v59, v91, v59
    v_cvt_pk_bf16_f32 v83, v90, v91
    s_add_u32 s69, s75, 3072
    buffer_store_dwordx4 v[80:83], v1, s[20:23], s69 offen sc0 sc1
    s_endpgm
K1_BK:
    s_sub_u32 s48, s47, 8
    s_lshl_b32 s55, s48, 8
    s_add_u32 s73, s55, 128
    s_mov_b32 m0, s46
    s_nop 0
    buffer_load_dwordx4 v2, s[8:11], s50 offen lds
    s_add_u32 m0, s46, 1024
    s_nop 0
    buffer_load_dwordx4 v3, s[8:11], s51 offen lds
    s_add_u32 m0, s46, 2048
    s_nop 0
    buffer_load_dwordx4 v2, s[8:11], s52 offen lds
    s_add_u32 m0, s46, 3072
    s_nop 0
    buffer_load_dwordx4 v3, s[8:11], s53 offen lds
    s_add_u32 m0, s46, 3968
    s_nop 0
    buffer_load_dwordx4 v2, s[8:11], s50 offen offset:128 lds
    s_add_u32 m0, s46, 4992
    s_nop 0
    buffer_load_dwordx4 v3, s[8:11], s51 offen offset:128 lds
    s_add_u32 m0, s46, 6016
    s_nop 0
    buffer_load_dwordx4 v2, s[8:11], s52 offen offset:128 lds
    s_add_u32 m0, s46, 7040
    s_nop 0
    buffer_load_dwordx4 v3, s[8:11], s53 offen offset:128 lds
    s_add_u32 s54, s55, s59
    s_mov_b32 m0, s82
    s_nop 0
    buffer_load_dwordx4 v170, s[12:15], s54 offen lds
    s_add_u32 s54, s54, 28672
    s_add_u32 m0, s82, 1024
    s_nop 0
    buffer_load_dwordx4 v170, s[12:15], s54 offen lds
    s_add_u32 s54, s54, 28672
    s_add_u32 m0, s82, 2048
    s_nop 0
    buffer_load_dwordx4 v170, s[12:15], s54 offen lds
    s_add_u32 s54, s54, 28672
    s_add_u32 m0, s82, 3072
    s_nop 0
    buffer_load_dwordx4 v170, s[12:15], s54 offen lds
    buffer_load_ushort v16, v13, s[24:27], s55 offen
    buffer_load_ushort v17, v13, s[24:27], s55 offen offset:64
    buffer_load_ushort v18, v13, s[24:27], s73 offen
    buffer_load_ushort v19, v13, s[24:27], s73 offen offset:64
    s_add_u32 m0, s46, 7936
    s_nop 0
    buffer_load_dwordx4 v2, s[8:11], s50 offen offset:256 lds
    s_add_u32 m0, s46, 8960
    s_nop 0
    buffer_load_dwordx4 v3, s[8:11], s51 offen offset:256 lds
    s_add_u32 m0, s46, 9984
    s_nop 0
    buffer_load_dwordx4 v2, s[8:11], s52 offen offset:256 lds
    s_add_u32 m0, s46, 11008
    s_nop 0
    buffer_load_dwordx4 v3, s[8:11], s53 offen offset:256 lds
    s_add_u32 m0, s46, 11904
    s_nop 0
    buffer_load_dwordx4 v2, s[8:11], s50 offen offset:384 lds
    s_add_u32 m0, s46, 12928
    s_nop 0
    buffer_load_dwordx4 v3, s[8:11], s51 offen offset:384 lds
    s_add_u32 m0, s46, 13952
    s_nop 0
    buffer_load_dwordx4 v2, s[8:11], s52 offen offset:384 lds
    s_add_u32 m0, s46, 14976
    s_nop 0
    buffer_load_dwordx4 v3, s[8:11], s53 offen offset:384 lds
    s_add_u32 s54, s55, s59
    s_add_u32 s54, s54, 458752
    s_add_u32 m0, s82, 16384
    s_nop 0
    buffer_load_dwordx4 v170, s[12:15], s54 offen lds
    s_add_u32 s54, s54, 28672
    s_add_u32 m0, s82, 17408
    s_nop 0
    buffer_load_dwordx4 v170, s[12:15], s54 offen lds
    s_add_u32 s54, s54, 28672
    s_add_u32 m0, s82, 18432
    s_nop 0
    buffer_load_dwordx4 v170, s[12:15], s54 offen lds
    s_add_u32 s54, s54, 28672
    s_add_u32 m0, s82, 19456
    s_nop 0
    buffer_load_dwordx4 v170, s[12:15], s54 offen lds
    s_mul_i32 s57, s45, 114688
    s_add_u32 s57, s57, 4718592
    s_lshl_b32 s48, s73, 5
    s_add_u32 s75, s57, s48
    s_lshl_b32 s48, s55, 5
    s_add_u32 s57, s57, s48
    s_mov_b32 s28, s76
    s_mov_b32 s29, s77
    s_mov_b32 s30, 16384
    s_mov_b32 s31, 0x00020000
    v_bfe_u32 v15, v0, 2, 2
    v_lshrrev_b32 v10, 5, v0
    v_lshl_add_u32 v15, v10, 3, v15
    v_and_b32 v10, 3, v0
    v_lshlrev_b32 v10, 3, v10
    v_lshl_add_u32 v10, v15, 5, v10
    v_add_u32 v11, 0x10000, v10
    v_add_u32 v12, 0x20000, v10
    s_waitcnt vmcnt(12)
    s_barrier
    ds_read_b128 a[0:3], v6 offset:0
    ds_read_b128 a[4:7], v7 offset:0
    ds_read_b128 a[8:11], v8 offset:0
    ds_read_b128 a[12:15], v9 offset:0
    ds_read_b128 a[16:19], v6 offset:4096
    ds_read_b128 a[20:23], v7 offset:4096
    ds_read_b128 a[24:27], v8 offset:4096
    ds_read_b128 a[28:31], v9 offset:4096
    ds_read_b64_tr_b16 v[108:109], v164 offset:0
    ds_read_b64_tr_b16 v[110:111], v164 offset:512
    ds_read_b64_tr_b16 v[112:113], v167 offset:0
    ds_read_b64_tr_b16 v[114:115], v167 offset:512
    ds_read_b64_tr_b16 v[116:117], v164 offset:2048
    ds_read_b64_tr_b16 v[118:119], v164 offset:2560
    ds_read_b64_tr_b16 v[120:121], v167 offset:2048
    ds_read_b64_tr_b16 v[122:123], v167 offset:2560
    ds_read_b64_tr_b16 v[124:125], v164 offset:4096
    ds_read_b64_tr_b16 v[126:127], v164 offset:4608
    ds_read_b64_tr_b16 v[128:129], v167 offset:4096
    ds_read_b64_tr_b16 v[130:131], v167 offset:4608
    ds_read_b64_tr_b16 v[132:133], v164 offset:6144
    ds_read_b64_tr_b16 v[134:135], v164 offset:6656
    v_mov_b32 v20, v16
    s_nop 1
    v_mfma_f32_32x32x16_bf16 v[44:59], v[20:23], v[24:27], 0
    s_waitcnt lgkmcnt(6)
    v_mfma_f32_32x32x16_bf16 v[44:59], v[108:111], a[0:3], v[44:59]
    ds_read_b64_tr_b16 v[136:137], v167 offset:6144
    ds_read_b64_tr_b16 v[138:139], v167 offset:6656
    s_add_u32 m0, s46, 15872
    s_nop 0
    buffer_load_dwordx4 v2, s[8:11], s50 offen offset:512 lds
    s_add_u32 m0, s46, 16896
    s_nop 0
    buffer_load_dwordx4 v3, s[8:11], s51 offen offset:512 lds
    v_mov_b32 v20, v17
    s_nop 1
    v_mfma_f32_32x32x16_bf16 v[60:75], v[20:23], v[24:27], 0
    v_mfma_f32_32x32x16_bf16 v[60:75], v[112:115], a[0:3], v[60:75]
    ds_read_b64_tr_b16 v[108:109], v164 offset:8192
    ds_read_b64_tr_b16 v[110:111], v164 offset:8704
    s_add_u32 m0, s46, 17920
    s_nop 0
    buffer_load_dwordx4 v2, s[8:11], s52 offen offset:512 lds
    s_add_u32 m0, s46, 18944
    s_nop 0
    buffer_load_dwordx4 v3, s[8:11], s53 offen offset:512 lds
    v_mfma_f32_32x32x16_bf16 v[44:59], v[116:119], a[4:7], v[44:59]
    ds_read_b64_tr_b16 v[112:113], v167 offset:8192
    ds_read_b64_tr_b16 v[114:115], v167 offset:8704
    s_add_u32 m0, s46, 19840
    s_nop 0
    buffer_load_dwordx4 v2, s[8:11], s50 offen offset:640 lds
    s_add_u32 m0, s46, 20864
    s_nop 0
    buffer_load_dwordx4 v3, s[8:11], s51 offen offset:640 lds
    s_add_u32 s64, s70, 0
    s_lshr_b32 s48, s64, 4
    s_cmp_ge_u32 s48, 112
    s_cselect_b32 s40, s36, s32
    s_cselect_b32 s41, s37, s33
    s_cselect_b32 s42, s38, s34
    s_mov_b32 s43, 0x00020000
    s_cselect_b32 s49, 112, 0
    s_sub_u32 s48, s48, s49
    s_lshl_b32 s48, s48, 14
    s_and_b32 s49, s64, 15
    s_lshl_b32 s49, s49, 6
    s_add_u32 s65, s48, s49
    s_add_u32 s66, s65, 8192
    s_lshl_b32 s67, s64, 10
    s_add_u32 s67, s67, 2359296
    v_mfma_f32_32x32x16_bf16 v[60:75], v[120:123], a[4:7], v[60:75]
    ds_read_b64_tr_b16 v[116:117], v164 offset:10240
    ds_read_b64_tr_b16 v[118:119], v164 offset:10752
    s_add_u32 m0, s46, 21888
    s_nop 0
    buffer_load_dwordx4 v2, s[8:11], s52 offen offset:640 lds
    s_add_u32 m0, s46, 22912
    s_nop 0
    buffer_load_dwordx4 v3, s[8:11], s53 offen offset:640 lds
    buffer_load_ushort v92, v14, s[40:43], s65 offen
    s_waitcnt lgkmcnt(6)
    v_mfma_f32_32x32x16_bf16 v[44:59], v[124:127], a[8:11], v[44:59]
    ds_read_b64_tr_b16 v[120:121], v167 offset:10240
    ds_read_b64_tr_b16 v[122:123], v167 offset:10752
    s_add_u32 s54, s55, s59
    s_add_u32 s54, s54, 917504
    s_add_u32 m0, s46, 24576
    s_nop 0
    buffer_load_dwordx4 v170, s[12:15], s54 offen lds
    s_add_u32 s54, s54, 28672
    s_add_u32 m0, s46, 25600
    s_nop 0
    buffer_load_dwordx4 v170, s[12:15], s54 offen lds
    buffer_load_ushort v93, v14, s[40:43], s65 offen offset:1024
    v_mfma_f32_32x32x16_bf16 v[60:75], v[128:131], a[8:11], v[60:75]
    ds_read_b64_tr_b16 v[124:125], v164 offset:12288
    ds_read_b64_tr_b16 v[126:127], v164 offset:12800
    s_add_u32 s54, s54, 28672
    s_add_u32 m0, s46, 26624
    s_nop 0
    buffer_load_dwordx4 v170, s[12:15], s54 offen lds
    s_add_u32 s54, s54, 28672
    s_add_u32 m0, s46, 27648
    s_nop 0
    buffer_load_dwordx4 v170, s[12:15], s54 offen lds
    buffer_load_ushort v94, v14, s[40:43], s65 offen offset:2048
    v_mfma_f32_32x32x16_bf16 v[44:59], v[132:135], a[12:15], v[44:59]
    ds_read_b64_tr_b16 v[128:129], v167 offset:12288
    ds_read_b64_tr_b16 v[130:131], v167 offset:12800
    s_sub_u32 m0, s46, 768
    s_nop 0
    buffer_load_dwordx4 v2, s[8:11], s50 offen offset:768 lds
    s_add_u32 m0, s46, 256
    s_nop 0
    buffer_load_dwordx4 v3, s[8:11], s51 offen offset:768 lds
    buffer_load_ushort v95, v14, s[40:43], s65 offen offset:3072
    v_mfma_f32_32x32x16_bf16 v[60:75], v[136:139], a[12:15], v[60:75]
    ds_read_b64_tr_b16 v[132:133], v164 offset:14336
    ds_read_b64_tr_b16 v[134:135], v164 offset:14848
    s_add_u32 m0, s46, 1280
    s_nop 0
    buffer_load_dwordx4 v2, s[8:11], s52 offen offset:768 lds
    s_add_u32 m0, s46, 2304
    s_nop 0
    buffer_load_dwordx4 v3, s[8:11], s53 offen offset:768 lds
    buffer_load_ushort v96, v14, s[40:43], s66 offen
    s_waitcnt lgkmcnt(6)
    v_mfma_f32_32x32x16_bf16 v[44:59], v[108:111], a[16:19], v[44:59]
    ds_read_b64_tr_b16 v[136:137], v167 offset:14336
    ds_read_b64_tr_b16 v[138:139], v167 offset:14848
    s_add_u32 m0, s46, 3200
    s_nop 0
    buffer_load_dwordx4 v2, s[8:11], s50 offen offset:896 lds
    s_add_u32 m0, s46, 4224
    s_nop 0
    buffer_load_dwordx4 v3, s[8:11], s51 offen offset:896 lds
    buffer_load_ushort v97, v14, s[40:43], s66 offen offset:1024
    s_waitcnt vmcnt(24)
    s_barrier
    ds_read_b128 a[32:35], v6 offset:8192
    ds_read_b128 a[36:39], v7 offset:8192
    ds_read_b128 a[40:43], v8 offset:8192
    ds_read_b128 a[44:47], v9 offset:8192
    ds_read_b128 a[48:51], v6 offset:12288
    ds_read_b128 a[52:55], v7 offset:12288
    ds_read_b128 a[56:59], v8 offset:12288
    ds_read_b128 a[60:63], v9 offset:12288
    v_mfma_f32_32x32x16_bf16 v[60:75], v[112:115], a[16:19], v[60:75]
    ds_read_b64_tr_b16 v[108:109], v164 offset:16384
    ds_read_b64_tr_b16 v[110:111], v164 offset:16896
    s_add_u32 m0, s46, 5248
    s_nop 0
    buffer_load_dwordx4 v2, s[8:11], s52 offen offset:896 lds
    s_add_u32 m0, s46, 6272
    s_nop 0
    buffer_load_dwordx4 v3, s[8:11], s53 offen offset:896 lds
    buffer_load_ushort v98, v14, s[40:43], s66 offen offset:2048
    v_mfma_f32_32x32x16_bf16 v[44:59], v[116:119], a[20:23], v[44:59]
    ds_read_b64_tr_b16 v[112:113], v167 offset:16384
    ds_read_b64_tr_b16 v[114:115], v167 offset:16896
    s_add_u32 s54, s55, s59
    s_add_u32 s54, s54, 1376256
    s_add_u32 m0, s46, 28672
    s_nop 0
    buffer_load_dwordx4 v170, s[12:15], s54 offen lds
    s_add_u32 s54, s54, 28672
    s_add_u32 m0, s46, 29696
    s_nop 0
    buffer_load_dwordx4 v170, s[12:15], s54 offen lds
    buffer_load_ushort v99, v14, s[40:43], s66 offen offset:3072
    v_mfma_f32_32x32x16_bf16 v[60:75], v[120:123], a[20:23], v[60:75]
    ds_read_b64_tr_b16 v[116:117], v164 offset:18432
    ds_read_b64_tr_b16 v[118:119], v164 offset:18944
    s_add_u32 s54, s54, 28672
    s_add_u32 m0, s46, 30720
    s_nop 0
    buffer_load_dwordx4 v170, s[12:15], s54 offen lds
    s_add_u32 s54, s54, 28672
    s_add_u32 m0, s46, 31744
    s_nop 0
    buffer_load_dwordx4 v170, s[12:15], s54 offen lds
    s_waitcnt lgkmcnt(14)
    v_mfma_f32_32x32x16_bf16 v[44:59], v[124:127], a[24:27], v[44:59]
    ds_read_b64_tr_b16 v[120:121], v167 offset:18432
    ds_read_b64_tr_b16 v[122:123], v167 offset:18944
    v_mfma_f32_32x32x16_bf16 v[60:75], v[128:131], a[24:27], v[60:75]
    ds_read_b64_tr_b16 v[124:125], v164 offset:20480
    ds_read_b64_tr_b16 v[126:127], v164 offset:20992
    v_mfma_f32_32x32x16_bf16 v[44:59], v[132:135], a[28:31], v[44:59]
    ds_read_b64_tr_b16 v[128:129], v167 offset:20480
    ds_read_b64_tr_b16 v[130:131], v167 offset:20992
    v_mfma_f32_32x32x16_bf16 v[60:75], v[136:139], a[28:31], v[60:75]
    ds_read_b64_tr_b16 v[132:133], v164 offset:22528
    ds_read_b64_tr_b16 v[134:135], v164 offset:23040
    s_waitcnt lgkmcnt(6)
    v_mfma_f32_32x32x16_bf16 v[44:59], v[108:111], a[32:35], v[44:59]
    ds_read_b64_tr_b16 v[136:137], v167 offset:22528
    ds_read_b64_tr_b16 v[138:139], v167 offset:23040
    s_add_u32 s54, s73, s71
    s_add_u32 m0, s46, 8192
    s_nop 0
    buffer_load_dwordx4 v170, s[12:15], s54 offen lds
    s_add_u32 s54, s54, 28672
    s_add_u32 m0, s46, 9216
    s_nop 0
    buffer_load_dwordx4 v170, s[12:15], s54 offen lds
    v_mfma_f32_32x32x16_bf16 v[60:75], v[112:115], a[32:35], v[60:75]
    ds_read_b64_tr_b16 v[108:109], v164 offset:24576
    ds_read_b64_tr_b16 v[110:111], v164 offset:25088
    s_add_u32 s54, s54, 28672
    s_add_u32 m0, s46, 10240
    s_nop 0
    buffer_load_dwordx4 v170, s[12:15], s54 offen lds
    s_add_u32 s54, s54, 28672
    s_add_u32 m0, s46, 11264
    s_nop 0
    buffer_load_dwordx4 v170, s[12:15], s54 offen lds
    v_mfma_f32_32x32x16_bf16 v[44:59], v[116:119], a[36:39], v[44:59]
    ds_read_b64_tr_b16 v[112:113], v167 offset:24576
    ds_read_b64_tr_b16 v[114:115], v167 offset:25088
    s_add_u32 s54, s54, 28672
    s_add_u32 m0, s46, 12288
    s_nop 0
    buffer_load_dwordx4 v170, s[12:15], s54 offen lds
    s_add_u32 s54, s54, 28672
    s_add_u32 m0, s46, 13312
    s_nop 0
    buffer_load_dwordx4 v170, s[12:15], s54 offen lds
    v_mfma_f32_32x32x16_bf16 v[60:75], v[120:123], a[36:39], v[60:75]
    ds_read_b64_tr_b16 v[116:117], v164 offset:26624
    ds_read_b64_tr_b16 v[118:119], v164 offset:27136
    s_add_u32 s54, s54, 28672
    s_add_u32 m0, s46, 14336
    s_nop 0
    buffer_load_dwordx4 v170, s[12:15], s54 offen lds
    s_add_u32 s54, s54, 28672
    s_add_u32 m0, s46, 15360
    s_nop 0
    buffer_load_dwordx4 v170, s[12:15], s54 offen lds
    s_waitcnt lgkmcnt(6)
    v_mfma_f32_32x32x16_bf16 v[44:59], v[124:127], a[40:43], v[44:59]
    ds_read_b64_tr_b16 v[120:121], v167 offset:26624
    ds_read_b64_tr_b16 v[122:123], v167 offset:27136
    v_mfma_f32_32x32x16_bf16 v[60:75], v[128:131], a[40:43], v[60:75]
    ds_read_b64_tr_b16 v[124:125], v164 offset:28672
    ds_read_b64_tr_b16 v[126:127], v164 offset:29184
    v_mfma_f32_32x32x16_bf16 v[44:59], v[132:135], a[44:47], v[44:59]
    ds_read_b64_tr_b16 v[128:129], v167 offset:28672
    ds_read_b64_tr_b16 v[130:131], v167 offset:29184
    s_waitcnt vmcnt(10)
    v_lshl_or_b32 v100, v93, 16, v92
    v_lshl_or_b32 v101, v95, 16, v94
    v_lshl_or_b32 v102, v97, 16, v96
    v_lshl_or_b32 v103, v99, 16, v98
    buffer_store_dwordx4 v[100:103], v1, s[20:23], s67 offen sc0 sc1
    s_add_u32 s64, s70, 1024
    s_lshr_b32 s48, s64, 4
    s_cmp_ge_u32 s48, 112
    s_cselect_b32 s40, s36, s32
    s_cselect_b32 s41, s37, s33
    s_cselect_b32 s42, s38, s34
    s_mov_b32 s43, 0x00020000
    s_cselect_b32 s49, 112, 0
    s_sub_u32 s48, s48, s49
    s_lshl_b32 s48, s48, 14
    s_and_b32 s49, s64, 15
    s_lshl_b32 s49, s49, 6
    s_add_u32 s65, s48, s49
    s_add_u32 s66, s65, 8192
    s_lshl_b32 s67, s64, 10
    s_add_u32 s67, s67, 2359296
    v_mfma_f32_32x32x16_bf16 v[60:75], v[136:139], a[44:47], v[60:75]
    ds_read_b64_tr_b16 v[132:133], v164 offset:30720
    ds_read_b64_tr_b16 v[134:135], v164 offset:31232
    buffer_load_ushort v92, v14, s[40:43], s65 offen
    s_waitcnt lgkmcnt(6)
    v_mfma_f32_32x32x16_bf16 v[44:59], v[108:111], a[48:51], v[44:59]
    ds_read_b64_tr_b16 v[136:137], v167 offset:30720
    ds_read_b64_tr_b16 v[138:139], v167 offset:31232
    buffer_load_ushort v93, v14, s[40:43], s65 offen offset:1024
    s_barrier
    ds_read_b128 a[64:67], v6 offset:16384
    ds_read_b128 a[68:71], v7 offset:16384
    ds_read_b128 a[72:75], v8 offset:16384
    ds_read_b128 a[76:79], v9 offset:16384
    ds_read_b128 a[80:83], v6 offset:20480
    ds_read_b128 a[84:87], v7 offset:20480
    ds_read_b128 a[88:91], v8 offset:20480
    ds_read_b128 a[92:95], v9 offset:20480
    v_mfma_f32_32x32x16_bf16 v[60:75], v[112:115], a[48:51], v[60:75]
    ds_read_b64_tr_b16 v[108:109], v164 offset:57344
    ds_read_b64_tr_b16 v[110:111], v164 offset:57856
    buffer_load_ushort v94, v14, s[40:43], s65 offen offset:2048
    v_mfma_f32_32x32x16_bf16 v[44:59], v[116:119], a[52:55], v[44:59]
    ds_read_b64_tr_b16 v[112:113], v167 offset:57344
    ds_read_b64_tr_b16 v[114:115], v167 offset:57856
    buffer_load_ushort v95, v14, s[40:43], s65 offen offset:3072
    v_mfma_f32_32x32x16_bf16 v[60:75], v[120:123], a[52:55], v[60:75]
    ds_read_b64_tr_b16 v[116:117], v164 offset:59392
    ds_read_b64_tr_b16 v[118:119], v164 offset:59904
    buffer_load_ushort v96, v14, s[40:43], s66 offen
    s_waitcnt lgkmcnt(14)
    v_mfma_f32_32x32x16_bf16 v[44:59], v[124:127], a[56:59], v[44:59]
    ds_read_b64_tr_b16 v[120:121], v167 offset:59392
    ds_read_b64_tr_b16 v[122:123], v167 offset:59904
    buffer_load_ushort v97, v14, s[40:43], s66 offen offset:1024
    v_mfma_f32_32x32x16_bf16 v[60:75], v[128:131], a[56:59], v[60:75]
    ds_read_b64_tr_b16 v[124:125], v165 offset:24576
    ds_read_b64_tr_b16 v[126:127], v165 offset:25088
    buffer_load_ushort v98, v14, s[40:43], s66 offen offset:2048
    v_mfma_f32_32x32x16_bf16 v[44:59], v[132:135], a[60:63], v[44:59]
    ds_read_b64_tr_b16 v[128:129], v168 offset:24576
    ds_read_b64_tr_b16 v[130:131], v168 offset:25088
    buffer_load_ushort v99, v14, s[40:43], s66 offen offset:3072
    v_mfma_f32_32x32x16_bf16 v[60:75], v[136:139], a[60:63], v[60:75]
    ds_read_b64_tr_b16 v[132:133], v165 offset:26624
    ds_read_b64_tr_b16 v[134:135], v165 offset:27136
    s_waitcnt lgkmcnt(6)
    v_mfma_f32_32x32x16_bf16 v[44:59], v[108:111], a[64:67], v[44:59]
    ds_read_b64_tr_b16 v[136:137], v168 offset:26624
    ds_read_b64_tr_b16 v[138:139], v168 offset:27136
    s_add_u32 s54, s54, 28672
    s_add_u32 m0, s46, 16384
    s_nop 0
    buffer_load_dwordx4 v170, s[12:15], s54 offen lds
    s_add_u32 s54, s54, 28672
    s_add_u32 m0, s46, 17408
    s_nop 0
    buffer_load_dwordx4 v170, s[12:15], s54 offen lds
    v_mfma_f32_32x32x16_bf16 v[60:75], v[112:115], a[64:67], v[60:75]
    ds_read_b64_tr_b16 v[108:109], v165 offset:57344
    ds_read_b64_tr_b16 v[110:111], v165 offset:57856
    s_add_u32 s54, s54, 28672
    s_add_u32 m0, s46, 18432
    s_nop 0
    buffer_load_dwordx4 v170, s[12:15], s54 offen lds
    s_add_u32 s54, s54, 28672
    s_add_u32 m0, s46, 19456
    s_nop 0
    buffer_load_dwordx4 v170, s[12:15], s54 offen lds
    v_mfma_f32_32x32x16_bf16 v[44:59], v[116:119], a[68:71], v[44:59]
    ds_read_b64_tr_b16 v[112:113], v168 offset:57344
    ds_read_b64_tr_b16 v[114:115], v168 offset:57856
    s_add_u32 s54, s54, 28672
    s_add_u32 m0, s46, 20480
    s_nop 0
    buffer_load_dwordx4 v170, s[12:15], s54 offen lds
    s_add_u32 s54, s54, 28672
    s_add_u32 m0, s46, 21504
    s_nop 0
    buffer_load_dwordx4 v170, s[12:15], s54 offen lds
    v_mfma_f32_32x32x16_bf16 v[60:75], v[120:123], a[68:71], v[60:75]
    ds_read_b64_tr_b16 v[116:117], v165 offset:59392
    ds_read_b64_tr_b16 v[118:119], v165 offset:59904
    s_add_u32 s54, s54, 28672
    s_add_u32 m0, s46, 22528
    s_nop 0
    buffer_load_dwordx4 v170, s[12:15], s54 offen lds
    s_add_u32 s54, s54, 28672
    s_add_u32 m0, s46, 23552
    s_nop 0
    buffer_load_dwordx4 v170, s[12:15], s54 offen lds
    s_waitcnt lgkmcnt(6)
    v_mfma_f32_32x32x16_bf16 v[44:59], v[124:127], a[72:75], v[44:59]
    ds_read_b64_tr_b16 v[120:121], v168 offset:59392
    ds_read_b64_tr_b16 v[122:123], v168 offset:59904
    v_mfma_f32_32x32x16_bf16 v[60:75], v[128:131], a[72:75], v[60:75]
    ds_read_b64_tr_b16 v[124:125], v166 offset:24576
    ds_read_b64_tr_b16 v[126:127], v166 offset:25088
    v_mfma_f32_32x32x16_bf16 v[44:59], v[132:135], a[76:79], v[44:59]
    ds_read_b64_tr_b16 v[128:129], v169 offset:24576
    ds_read_b64_tr_b16 v[130:131], v169 offset:25088
    v_mfma_f32_32x32x16_bf16 v[60:75], v[136:139], a[76:79], v[60:75]
    ds_read_b64_tr_b16 v[132:133], v166 offset:26624
    ds_read_b64_tr_b16 v[134:135], v166 offset:27136
    s_waitcnt lgkmcnt(6)
    v_mfma_f32_32x32x16_bf16 v[44:59], v[108:111], a[80:83], v[44:59]
    ds_read_b64_tr_b16 v[136:137], v169 offset:26624
    ds_read_b64_tr_b16 v[138:139], v169 offset:27136
    s_waitcnt vmcnt(25)
    s_barrier
    ds_read_b128 a[96:99], v6 offset:0
    ds_read_b128 a[100:103], v7 offset:0
    ds_read_b128 a[104:107], v8 offset:0
    ds_read_b128 a[108:111], v9 offset:0
    ds_read_b128 a[112:115], v6 offset:4096
    ds_read_b128 a[116:119], v7 offset:4096
    ds_read_b128 a[120:123], v8 offset:4096
    ds_read_b128 a[124:127], v9 offset:4096
    v_mfma_f32_32x32x16_bf16 v[60:75], v[112:115], a[80:83], v[60:75]
    ds_read_b64_tr_b16 v[108:109], v164 offset:61440
    ds_read_b64_tr_b16 v[110:111], v164 offset:61952
    v_mfma_f32_32x32x16_bf16 v[44:59], v[116:119], a[84:87], v[44:59]
    ds_read_b64_tr_b16 v[112:113], v167 offset:61440
    ds_read_b64_tr_b16 v[114:115], v167 offset:61952
    s_waitcnt vmcnt(8)
    v_lshl_or_b32 v100, v93, 16, v92
    v_lshl_or_b32 v101, v95, 16, v94
    v_lshl_or_b32 v102, v97, 16, v96
    v_lshl_or_b32 v103, v99, 16, v98
    buffer_store_dwordx4 v[100:103], v1, s[20:23], s67 offen sc0 sc1
    v_mfma_f32_32x32x16_bf16 v[60:75], v[120:123], a[84:87], v[60:75]
    ds_read_b64_tr_b16 v[116:117], v164 offset:63488
    ds_read_b64_tr_b16 v[118:119], v164 offset:64000
    s_waitcnt lgkmcnt(14)
    v_mfma_f32_32x32x16_bf16 v[44:59], v[124:127], a[88:91], v[44:59]
    ds_read_b64_tr_b16 v[120:121], v167 offset:63488
    ds_read_b64_tr_b16 v[122:123], v167 offset:64000
    v_mfma_f32_32x32x16_bf16 v[60:75], v[128:131], a[88:91], v[60:75]
    ds_read_b64_tr_b16 v[124:125], v165 offset:28672
    ds_read_b64_tr_b16 v[126:127], v165 offset:29184
    v_mfma_f32_32x32x16_bf16 v[44:59], v[132:135], a[92:95], v[44:59]
    ds_read_b64_tr_b16 v[128:129], v168 offset:28672
    ds_read_b64_tr_b16 v[130:131], v168 offset:29184
    v_mfma_f32_32x32x16_bf16 v[60:75], v[136:139], a[92:95], v[60:75]
    ds_read_b64_tr_b16 v[132:133], v165 offset:30720
    ds_read_b64_tr_b16 v[134:135], v165 offset:31232
    s_waitcnt lgkmcnt(6)
    v_mfma_f32_32x32x16_bf16 v[44:59], v[108:111], a[96:99], v[44:59]
    ds_read_b64_tr_b16 v[136:137], v168 offset:30720
    ds_read_b64_tr_b16 v[138:139], v168 offset:31232
    s_mov_b32 m0, s46
    s_lshl_b32 s54, s44, 12
    buffer_load_dwordx4 v1, s[28:31], s54 offen lds
    s_add_u32 m0, s46, 1024
    s_add_u32 s54, s54, 1024
    buffer_load_dwordx4 v1, s[28:31], s54 offen lds
    v_mfma_f32_32x32x16_bf16 v[60:75], v[112:115], a[96:99], v[60:75]
    ds_read_b64_tr_b16 v[108:109], v165 offset:61440
    ds_read_b64_tr_b16 v[110:111], v165 offset:61952
    s_add_u32 m0, s46, 2048
    s_add_u32 s54, s54, 1024
    buffer_load_dwordx4 v1, s[28:31], s54 offen lds
    s_add_u32 m0, s46, 3072
    s_add_u32 s54, s54, 1024
    buffer_load_dwordx4 v1, s[28:31], s54 offen lds
    v_mfma_f32_32x32x16_bf16 v[44:59], v[116:119], a[100:103], v[44:59]
    ds_read_b64_tr_b16 v[112:113], v168 offset:61440
    ds_read_b64_tr_b16 v[114:115], v168 offset:61952
    v_mfma_f32_32x32x16_bf16 v[60:75], v[120:123], a[100:103], v[60:75]
    ds_read_b64_tr_b16 v[116:117], v165 offset:63488
    ds_read_b64_tr_b16 v[118:119], v165 offset:64000
    s_waitcnt lgkmcnt(6)
    v_mfma_f32_32x32x16_bf16 v[44:59], v[124:127], a[104:107], v[44:59]
    ds_read_b64_tr_b16 v[120:121], v168 offset:63488
    ds_read_b64_tr_b16 v[122:123], v168 offset:64000
    v_mfma_f32_32x32x16_bf16 v[60:75], v[128:131], a[104:107], v[60:75]
    ds_read_b64_tr_b16 v[124:125], v166 offset:28672
    ds_read_b64_tr_b16 v[126:127], v166 offset:29184
    v_mfma_f32_32x32x16_bf16 v[44:59], v[132:135], a[108:111], v[44:59]
    ds_read_b64_tr_b16 v[128:129], v169 offset:28672
    ds_read_b64_tr_b16 v[130:131], v169 offset:29184
    v_mfma_f32_32x32x16_bf16 v[60:75], v[136:139], a[108:111], v[60:75]
    ds_read_b64_tr_b16 v[132:133], v166 offset:30720
    ds_read_b64_tr_b16 v[134:135], v166 offset:31232
    s_waitcnt lgkmcnt(6)
    v_mfma_f32_32x32x16_bf16 v[44:59], v[108:111], a[112:115], v[44:59]
    ds_read_b64_tr_b16 v[136:137], v169 offset:30720
    ds_read_b64_tr_b16 v[138:139], v169 offset:31232
    s_waitcnt vmcnt(5)
    s_barrier
    v_mfma_f32_32x32x16_bf16 v[60:75], v[112:115], a[112:115], v[60:75]
    ds_read_b64_tr_b16 v[108:109], v164 offset:40960
    ds_read_b64_tr_b16 v[110:111], v164 offset:41472
    v_mfma_f32_32x32x16_bf16 v[44:59], v[116:119], a[116:119], v[44:59]
    ds_read_b64_tr_b16 v[112:113], v164 offset:43008
    ds_read_b64_tr_b16 v[114:115], v164 offset:43520
    v_mfma_f32_32x32x16_bf16 v[60:75], v[120:123], a[116:119], v[60:75]
    ds_read_b64_tr_b16 v[116:117], v164 offset:45056
    ds_read_b64_tr_b16 v[118:119], v164 offset:45568
    s_waitcnt lgkmcnt(6)
    v_mfma_f32_32x32x16_bf16 v[44:59], v[124:127], a[120:123], v[44:59]
    ds_read_b64_tr_b16 v[120:121], v164 offset:47104
    ds_read_b64_tr_b16 v[122:123], v164 offset:47616
    v_mfma_f32_32x32x16_bf16 v[60:75], v[128:131], a[120:123], v[60:75]
    ds_read_b64_tr_b16 v[124:125], v164 offset:49152
    ds_read_b64_tr_b16 v[126:127], v164 offset:49664
    v_mfma_f32_32x32x16_bf16 v[44:59], v[132:135], a[124:127], v[44:59]
    ds_read_b64_tr_b16 v[128:129], v164 offset:51200
    ds_read_b64_tr_b16 v[130:131], v164 offset:51712
    v_mfma_f32_32x32x16_bf16 v[60:75], v[136:139], a[124:127], v[60:75]
    ds_read_b64_tr_b16 v[132:133], v164 offset:53248
    ds_read_b64_tr_b16 v[134:135], v164 offset:53760
    v_mov_b32 v20, v18
    s_nop 1
    v_mfma_f32_32x32x16_bf16 v[140:155], v[20:23], v[24:27], 0
    s_waitcnt lgkmcnt(6)
    v_mfma_f32_32x32x16_bf16 v[140:155], v[108:111], a[0:3], v[140:155]
    ds_read_b64_tr_b16 v[136:137], v164 offset:55296
    ds_read_b64_tr_b16 v[138:139], v164 offset:55808
    v_mul_f32 v84, s60, v44
    v_mul_f32 v85, s60, v45
    v_exp_f32 v84, v84
    v_mfma_f32_32x32x16_bf16 v[140:155], v[112:115], a[4:7], v[140:155]
    ds_read_b64_tr_b16 v[108:109], v165 offset:8192
    ds_read_b64_tr_b16 v[110:111], v165 offset:8704
    v_exp_f32 v85, v85
    v_fma_f32 v86, v84, -0.5, -1.0
    v_fma_f32 v87, v85, -0.5, -1.0
    v_fma_f32 v86, v84, v86, -1.0
    v_mfma_f32_32x32x16_bf16 v[140:155], v[116:119], a[8:11], v[140:155]
    ds_read_b64_tr_b16 v[112:113], v165 offset:10240
    ds_read_b64_tr_b16 v[114:115], v165 offset:10752
    v_fma_f32 v87, v85, v87, -1.0
    v_rcp_f32 v86, v86
    v_rcp_f32 v87, v87
    v_mfma_f32_32x32x16_bf16 v[140:155], v[120:123], a[12:15], v[140:155]
    ds_read_b64_tr_b16 v[116:117], v165 offset:12288
    ds_read_b64_tr_b16 v[118:119], v165 offset:12800
    v_fma_f32 v86, v44, v86, v44
    v_fma_f32 v87, v45, v87, v45
    v_cvt_pk_bf16_f32 v76, v86, v87
    s_waitcnt lgkmcnt(6)
    v_mfma_f32_32x32x16_bf16 v[140:155], v[124:127], a[16:19], v[140:155]
    ds_read_b64_tr_b16 v[120:121], v165 offset:14336
    ds_read_b64_tr_b16 v[122:123], v165 offset:14848
    v_mul_f32 v88, s60, v46
    v_mul_f32 v89, s60, v47
    v_exp_f32 v88, v88
    v_mfma_f32_32x32x16_bf16 v[140:155], v[128:131], a[20:23], v[140:155]
    ds_read_b64_tr_b16 v[124:125], v165 offset:16384
    ds_read_b64_tr_b16 v[126:127], v165 offset:16896
    v_exp_f32 v89, v89
    v_fma_f32 v90, v88, -0.5, -1.0
    v_fma_f32 v91, v89, -0.5, -1.0
    v_fma_f32 v90, v88, v90, -1.0
    v_mfma_f32_32x32x16_bf16 v[140:155], v[132:135], a[24:27], v[140:155]
    ds_read_b64_tr_b16 v[128:129], v165 offset:18432
    ds_read_b64_tr_b16 v[130:131], v165 offset:18944
    v_fma_f32 v91, v89, v91, -1.0
    v_rcp_f32 v90, v90
    v_rcp_f32 v91, v91
    v_mfma_f32_32x32x16_bf16 v[140:155], v[136:139], a[28:31], v[140:155]
    ds_read_b64_tr_b16 v[132:133], v165 offset:20480
    ds_read_b64_tr_b16 v[134:135], v165 offset:20992
    v_fma_f32 v90, v46, v90, v46
    v_fma_f32 v91, v47, v91, v47
    v_cvt_pk_bf16_f32 v77, v90, v91
    s_waitcnt lgkmcnt(6)
    v_mfma_f32_32x32x16_bf16 v[140:155], v[108:111], a[32:35], v[140:155]
    ds_read_b64_tr_b16 v[136:137], v165 offset:22528
    ds_read_b64_tr_b16 v[138:139], v165 offset:23040
    v_mul_f32 v84, s60, v48
    v_mul_f32 v85, s60, v49
    v_exp_f32 v84, v84
    v_mfma_f32_32x32x16_bf16 v[140:155], v[112:115], a[36:39], v[140:155]
    ds_read_b64_tr_b16 v[108:109], v165 offset:40960
    ds_read_b64_tr_b16 v[110:111], v165 offset:41472
    v_exp_f32 v85, v85
    v_fma_f32 v86, v84, -0.5, -1.0
    v_fma_f32 v87, v85, -0.5, -1.0
    v_fma_f32 v86, v84, v86, -1.0
    v_mfma_f32_32x32x16_bf16 v[140:155], v[116:119], a[40:43], v[140:155]
    ds_read_b64_tr_b16 v[112:113], v165 offset:43008
    ds_read_b64_tr_b16 v[114:115], v165 offset:43520
    v_fma_f32 v87, v85, v87, -1.0
    v_rcp_f32 v86, v86
    v_rcp_f32 v87, v87
    v_mfma_f32_32x32x16_bf16 v[140:155], v[120:123], a[44:47], v[140:155]
    ds_read_b64_tr_b16 v[116:117], v165 offset:45056
    ds_read_b64_tr_b16 v[118:119], v165 offset:45568
    v_fma_f32 v86, v48, v86, v48
    v_fma_f32 v87, v49, v87, v49
    v_cvt_pk_bf16_f32 v78, v86, v87
    s_waitcnt lgkmcnt(6)
    v_mfma_f32_32x32x16_bf16 v[140:155], v[124:127], a[48:51], v[140:155]
    ds_read_b64_tr_b16 v[120:121], v165 offset:47104
    ds_read_b64_tr_b16 v[122:123], v165 offset:47616
    v_mul_f32 v88, s60, v50
    v_mul_f32 v89, s60, v51
    v_exp_f32 v88, v88
    v_mfma_f32_32x32x16_bf16 v[140:155], v[128:131], a[52:55], v[140:155]
    ds_read_b64_tr_b16 v[124:125], v165 offset:49152
    ds_read_b64_tr_b16 v[126:127], v165 offset:49664
    v_exp_f32 v89, v89
    v_fma_f32 v90, v88, -0.5, -1.0
    v_fma_f32 v91, v89, -0.5, -1.0
    v_fma_f32 v90, v88, v90, -1.0
    v_mfma_f32_32x32x16_bf16 v[140:155], v[132:135], a[56:59], v[140:155]
    ds_read_b64_tr_b16 v[128:129], v165 offset:51200
    ds_read_b64_tr_b16 v[130:131], v165 offset:51712
    v_fma_f32 v91, v89, v91, -1.0
    v_rcp_f32 v90, v90
    v_rcp_f32 v91, v91
    v_mfma_f32_32x32x16_bf16 v[140:155], v[136:139], a[60:63], v[140:155]
    ds_read_b64_tr_b16 v[132:133], v165 offset:53248
    ds_read_b64_tr_b16 v[134:135], v165 offset:53760
    v_fma_f32 v90, v50, v90, v50
    v_fma_f32 v91, v51, v91, v51
    v_cvt_pk_bf16_f32 v79, v90, v91
    s_add_u32 s69, s57, 0
    buffer_store_dwordx4 v[76:79], v1, s[20:23], s69 offen sc0 sc1
    s_waitcnt lgkmcnt(6)
    v_mfma_f32_32x32x16_bf16 v[140:155], v[108:111], a[64:67], v[140:155]
    ds_read_b64_tr_b16 v[136:137], v165 offset:55296
    ds_read_b64_tr_b16 v[138:139], v165 offset:55808
    v_mul_f32 v84, s60, v52
    v_mul_f32 v85, s60, v53
    v_exp_f32 v84, v84
    v_mfma_f32_32x32x16_bf16 v[140:155], v[112:115], a[68:71], v[140:155]
    ds_read_b64_tr_b16 v[108:109], v166 offset:8192
    ds_read_b64_tr_b16 v[110:111], v166 offset:8704
    v_exp_f32 v85, v85
    v_fma_f32 v86, v84, -0.5, -1.0
    v_fma_f32 v87, v85, -0.5, -1.0
    v_fma_f32 v86, v84, v86, -1.0
    v_mfma_f32_32x32x16_bf16 v[140:155], v[116:119], a[72:75], v[140:155]
    ds_read_b64_tr_b16 v[112:113], v166 offset:10240
    ds_read_b64_tr_b16 v[114:115], v166 offset:10752
    v_fma_f32 v87, v85, v87, -1.0
    v_rcp_f32 v86, v86
    v_rcp_f32 v87, v87
    v_mfma_f32_32x32x16_bf16 v[140:155], v[120:123], a[76:79], v[140:155]
    ds_read_b64_tr_b16 v[116:117], v166 offset:12288
    ds_read_b64_tr_b16 v[118:119], v166 offset:12800
    v_fma_f32 v86, v52, v86, v52
    v_fma_f32 v87, v53, v87, v53
    v_cvt_pk_bf16_f32 v80, v86, v87
    s_waitcnt lgkmcnt(6)
    v_mfma_f32_32x32x16_bf16 v[140:155], v[124:127], a[80:83], v[140:155]
    ds_read_b64_tr_b16 v[120:121], v166 offset:14336
    ds_read_b64_tr_b16 v[122:123], v166 offset:14848
    v_mul_f32 v88, s60, v54
    v_mul_f32 v89, s60, v55
    v_exp_f32 v88, v88
    v_mfma_f32_32x32x16_bf16 v[140:155], v[128:131], a[84:87], v[140:155]
    ds_read_b64_tr_b16 v[124:125], v166 offset:16384
    ds_read_b64_tr_b16 v[126:127], v166 offset:16896
    v_exp_f32 v89, v89
    v_fma_f32 v90, v88, -0.5, -1.0
    v_fma_f32 v91, v89, -0.5, -1.0
    v_fma_f32 v90, v88, v90, -1.0
    v_mfma_f32_32x32x16_bf16 v[140:155], v[132:135], a[88:91], v[140:155]
    ds_read_b64_tr_b16 v[128:129], v166 offset:18432
    ds_read_b64_tr_b16 v[130:131], v166 offset:18944
    v_fma_f32 v91, v89, v91, -1.0
    v_rcp_f32 v90, v90
    v_rcp_f32 v91, v91
    v_mfma_f32_32x32x16_bf16 v[140:155], v[136:139], a[92:95], v[140:155]
    ds_read_b64_tr_b16 v[132:133], v166 offset:20480
    ds_read_b64_tr_b16 v[134:135], v166 offset:20992
    v_fma_f32 v90, v54, v90, v54
    v_fma_f32 v91, v55, v91, v55
    v_cvt_pk_bf16_f32 v81, v90, v91
    s_waitcnt lgkmcnt(6)
    v_mfma_f32_32x32x16_bf16 v[140:155], v[108:111], a[96:99], v[140:155]
    ds_read_b64_tr_b16 v[136:137], v166 offset:22528
    ds_read_b64_tr_b16 v[138:139], v166 offset:23040
    v_mul_f32 v84, s60, v56
    v_mul_f32 v85, s60, v57
    v_exp_f32 v84, v84
    v_mfma_f32_32x32x16_bf16 v[140:155], v[112:115], a[100:103], v[140:155]
    ds_read_b64_tr_b16 v[108:109], v167 offset:40960
    ds_read_b64_tr_b16 v[110:111], v167 offset:41472
    v_exp_f32 v85, v85
    v_fma_f32 v86, v84, -0.5, -1.0
    v_fma_f32 v87, v85, -0.5, -1.0
    v_fma_f32 v86, v84, v86, -1.0
    v_mfma_f32_32x32x16_bf16 v[140:155], v[116:119], a[104:107], v[140:155]
    ds_read_b64_tr_b16 v[112:113], v167 offset:43008
    ds_read_b64_tr_b16 v[114:115], v167 offset:43520
    v_fma_f32 v87, v85, v87, -1.0
    v_rcp_f32 v86, v86
    v_rcp_f32 v87, v87
    v_mfma_f32_32x32x16_bf16 v[140:155], v[120:123], a[108:111], v[140:155]
    ds_read_b64_tr_b16 v[116:117], v167 offset:45056
    ds_read_b64_tr_b16 v[118:119], v167 offset:45568
    v_fma_f32 v86, v56, v86, v56
    v_fma_f32 v87, v57, v87, v57
    v_cvt_pk_bf16_f32 v82, v86, v87
    s_waitcnt lgkmcnt(6)
    v_mfma_f32_32x32x16_bf16 v[140:155], v[124:127], a[112:115], v[140:155]
    ds_read_b64_tr_b16 v[120:121], v167 offset:47104
    ds_read_b64_tr_b16 v[122:123], v167 offset:47616
    v_mul_f32 v88, s60, v58
    v_mul_f32 v89, s60, v59
    v_exp_f32 v88, v88
    v_mfma_f32_32x32x16_bf16 v[140:155], v[128:131], a[116:119], v[140:155]
    ds_read_b64_tr_b16 v[124:125], v167 offset:49152
    ds_read_b64_tr_b16 v[126:127], v167 offset:49664
    v_exp_f32 v89, v89
    v_fma_f32 v90, v88, -0.5, -1.0
    v_fma_f32 v91, v89, -0.5, -1.0
    v_fma_f32 v90, v88, v90, -1.0
    v_mfma_f32_32x32x16_bf16 v[140:155], v[132:135], a[120:123], v[140:155]
    ds_read_b64_tr_b16 v[128:129], v167 offset:51200
    ds_read_b64_tr_b16 v[130:131], v167 offset:51712
    v_fma_f32 v91, v89, v91, -1.0
    v_rcp_f32 v90, v90
    v_rcp_f32 v91, v91
    v_mfma_f32_32x32x16_bf16 v[140:155], v[136:139], a[124:127], v[140:155]
    ds_read_b64_tr_b16 v[132:133], v167 offset:53248
    ds_read_b64_tr_b16 v[134:135], v167 offset:53760
    v_fma_f32 v90, v58, v90, v58
    v_fma_f32 v91, v59, v91, v59
    v_cvt_pk_bf16_f32 v83, v90, v91
    s_add_u32 s69, s57, 1024
    buffer_store_dwordx4 v[80:83], v1, s[20:23], s69 offen sc0 sc1
    v_mov_b32 v20, v19
    s_nop 1
    v_mfma_f32_32x32x16_bf16 v[44:59], v[20:23], v[24:27], 0
    s_waitcnt lgkmcnt(6)
    v_mfma_f32_32x32x16_bf16 v[44:59], v[108:111], a[0:3], v[44:59]
    ds_read_b64_tr_b16 v[136:137], v167 offset:55296
    ds_read_b64_tr_b16 v[138:139], v167 offset:55808
    v_mul_f32 v84, s60, v60
    v_mul_f32 v85, s60, v61
    v_exp_f32 v84, v84
    v_mfma_f32_32x32x16_bf16 v[44:59], v[112:115], a[4:7], v[44:59]
    ds_read_b64_tr_b16 v[108:109], v168 offset:8192
    ds_read_b64_tr_b16 v[110:111], v168 offset:8704
    v_exp_f32 v85, v85
    v_fma_f32 v86, v84, -0.5, -1.0
    v_fma_f32 v87, v85, -0.5, -1.0
    v_fma_f32 v86, v84, v86, -1.0
    v_mfma_f32_32x32x16_bf16 v[44:59], v[116:119], a[8:11], v[44:59]
    ds_read_b64_tr_b16 v[112:113], v168 offset:10240
    ds_read_b64_tr_b16 v[114:115], v168 offset:10752
    v_fma_f32 v87, v85, v87, -1.0
    v_rcp_f32 v86, v86
    v_rcp_f32 v87, v87
    v_mfma_f32_32x32x16_bf16 v[44:59], v[120:123], a[12:15], v[44:59]
    ds_read_b64_tr_b16 v[116:117], v168 offset:12288
    ds_read_b64_tr_b16 v[118:119], v168 offset:12800
    v_fma_f32 v86, v60, v86, v60
    v_fma_f32 v87, v61, v87, v61
    v_cvt_pk_bf16_f32 v76, v86, v87
    s_waitcnt lgkmcnt(6)
    v_mfma_f32_32x32x16_bf16 v[44:59], v[124:127], a[16:19], v[44:59]
    ds_read_b64_tr_b16 v[120:121], v168 offset:14336
    ds_read_b64_tr_b16 v[122:123], v168 offset:14848
    v_mul_f32 v88, s60, v62
    v_mul_f32 v89, s60, v63
    v_exp_f32 v88, v88
    v_mfma_f32_32x32x16_bf16 v[44:59], v[128:131], a[20:23], v[44:59]
    ds_read_b64_tr_b16 v[124:125], v168 offset:16384
    ds_read_b64_tr_b16 v[126:127], v168 offset:16896
    v_exp_f32 v89, v89
    v_fma_f32 v90, v88, -0.5, -1.0
    v_fma_f32 v91, v89, -0.5, -1.0
    v_fma_f32 v90, v88, v90, -1.0
    v_mfma_f32_32x32x16_bf16 v[44:59], v[132:135], a[24:27], v[44:59]
    ds_read_b64_tr_b16 v[128:129], v168 offset:18432
    ds_read_b64_tr_b16 v[130:131], v168 offset:18944
    v_fma_f32 v91, v89, v91, -1.0
    v_rcp_f32 v90, v90
    v_rcp_f32 v91, v91
    v_mfma_f32_32x32x16_bf16 v[44:59], v[136:139], a[28:31], v[44:59]
    ds_read_b64_tr_b16 v[132:133], v168 offset:20480
    ds_read_b64_tr_b16 v[134:135], v168 offset:20992
    v_fma_f32 v90, v62, v90, v62
    v_fma_f32 v91, v63, v91, v63
    v_cvt_pk_bf16_f32 v77, v90, v91
    s_waitcnt lgkmcnt(6)
    v_mfma_f32_32x32x16_bf16 v[44:59], v[108:111], a[32:35], v[44:59]
    ds_read_b64_tr_b16 v[136:137], v168 offset:22528
    ds_read_b64_tr_b16 v[138:139], v168 offset:23040
    v_mul_f32 v84, s60, v64
    v_mul_f32 v85, s60, v65
    v_exp_f32 v84, v84
    v_mfma_f32_32x32x16_bf16 v[44:59], v[112:115], a[36:39], v[44:59]
    ds_read_b64_tr_b16 v[108:109], v168 offset:40960
    ds_read_b64_tr_b16 v[110:111], v168 offset:41472
    v_exp_f32 v85, v85
    v_fma_f32 v86, v84, -0.5, -1.0
    v_fma_f32 v87, v85, -0.5, -1.0
    v_fma_f32 v86, v84, v86, -1.0
    v_mfma_f32_32x32x16_bf16 v[44:59], v[116:119], a[40:43], v[44:59]
    ds_read_b64_tr_b16 v[112:113], v168 offset:43008
    ds_read_b64_tr_b16 v[114:115], v168 offset:43520
    v_fma_f32 v87, v85, v87, -1.0
    v_rcp_f32 v86, v86
    v_rcp_f32 v87, v87
    v_mfma_f32_32x32x16_bf16 v[44:59], v[120:123], a[44:47], v[44:59]
    ds_read_b64_tr_b16 v[116:117], v168 offset:45056
    ds_read_b64_tr_b16 v[118:119], v168 offset:45568
    v_fma_f32 v86, v64, v86, v64
    v_fma_f32 v87, v65, v87, v65
    v_cvt_pk_bf16_f32 v78, v86, v87
    s_waitcnt lgkmcnt(6)
    v_mfma_f32_32x32x16_bf16 v[44:59], v[124:127], a[48:51], v[44:59]
    ds_read_b64_tr_b16 v[120:121], v168 offset:47104
    ds_read_b64_tr_b16 v[122:123], v168 offset:47616
    v_mul_f32 v88, s60, v66
    v_mul_f32 v89, s60, v67
    v_exp_f32 v88, v88
    v_mfma_f32_32x32x16_bf16 v[44:59], v[128:131], a[52:55], v[44:59]
    ds_read_b64_tr_b16 v[124:125], v168 offset:49152
    ds_read_b64_tr_b16 v[126:127], v168 offset:49664
    v_exp_f32 v89, v89
    v_fma_f32 v90, v88, -0.5, -1.0
    v_fma_f32 v91, v89, -0.5, -1.0
    v_fma_f32 v90, v88, v90, -1.0
    v_mfma_f32_32x32x16_bf16 v[44:59], v[132:135], a[56:59], v[44:59]
    ds_read_b64_tr_b16 v[128:129], v168 offset:51200
    ds_read_b64_tr_b16 v[130:131], v168 offset:51712
    v_fma_f32 v91, v89, v91, -1.0
    v_rcp_f32 v90, v90
    v_rcp_f32 v91, v91
    v_mfma_f32_32x32x16_bf16 v[44:59], v[136:139], a[60:63], v[44:59]
    ds_read_b64_tr_b16 v[132:133], v168 offset:53248
    ds_read_b64_tr_b16 v[134:135], v168 offset:53760
    v_fma_f32 v90, v66, v90, v66
    v_fma_f32 v91, v67, v91, v67
    v_cvt_pk_bf16_f32 v79, v90, v91
    s_add_u32 s69, s57, 2048
    buffer_store_dwordx4 v[76:79], v1, s[20:23], s69 offen sc0 sc1
    s_waitcnt lgkmcnt(6)
    v_mfma_f32_32x32x16_bf16 v[44:59], v[108:111], a[64:67], v[44:59]
    ds_read_b64_tr_b16 v[136:137], v168 offset:55296
    ds_read_b64_tr_b16 v[138:139], v168 offset:55808
    v_mul_f32 v84, s60, v68
    v_mul_f32 v85, s60, v69
    v_exp_f32 v84, v84
    v_mfma_f32_32x32x16_bf16 v[44:59], v[112:115], a[68:71], v[44:59]
    ds_read_b64_tr_b16 v[108:109], v169 offset:8192
    ds_read_b64_tr_b16 v[110:111], v169 offset:8704
    v_exp_f32 v85, v85
    v_fma_f32 v86, v84, -0.5, -1.0
    v_fma_f32 v87, v85, -0.5, -1.0
    v_fma_f32 v86, v84, v86, -1.0
    v_mfma_f32_32x32x16_bf16 v[44:59], v[116:119], a[72:75], v[44:59]
    ds_read_b64_tr_b16 v[112:113], v169 offset:10240
    ds_read_b64_tr_b16 v[114:115], v169 offset:10752
    v_fma_f32 v87, v85, v87, -1.0
    v_rcp_f32 v86, v86
    v_rcp_f32 v87, v87
    v_mfma_f32_32x32x16_bf16 v[44:59], v[120:123], a[76:79], v[44:59]
    ds_read_b64_tr_b16 v[116:117], v169 offset:12288
    ds_read_b64_tr_b16 v[118:119], v169 offset:12800
    v_fma_f32 v86, v68, v86, v68
    v_fma_f32 v87, v69, v87, v69
    v_cvt_pk_bf16_f32 v80, v86, v87
    s_waitcnt lgkmcnt(6)
    v_mfma_f32_32x32x16_bf16 v[44:59], v[124:127], a[80:83], v[44:59]
    ds_read_b64_tr_b16 v[120:121], v169 offset:14336
    ds_read_b64_tr_b16 v[122:123], v169 offset:14848
    v_mul_f32 v88, s60, v70
    v_mul_f32 v89, s60, v71
    v_exp_f32 v88, v88
    v_mfma_f32_32x32x16_bf16 v[44:59], v[128:131], a[84:87], v[44:59]
    ds_read_b64_tr_b16 v[124:125], v169 offset:16384
    ds_read_b64_tr_b16 v[126:127], v169 offset:16896
    v_exp_f32 v89, v89
    v_fma_f32 v90, v88, -0.5, -1.0
    v_fma_f32 v91, v89, -0.5, -1.0
    v_fma_f32 v90, v88, v90, -1.0
    v_mfma_f32_32x32x16_bf16 v[44:59], v[132:135], a[88:91], v[44:59]
    ds_read_b64_tr_b16 v[128:129], v169 offset:18432
    ds_read_b64_tr_b16 v[130:131], v169 offset:18944
    v_fma_f32 v91, v89, v91, -1.0
    v_rcp_f32 v90, v90
    v_rcp_f32 v91, v91
    v_mfma_f32_32x32x16_bf16 v[44:59], v[136:139], a[92:95], v[44:59]
    ds_read_b64_tr_b16 v[132:133], v169 offset:20480
    ds_read_b64_tr_b16 v[134:135], v169 offset:20992
    v_fma_f32 v90, v70, v90, v70
    v_fma_f32 v91, v71, v91, v71
    v_cvt_pk_bf16_f32 v81, v90, v91
    s_waitcnt lgkmcnt(6)
    v_mfma_f32_32x32x16_bf16 v[44:59], v[108:111], a[96:99], v[44:59]
    ds_read_b64_tr_b16 v[136:137], v169 offset:22528
    ds_read_b64_tr_b16 v[138:139], v169 offset:23040
    v_mul_f32 v84, s60, v72
    v_mul_f32 v85, s60, v73
    v_exp_f32 v84, v84
    s_waitcnt vmcnt(3)
    s_barrier
    v_mfma_f32_32x32x16_bf16 v[44:59], v[112:115], a[100:103], v[44:59]
    ds_read_b64_tr_b16 v[108:109], v10 offset:32768
    ds_read_b64_tr_b16 v[110:111], v10 offset:32896
    v_exp_f32 v85, v85
    v_fma_f32 v86, v84, -0.5, -1.0
    v_fma_f32 v87, v85, -0.5, -1.0
    v_fma_f32 v86, v84, v86, -1.0
    v_mfma_f32_32x32x16_bf16 v[44:59], v[116:119], a[104:107], v[44:59]
    ds_read_b64_tr_b16 v[112:113], v10 offset:33280
    ds_read_b64_tr_b16 v[114:115], v10 offset:33408
    v_fma_f32 v87, v85, v87, -1.0
    v_rcp_f32 v86, v86
    v_rcp_f32 v87, v87
    v_mfma_f32_32x32x16_bf16 v[44:59], v[120:123], a[108:111], v[44:59]
    ds_read_b64_tr_b16 v[116:117], v10 offset:33792
    ds_read_b64_tr_b16 v[118:119], v10 offset:33920
    v_fma_f32 v86, v72, v86, v72
    v_fma_f32 v87, v73, v87, v73
    v_cvt_pk_bf16_f32 v82, v86, v87
    s_waitcnt lgkmcnt(6)
    v_mfma_f32_32x32x16_bf16 v[44:59], v[124:127], a[112:115], v[44:59]
    ds_read_b64_tr_b16 v[120:121], v10 offset:34304
    ds_read_b64_tr_b16 v[122:123], v10 offset:34432
    v_mul_f32 v88, s60, v74
    v_mul_f32 v89, s60, v75
    v_exp_f32 v88, v88
    v_mfma_f32_32x32x16_bf16 v[44:59], v[128:131], a[116:119], v[44:59]
    ds_read_b64_tr_b16 v[124:125], v10 offset:34816
    ds_read_b64_tr_b16 v[126:127], v10 offset:34944
    v_exp_f32 v89, v89
    v_fma_f32 v90, v88, -0.5, -1.0
    v_fma_f32 v91, v89, -0.5, -1.0
    v_fma_f32 v90, v88, v90, -1.0
    v_mfma_f32_32x32x16_bf16 v[44:59], v[132:135], a[120:123], v[44:59]
    ds_read_b64_tr_b16 v[128:129], v10 offset:35328
    ds_read_b64_tr_b16 v[130:131], v10 offset:35456
    v_fma_f32 v91, v89, v91, -1.0
    v_rcp_f32 v90, v90
    v_rcp_f32 v91, v91
    v_mfma_f32_32x32x16_bf16 v[44:59], v[136:139], a[124:127], v[44:59]
    ds_read_b64_tr_b16 v[132:133], v10 offset:35840
    ds_read_b64_tr_b16 v[134:135], v10 offset:35968
    v_fma_f32 v90, v74, v90, v74
    v_fma_f32 v91, v75, v91, v75
    v_cvt_pk_bf16_f32 v83, v90, v91
    s_add_u32 s69, s57, 3072
    buffer_store_dwordx4 v[80:83], v1, s[20:23], s69 offen sc0 sc1
    s_waitcnt lgkmcnt(6)
    v_mfma_f32_32x32x16_bf16 v[60:75], v[108:111], a[0:3], 0
    ds_read_b64_tr_b16 v[136:137], v10 offset:36352
    ds_read_b64_tr_b16 v[138:139], v10 offset:36480
    v_mul_f32 v84, s60, v140
    v_mul_f32 v85, s60, v141
    v_exp_f32 v84, v84
    v_mfma_f32_32x32x16_bf16 v[60:75], v[112:115], a[4:7], v[60:75]
    ds_read_b64_tr_b16 v[108:109], v11 offset:0
    ds_read_b64_tr_b16 v[110:111], v11 offset:128
    v_exp_f32 v85, v85
    v_fma_f32 v86, v84, -0.5, -1.0
    v_fma_f32 v87, v85, -0.5, -1.0
    v_fma_f32 v86, v84, v86, -1.0
    v_mfma_f32_32x32x16_bf16 v[60:75], v[116:119], a[8:11], v[60:75]
    ds_read_b64_tr_b16 v[112:113], v11 offset:512
    ds_read_b64_tr_b16 v[114:115], v11 offset:640
    v_fma_f32 v87, v85, v87, -1.0
    v_rcp_f32 v86, v86
    v_rcp_f32 v87, v87
    v_mfma_f32_32x32x16_bf16 v[60:75], v[120:123], a[12:15], v[60:75]
    ds_read_b64_tr_b16 v[116:117], v11 offset:1024
    ds_read_b64_tr_b16 v[118:119], v11 offset:1152
    v_fma_f32 v86, v140, v86, v140
    v_fma_f32 v87, v141, v87, v141
    v_cvt_pk_bf16_f32 v76, v86, v87
    s_waitcnt lgkmcnt(6)
    v_mfma_f32_32x32x16_bf16 v[60:75], v[124:127], a[16:19], v[60:75]
    ds_read_b64_tr_b16 v[120:121], v11 offset:1536
    ds_read_b64_tr_b16 v[122:123], v11 offset:1664
    v_mul_f32 v88, s60, v142
    v_mul_f32 v89, s60, v143
    v_exp_f32 v88, v88
    v_mfma_f32_32x32x16_bf16 v[60:75], v[128:131], a[20:23], v[60:75]
    ds_read_b64_tr_b16 v[124:125], v11 offset:2048
    ds_read_b64_tr_b16 v[126:127], v11 offset:2176
    v_exp_f32 v89, v89
    v_fma_f32 v90, v88, -0.5, -1.0
    v_fma_f32 v91, v89, -0.5, -1.0
    v_fma_f32 v90, v88, v90, -1.0
    v_mfma_f32_32x32x16_bf16 v[60:75], v[132:135], a[24:27], v[60:75]
    ds_read_b64_tr_b16 v[128:129], v11 offset:2560
    ds_read_b64_tr_b16 v[130:131], v11 offset:2688
    v_fma_f32 v91, v89, v91, -1.0
    v_rcp_f32 v90, v90
    v_rcp_f32 v91, v91
    v_mfma_f32_32x32x16_bf16 v[60:75], v[136:139], a[28:31], v[60:75]
    ds_read_b64_tr_b16 v[132:133], v11 offset:3072
    ds_read_b64_tr_b16 v[134:135], v11 offset:3200
    v_fma_f32 v90, v142, v90, v142
    v_fma_f32 v91, v143, v91, v143
    v_cvt_pk_bf16_f32 v77, v90, v91
    s_waitcnt lgkmcnt(6)
    v_mfma_f32_32x32x16_bf16 v[60:75], v[108:111], a[32:35], v[60:75]
    ds_read_b64_tr_b16 v[136:137], v11 offset:3584
    ds_read_b64_tr_b16 v[138:139], v11 offset:3712
    v_mul_f32 v84, s60, v144
    v_mul_f32 v85, s60, v145
    v_exp_f32 v84, v84
    v_mfma_f32_32x32x16_bf16 v[60:75], v[112:115], a[36:39], v[60:75]
    ds_read_b64_tr_b16 v[108:109], v11 offset:32768
    ds_read_b64_tr_b16 v[110:111], v11 offset:32896
    v_exp_f32 v85, v85
    v_fma_f32 v86, v84, -0.5, -1.0
    v_fma_f32 v87, v85, -0.5, -1.0
    v_fma_f32 v86, v84, v86, -1.0
    v_mfma_f32_32x32x16_bf16 v[60:75], v[116:119], a[40:43], v[60:75]
    ds_read_b64_tr_b16 v[112:113], v11 offset:33280
    ds_read_b64_tr_b16 v[114:115], v11 offset:33408
    v_fma_f32 v87, v85, v87, -1.0
    v_rcp_f32 v86, v86
    v_rcp_f32 v87, v87
    v_mfma_f32_32x32x16_bf16 v[60:75], v[120:123], a[44:47], v[60:75]
    ds_read_b64_tr_b16 v[116:117], v11 offset:33792
    ds_read_b64_tr_b16 v[118:119], v11 offset:33920
    v_fma_f32 v86, v144, v86, v144
    v_fma_f32 v87, v145, v87, v145
    v_cvt_pk_bf16_f32 v78, v86, v87
    s_waitcnt lgkmcnt(6)
    v_mfma_f32_32x32x16_bf16 v[60:75], v[124:127], a[48:51], v[60:75]
    ds_read_b64_tr_b16 v[120:121], v11 offset:34304
    ds_read_b64_tr_b16 v[122:123], v11 offset:34432
    v_mul_f32 v88, s60, v146
    v_mul_f32 v89, s60, v147
    v_exp_f32 v88, v88
    v_mfma_f32_32x32x16_bf16 v[60:75], v[128:131], a[52:55], v[60:75]
    ds_read_b64_tr_b16 v[124:125], v11 offset:34816
    ds_read_b64_tr_b16 v[126:127], v11 offset:34944
    v_exp_f32 v89, v89
    v_fma_f32 v90, v88, -0.5, -1.0
    v_fma_f32 v91, v89, -0.5, -1.0
    v_fma_f32 v90, v88, v90, -1.0
    v_mfma_f32_32x32x16_bf16 v[60:75], v[132:135], a[56:59], v[60:75]
    ds_read_b64_tr_b16 v[128:129], v11 offset:35328
    ds_read_b64_tr_b16 v[130:131], v11 offset:35456
    v_fma_f32 v91, v89, v91, -1.0
    v_rcp_f32 v90, v90
    v_rcp_f32 v91, v91
    v_mfma_f32_32x32x16_bf16 v[60:75], v[136:139], a[60:63], v[60:75]
    ds_read_b64_tr_b16 v[132:133], v11 offset:35840
    ds_read_b64_tr_b16 v[134:135], v11 offset:35968
    v_fma_f32 v90, v146, v90, v146
    v_fma_f32 v91, v147, v91, v147
    v_cvt_pk_bf16_f32 v79, v90, v91
    s_add_u32 s69, s75, 0
    buffer_store_dwordx4 v[76:79], v1, s[20:23], s69 offen sc0 sc1
    s_waitcnt lgkmcnt(6)
    v_mfma_f32_32x32x16_bf16 v[60:75], v[108:111], a[64:67], v[60:75]
    ds_read_b64_tr_b16 v[136:137], v11 offset:36352
    ds_read_b64_tr_b16 v[138:139], v11 offset:36480
    v_mul_f32 v84, s60, v148
    v_mul_f32 v85, s60, v149
    v_exp_f32 v84, v84
    v_mfma_f32_32x32x16_bf16 v[60:75], v[112:115], a[68:71], v[60:75]
    ds_read_b64_tr_b16 v[108:109], v12 offset:0
    ds_read_b64_tr_b16 v[110:111], v12 offset:128
    v_exp_f32 v85, v85
    v_fma_f32 v86, v84, -0.5, -1.0
    v_fma_f32 v87, v85, -0.5, -1.0
    v_fma_f32 v86, v84, v86, -1.0
    v_mfma_f32_32x32x16_bf16 v[60:75], v[116:119], a[72:75], v[60:75]
    ds_read_b64_tr_b16 v[112:113], v12 offset:512
    ds_read_b64_tr_b16 v[114:115], v12 offset:640
    v_fma_f32 v87, v85, v87, -1.0
    v_rcp_f32 v86, v86
    v_rcp_f32 v87, v87
    v_mfma_f32_32x32x16_bf16 v[60:75], v[120:123], a[76:79], v[60:75]
    ds_read_b64_tr_b16 v[116:117], v12 offset:1024
    ds_read_b64_tr_b16 v[118:119], v12 offset:1152
    v_fma_f32 v86, v148, v86, v148
    v_fma_f32 v87, v149, v87, v149
    v_cvt_pk_bf16_f32 v80, v86, v87
    s_waitcnt lgkmcnt(6)
    v_mfma_f32_32x32x16_bf16 v[60:75], v[124:127], a[80:83], v[60:75]
    ds_read_b64_tr_b16 v[120:121], v12 offset:1536
    ds_read_b64_tr_b16 v[122:123], v12 offset:1664
    v_mul_f32 v88, s60, v150
    v_mul_f32 v89, s60, v151
    v_exp_f32 v88, v88
    v_mfma_f32_32x32x16_bf16 v[60:75], v[128:131], a[84:87], v[60:75]
    ds_read_b64_tr_b16 v[124:125], v12 offset:2048
    ds_read_b64_tr_b16 v[126:127], v12 offset:2176
    v_exp_f32 v89, v89
    v_fma_f32 v90, v88, -0.5, -1.0
    v_fma_f32 v91, v89, -0.5, -1.0
    v_fma_f32 v90, v88, v90, -1.0
    v_mfma_f32_32x32x16_bf16 v[60:75], v[132:135], a[88:91], v[60:75]
    ds_read_b64_tr_b16 v[128:129], v12 offset:2560
    ds_read_b64_tr_b16 v[130:131], v12 offset:2688
    v_fma_f32 v91, v89, v91, -1.0
    v_rcp_f32 v90, v90
    v_rcp_f32 v91, v91
    v_mfma_f32_32x32x16_bf16 v[60:75], v[136:139], a[92:95], v[60:75]
    ds_read_b64_tr_b16 v[132:133], v12 offset:3072
    ds_read_b64_tr_b16 v[134:135], v12 offset:3200
    v_fma_f32 v90, v150, v90, v150
    v_fma_f32 v91, v151, v91, v151
    v_cvt_pk_bf16_f32 v81, v90, v91
    s_waitcnt lgkmcnt(6)
    v_mfma_f32_32x32x16_bf16 v[60:75], v[108:111], a[96:99], v[60:75]
    ds_read_b64_tr_b16 v[136:137], v12 offset:3584
    ds_read_b64_tr_b16 v[138:139], v12 offset:3712
    v_mul_f32 v84, s60, v152
    v_mul_f32 v85, s60, v153
    v_exp_f32 v84, v84
    v_mfma_f32_32x32x16_bf16 v[60:75], v[112:115], a[100:103], v[60:75]
    v_exp_f32 v85, v85
    v_fma_f32 v86, v84, -0.5, -1.0
    v_fma_f32 v87, v85, -0.5, -1.0
    v_fma_f32 v86, v84, v86, -1.0
    v_mfma_f32_32x32x16_bf16 v[60:75], v[116:119], a[104:107], v[60:75]
    v_fma_f32 v87, v85, v87, -1.0
    v_rcp_f32 v86, v86
    v_rcp_f32 v87, v87
    v_mfma_f32_32x32x16_bf16 v[60:75], v[120:123], a[108:111], v[60:75]
    v_fma_f32 v86, v152, v86, v152
    v_fma_f32 v87, v153, v87, v153
    v_cvt_pk_bf16_f32 v82, v86, v87
    s_waitcnt lgkmcnt(0)
    v_mfma_f32_32x32x16_bf16 v[60:75], v[124:127], a[112:115], v[60:75]
    v_mul_f32 v88, s60, v154
    v_mul_f32 v89, s60, v155
    v_exp_f32 v88, v88
    v_mfma_f32_32x32x16_bf16 v[60:75], v[128:131], a[116:119], v[60:75]
    v_exp_f32 v89, v89
    v_fma_f32 v90, v88, -0.5, -1.0
    v_fma_f32 v91, v89, -0.5, -1.0
    v_fma_f32 v90, v88, v90, -1.0
    v_mfma_f32_32x32x16_bf16 v[60:75], v[132:135], a[120:123], v[60:75]
    v_fma_f32 v91, v89, v91, -1.0
    v_rcp_f32 v90, v90
    v_rcp_f32 v91, v91
    v_mfma_f32_32x32x16_bf16 v[60:75], v[136:139], a[124:127], v[60:75]
    v_fma_f32 v90, v154, v90, v154
    v_fma_f32 v91, v155, v91, v155
    v_cvt_pk_bf16_f32 v83, v90, v91
    s_add_u32 s69, s75, 1024
    buffer_store_dwordx4 v[80:83], v1, s[20:23], s69 offen sc0 sc1
    v_mul_f32 v84, s60, v44
    v_mul_f32 v85, s60, v45
    v_exp_f32 v84, v84
    v_exp_f32 v85, v85
    v_fma_f32 v86, v84, -0.5, -1.0
    v_fma_f32 v87, v85, -0.5, -1.0
    v_fma_f32 v86, v84, v86, -1.0
    v_fma_f32 v87, v85, v87, -1.0
    v_rcp_f32 v86, v86
    v_rcp_f32 v87, v87
    v_fma_f32 v86, v44, v86, v44
    v_fma_f32 v87, v45, v87, v45
    v_cvt_pk_bf16_f32 v76, v86, v87
    v_mul_f32 v88, s60, v46
    v_mul_f32 v89, s60, v47
    v_exp_f32 v88, v88
    v_exp_f32 v89, v89
    v_fma_f32 v90, v88, -0.5, -1.0
    v_fma_f32 v91, v89, -0.5, -1.0
    v_fma_f32 v90, v88, v90, -1.0
    v_fma_f32 v91, v89, v91, -1.0
    v_rcp_f32 v90, v90
    v_rcp_f32 v91, v91
    v_fma_f32 v90, v46, v90, v46
    v_fma_f32 v91, v47, v91, v47
    v_cvt_pk_bf16_f32 v77, v90, v91
    v_mul_f32 v84, s60, v48
    v_mul_f32 v85, s60, v49
    v_exp_f32 v84, v84
    v_exp_f32 v85, v85
    v_fma_f32 v86, v84, -0.5, -1.0
    v_fma_f32 v87, v85, -0.5, -1.0
    v_fma_f32 v86, v84, v86, -1.0
    v_fma_f32 v87, v85, v87, -1.0
    v_rcp_f32 v86, v86
    v_rcp_f32 v87, v87
    v_fma_f32 v86, v48, v86, v48
    v_fma_f32 v87, v49, v87, v49
    v_cvt_pk_bf16_f32 v78, v86, v87
    v_mul_f32 v88, s60, v50
    v_mul_f32 v89, s60, v51
    v_exp_f32 v88, v88
    v_exp_f32 v89, v89
    v_fma_f32 v90, v88, -0.5, -1.0
    v_fma_f32 v91, v89, -0.5, -1.0
    v_fma_f32 v90, v88, v90, -1.0
    v_fma_f32 v91, v89, v91, -1.0
    v_rcp_f32 v90, v90
    v_rcp_f32 v91, v91
    v_fma_f32 v90, v50, v90, v50
    v_fma_f32 v91, v51, v91, v51
    v_cvt_pk_bf16_f32 v79, v90, v91
    s_add_u32 s69, s75, 2048
    buffer_store_dwordx4 v[76:79], v1, s[20:23], s69 offen sc0 sc1
    v_mul_f32 v84, s60, v52
    v_mul_f32 v85, s60, v53
    v_exp_f32 v84, v84
    v_exp_f32 v85, v85
    v_fma_f32 v86, v84, -0.5, -1.0
    v_fma_f32 v87, v85, -0.5, -1.0
    v_fma_f32 v86, v84, v86, -1.0
    v_fma_f32 v87, v85, v87, -1.0
    v_rcp_f32 v86, v86
    v_rcp_f32 v87, v87
    v_fma_f32 v86, v52, v86, v52
    v_fma_f32 v87, v53, v87, v53
    v_cvt_pk_bf16_f32 v80, v86, v87
    v_mul_f32 v88, s60, v54
    v_mul_f32 v89, s60, v55
    v_exp_f32 v88, v88
    v_exp_f32 v89, v89
    v_fma_f32 v90, v88, -0.5, -1.0
    v_fma_f32 v91, v89, -0.5, -1.0
    v_fma_f32 v90, v88, v90, -1.0
    v_fma_f32 v91, v89, v91, -1.0
    v_rcp_f32 v90, v90
    v_rcp_f32 v91, v91
    v_fma_f32 v90, v54, v90, v54
    v_fma_f32 v91, v55, v91, v55
    v_cvt_pk_bf16_f32 v81, v90, v91
    v_mul_f32 v84, s60, v56
    v_mul_f32 v85, s60, v57
    v_exp_f32 v84, v84
    v_exp_f32 v85, v85
    v_fma_f32 v86, v84, -0.5, -1.0
    v_fma_f32 v87, v85, -0.5, -1.0
    v_fma_f32 v86, v84, v86, -1.0
    v_fma_f32 v87, v85, v87, -1.0
    v_rcp_f32 v86, v86
    v_rcp_f32 v87, v87
    v_fma_f32 v86, v56, v86, v56
    v_fma_f32 v87, v57, v87, v57
    v_cvt_pk_bf16_f32 v82, v86, v87
    v_mul_f32 v88, s60, v58
    v_mul_f32 v89, s60, v59
    v_exp_f32 v88, v88
    v_exp_f32 v89, v89
    v_fma_f32 v90, v88, -0.5, -1.0
    v_fma_f32 v91, v89, -0.5, -1.0
    v_fma_f32 v90, v88, v90, -1.0
    v_fma_f32 v91, v89, v91, -1.0
    v_rcp_f32 v90, v90
    v_rcp_f32 v91, v91
    v_fma_f32 v90, v58, v90, v58
    v_fma_f32 v91, v59, v91, v59
    v_cvt_pk_bf16_f32 v83, v90, v91
    s_add_u32 s69, s75, 3072
    buffer_store_dwordx4 v[80:83], v1, s[20:23], s69 offen sc0 sc1
    v_cvt_pk_bf16_f32 v76, v60, v61
    v_cvt_pk_bf16_f32 v77, v62, v63
    v_cvt_pk_bf16_f32 v78, v64, v65
    v_cvt_pk_bf16_f32 v79, v66, v67
    s_lshl_b32 s69, s45, 10
    s_add_u32 s69, s69, 2097152
    buffer_store_dwordx4 v[76:79], v1, s[20:23], s69 offen sc0 sc1
    s_endpgm
K1_BV:
    s_sub_u32 s48, s47, 8
    s_lshl_b32 s55, s48, 8
    s_add_u32 s73, s55, 128
    s_mov_b32 m0, s46
    s_nop 0
    buffer_load_dwordx4 v2, s[8:11], s50 offen lds
    s_add_u32 m0, s46, 1024
    s_nop 0
    buffer_load_dwordx4 v3, s[8:11], s51 offen lds
    s_add_u32 m0, s46, 2048
    s_nop 0
    buffer_load_dwordx4 v2, s[8:11], s52 offen lds
    s_add_u32 m0, s46, 3072
    s_nop 0
    buffer_load_dwordx4 v3, s[8:11], s53 offen lds
    s_add_u32 m0, s46, 3968
    s_nop 0
    buffer_load_dwordx4 v2, s[8:11], s50 offen offset:128 lds
    s_add_u32 m0, s46, 4992
    s_nop 0
    buffer_load_dwordx4 v3, s[8:11], s51 offen offset:128 lds
    s_add_u32 m0, s46, 6016
    s_nop 0
    buffer_load_dwordx4 v2, s[8:11], s52 offen offset:128 lds
    s_add_u32 m0, s46, 7040
    s_nop 0
    buffer_load_dwordx4 v3, s[8:11], s53 offen offset:128 lds
    s_add_u32 s54, s55, s59
    s_mov_b32 m0, s82
    s_nop 0
    buffer_load_dwordx4 v170, s[12:15], s54 offen lds
    s_add_u32 s54, s54, 28672
    s_add_u32 m0, s82, 1024
    s_nop 0
    buffer_load_dwordx4 v170, s[12:15], s54 offen lds
    s_add_u32 s54, s54, 28672
    s_add_u32 m0, s82, 2048
    s_nop 0
    buffer_load_dwordx4 v170, s[12:15], s54 offen lds
    s_add_u32 s54, s54, 28672
    s_add_u32 m0, s82, 3072
    s_nop 0
    buffer_load_dwordx4 v170, s[12:15], s54 offen lds
    buffer_load_ushort v16, v13, s[24:27], s55 offen
    buffer_load_ushort v17, v13, s[24:27], s55 offen offset:64
    buffer_load_ushort v18, v13, s[24:27], s73 offen
    buffer_load_ushort v19, v13, s[24:27], s73 offen offset:64
    s_add_u32 m0, s46, 7936
    s_nop 0
    buffer_load_dwordx4 v2, s[8:11], s50 offen offset:256 lds
    s_add_u32 m0, s46, 8960
    s_nop 0
    buffer_load_dwordx4 v3, s[8:11], s51 offen offset:256 lds
    s_add_u32 m0, s46, 9984
    s_nop 0
    buffer_load_dwordx4 v2, s[8:11], s52 offen offset:256 lds
    s_add_u32 m0, s46, 11008
    s_nop 0
    buffer_load_dwordx4 v3, s[8:11], s53 offen offset:256 lds
    s_add_u32 m0, s46, 11904
    s_nop 0
    buffer_load_dwordx4 v2, s[8:11], s50 offen offset:384 lds
    s_add_u32 m0, s46, 12928
    s_nop 0
    buffer_load_dwordx4 v3, s[8:11], s51 offen offset:384 lds
    s_add_u32 m0, s46, 13952
    s_nop 0
    buffer_load_dwordx4 v2, s[8:11], s52 offen offset:384 lds
    s_add_u32 m0, s46, 14976
    s_nop 0
    buffer_load_dwordx4 v3, s[8:11], s53 offen offset:384 lds
    s_add_u32 s54, s55, s59
    s_add_u32 s54, s54, 458752
    s_add_u32 m0, s82, 16384
    s_nop 0
    buffer_load_dwordx4 v170, s[12:15], s54 offen lds
    s_add_u32 s54, s54, 28672
    s_add_u32 m0, s82, 17408
    s_nop 0
    buffer_load_dwordx4 v170, s[12:15], s54 offen lds
    s_add_u32 s54, s54, 28672
    s_add_u32 m0, s82, 18432
    s_nop 0
    buffer_load_dwordx4 v170, s[12:15], s54 offen lds
    s_add_u32 s54, s54, 28672
    s_add_u32 m0, s82, 19456
    s_nop 0
    buffer_load_dwordx4 v170, s[12:15], s54 offen lds
    s_mul_i32 s57, s45, 114688
    s_add_u32 s57, s57, 4718592
    s_lshl_b32 s48, s73, 5
    s_add_u32 s75, s57, s48
    s_lshl_b32 s48, s55, 5
    s_add_u32 s57, s57, s48
    s_mov_b32 s28, s78
    s_mov_b32 s29, s79
    s_mov_b32 s30, 16384
    s_mov_b32 s31, 0x00020000
    v_bfe_u32 v15, v0, 2, 2
    v_lshrrev_b32 v10, 5, v0
    v_lshl_add_u32 v15, v10, 3, v15
    v_and_b32 v10, 3, v0
    v_lshlrev_b32 v10, 3, v10
    v_lshl_add_u32 v10, v15, 5, v10
    v_add_u32 v11, 0x10000, v10
    v_add_u32 v12, 0x20000, v10
    s_waitcnt vmcnt(12)
    s_barrier
    ds_read_b128 a[0:3], v6 offset:0
    ds_read_b128 a[4:7], v7 offset:0
    ds_read_b128 a[8:11], v8 offset:0
    ds_read_b128 a[12:15], v9 offset:0
    ds_read_b128 a[16:19], v6 offset:4096
    ds_read_b128 a[20:23], v7 offset:4096
    ds_read_b128 a[24:27], v8 offset:4096
    ds_read_b128 a[28:31], v9 offset:4096
    ds_read_b64_tr_b16 v[108:109], v164 offset:0
    ds_read_b64_tr_b16 v[110:111], v164 offset:512
    ds_read_b64_tr_b16 v[112:113], v167 offset:0
    ds_read_b64_tr_b16 v[114:115], v167 offset:512
    ds_read_b64_tr_b16 v[116:117], v164 offset:2048
    ds_read_b64_tr_b16 v[118:119], v164 offset:2560
    ds_read_b64_tr_b16 v[120:121], v167 offset:2048
    ds_read_b64_tr_b16 v[122:123], v167 offset:2560
    ds_read_b64_tr_b16 v[124:125], v164 offset:4096
    ds_read_b64_tr_b16 v[126:127], v164 offset:4608
    ds_read_b64_tr_b16 v[128:129], v167 offset:4096
    ds_read_b64_tr_b16 v[130:131], v167 offset:4608
    ds_read_b64_tr_b16 v[132:133], v164 offset:6144
    ds_read_b64_tr_b16 v[134:135], v164 offset:6656
    v_mov_b32 v20, v16
    s_nop 1
    v_mfma_f32_32x32x16_bf16 v[44:59], v[20:23], v[24:27], 0
    s_waitcnt lgkmcnt(6)
    v_mfma_f32_32x32x16_bf16 v[44:59], v[108:111], a[0:3], v[44:59]
    ds_read_b64_tr_b16 v[136:137], v167 offset:6144
    ds_read_b64_tr_b16 v[138:139], v167 offset:6656
    s_add_u32 m0, s46, 15872
    s_nop 0
    buffer_load_dwordx4 v2, s[8:11], s50 offen offset:512 lds
    s_add_u32 m0, s46, 16896
    s_nop 0
    buffer_load_dwordx4 v3, s[8:11], s51 offen offset:512 lds
    v_mov_b32 v20, v17
    s_nop 1
    v_mfma_f32_32x32x16_bf16 v[60:75], v[20:23], v[24:27], 0
    v_mfma_f32_32x32x16_bf16 v[60:75], v[112:115], a[0:3], v[60:75]
    ds_read_b64_tr_b16 v[108:109], v164 offset:8192
    ds_read_b64_tr_b16 v[110:111], v164 offset:8704
    s_add_u32 m0, s46, 17920
    s_nop 0
    buffer_load_dwordx4 v2, s[8:11], s52 offen offset:512 lds
    s_add_u32 m0, s46, 18944
    s_nop 0
    buffer_load_dwordx4 v3, s[8:11], s53 offen offset:512 lds
    v_mfma_f32_32x32x16_bf16 v[44:59], v[116:119], a[4:7], v[44:59]
    ds_read_b64_tr_b16 v[112:113], v167 offset:8192
    ds_read_b64_tr_b16 v[114:115], v167 offset:8704
    s_add_u32 m0, s46, 19840
    s_nop 0
    buffer_load_dwordx4 v2, s[8:11], s50 offen offset:640 lds
    s_add_u32 m0, s46, 20864
    s_nop 0
    buffer_load_dwordx4 v3, s[8:11], s51 offen offset:640 lds
    s_add_u32 s64, s70, 0
    s_lshr_b32 s48, s64, 4
    s_cmp_ge_u32 s48, 112
    s_cselect_b32 s40, s36, s32
    s_cselect_b32 s41, s37, s33
    s_cselect_b32 s42, s38, s34
    s_mov_b32 s43, 0x00020000
    s_cselect_b32 s49, 112, 0
    s_sub_u32 s48, s48, s49
    s_lshl_b32 s48, s48, 14
    s_and_b32 s49, s64, 15
    s_lshl_b32 s49, s49, 6
    s_add_u32 s65, s48, s49
    s_add_u32 s66, s65, 8192
    s_lshl_b32 s67, s64, 10
    s_add_u32 s67, s67, 2359296
    v_mfma_f32_32x32x16_bf16 v[60:75], v[120:123], a[4:7], v[60:75]
    ds_read_b64_tr_b16 v[116:117], v164 offset:10240
    ds_read_b64_tr_b16 v[118:119], v164 offset:10752
    s_add_u32 m0, s46, 21888
    s_nop 0
    buffer_load_dwordx4 v2, s[8:11], s52 offen offset:640 lds
    s_add_u32 m0, s46, 22912
    s_nop 0
    buffer_load_dwordx4 v3, s[8:11], s53 offen offset:640 lds
    buffer_load_ushort v92, v14, s[40:43], s65 offen
    s_waitcnt lgkmcnt(6)
    v_mfma_f32_32x32x16_bf16 v[44:59], v[124:127], a[8:11], v[44:59]
    ds_read_b64_tr_b16 v[120:121], v167 offset:10240
    ds_read_b64_tr_b16 v[122:123], v167 offset:10752
    s_add_u32 s54, s55, s59
    s_add_u32 s54, s54, 917504
    s_add_u32 m0, s46, 24576
    s_nop 0
    buffer_load_dwordx4 v170, s[12:15], s54 offen lds
    s_add_u32 s54, s54, 28672
    s_add_u32 m0, s46, 25600
    s_nop 0
    buffer_load_dwordx4 v170, s[12:15], s54 offen lds
    buffer_load_ushort v93, v14, s[40:43], s65 offen offset:1024
    v_mfma_f32_32x32x16_bf16 v[60:75], v[128:131], a[8:11], v[60:75]
    ds_read_b64_tr_b16 v[124:125], v164 offset:12288
    ds_read_b64_tr_b16 v[126:127], v164 offset:12800
    s_add_u32 s54, s54, 28672
    s_add_u32 m0, s46, 26624
    s_nop 0
    buffer_load_dwordx4 v170, s[12:15], s54 offen lds
    s_add_u32 s54, s54, 28672
    s_add_u32 m0, s46, 27648
    s_nop 0
    buffer_load_dwordx4 v170, s[12:15], s54 offen lds
    buffer_load_ushort v94, v14, s[40:43], s65 offen offset:2048
    v_mfma_f32_32x32x16_bf16 v[44:59], v[132:135], a[12:15], v[44:59]
    ds_read_b64_tr_b16 v[128:129], v167 offset:12288
    ds_read_b64_tr_b16 v[130:131], v167 offset:12800
    s_sub_u32 m0, s46, 768
    s_nop 0
    buffer_load_dwordx4 v2, s[8:11], s50 offen offset:768 lds
    s_add_u32 m0, s46, 256
    s_nop 0
    buffer_load_dwordx4 v3, s[8:11], s51 offen offset:768 lds
    buffer_load_ushort v95, v14, s[40:43], s65 offen offset:3072
    v_mfma_f32_32x32x16_bf16 v[60:75], v[136:139], a[12:15], v[60:75]
    ds_read_b64_tr_b16 v[132:133], v164 offset:14336
    ds_read_b64_tr_b16 v[134:135], v164 offset:14848
    s_add_u32 m0, s46, 1280
    s_nop 0
    buffer_load_dwordx4 v2, s[8:11], s52 offen offset:768 lds
    s_add_u32 m0, s46, 2304
    s_nop 0
    buffer_load_dwordx4 v3, s[8:11], s53 offen offset:768 lds
    buffer_load_ushort v96, v14, s[40:43], s66 offen
    s_waitcnt lgkmcnt(6)
    v_mfma_f32_32x32x16_bf16 v[44:59], v[108:111], a[16:19], v[44:59]
    ds_read_b64_tr_b16 v[136:137], v167 offset:14336
    ds_read_b64_tr_b16 v[138:139], v167 offset:14848
    s_add_u32 m0, s46, 3200
    s_nop 0
    buffer_load_dwordx4 v2, s[8:11], s50 offen offset:896 lds
    s_add_u32 m0, s46, 4224
    s_nop 0
    buffer_load_dwordx4 v3, s[8:11], s51 offen offset:896 lds
    buffer_load_ushort v97, v14, s[40:43], s66 offen offset:1024
    s_waitcnt vmcnt(24)
    s_barrier
    ds_read_b128 a[32:35], v6 offset:8192
    ds_read_b128 a[36:39], v7 offset:8192
    ds_read_b128 a[40:43], v8 offset:8192
    ds_read_b128 a[44:47], v9 offset:8192
    ds_read_b128 a[48:51], v6 offset:12288
    ds_read_b128 a[52:55], v7 offset:12288
    ds_read_b128 a[56:59], v8 offset:12288
    ds_read_b128 a[60:63], v9 offset:12288
    v_mfma_f32_32x32x16_bf16 v[60:75], v[112:115], a[16:19], v[60:75]
    ds_read_b64_tr_b16 v[108:109], v164 offset:16384
    ds_read_b64_tr_b16 v[110:111], v164 offset:16896
    s_add_u32 m0, s46, 5248
    s_nop 0
    buffer_load_dwordx4 v2, s[8:11], s52 offen offset:896 lds
    s_add_u32 m0, s46, 6272
    s_nop 0
    buffer_load_dwordx4 v3, s[8:11], s53 offen offset:896 lds
    buffer_load_ushort v98, v14, s[40:43], s66 offen offset:2048
    v_mfma_f32_32x32x16_bf16 v[44:59], v[116:119], a[20:23], v[44:59]
    ds_read_b64_tr_b16 v[112:113], v167 offset:16384
    ds_read_b64_tr_b16 v[114:115], v167 offset:16896
    s_add_u32 s54, s55, s59
    s_add_u32 s54, s54, 1376256
    s_add_u32 m0, s46, 28672
    s_nop 0
    buffer_load_dwordx4 v170, s[12:15], s54 offen lds
    s_add_u32 s54, s54, 28672
    s_add_u32 m0, s46, 29696
    s_nop 0
    buffer_load_dwordx4 v170, s[12:15], s54 offen lds
    buffer_load_ushort v99, v14, s[40:43], s66 offen offset:3072
    v_mfma_f32_32x32x16_bf16 v[60:75], v[120:123], a[20:23], v[60:75]
    ds_read_b64_tr_b16 v[116:117], v164 offset:18432
    ds_read_b64_tr_b16 v[118:119], v164 offset:18944
    s_add_u32 s54, s54, 28672
    s_add_u32 m0, s46, 30720
    s_nop 0
    buffer_load_dwordx4 v170, s[12:15], s54 offen lds
    s_add_u32 s54, s54, 28672
    s_add_u32 m0, s46, 31744
    s_nop 0
    buffer_load_dwordx4 v170, s[12:15], s54 offen lds
    s_waitcnt lgkmcnt(14)
    v_mfma_f32_32x32x16_bf16 v[44:59], v[124:127], a[24:27], v[44:59]
    ds_read_b64_tr_b16 v[120:121], v167 offset:18432
    ds_read_b64_tr_b16 v[122:123], v167 offset:18944
    v_mfma_f32_32x32x16_bf16 v[60:75], v[128:131], a[24:27], v[60:75]
    ds_read_b64_tr_b16 v[124:125], v164 offset:20480
    ds_read_b64_tr_b16 v[126:127], v164 offset:20992
    v_mfma_f32_32x32x16_bf16 v[44:59], v[132:135], a[28:31], v[44:59]
    ds_read_b64_tr_b16 v[128:129], v167 offset:20480
    ds_read_b64_tr_b16 v[130:131], v167 offset:20992
    v_mfma_f32_32x32x16_bf16 v[60:75], v[136:139], a[28:31], v[60:75]
    ds_read_b64_tr_b16 v[132:133], v164 offset:22528
    ds_read_b64_tr_b16 v[134:135], v164 offset:23040
    s_waitcnt lgkmcnt(6)
    v_mfma_f32_32x32x16_bf16 v[44:59], v[108:111], a[32:35], v[44:59]
    ds_read_b64_tr_b16 v[136:137], v167 offset:22528
    ds_read_b64_tr_b16 v[138:139], v167 offset:23040
    s_add_u32 s54, s73, s71
    s_add_u32 m0, s46, 8192
    s_nop 0
    buffer_load_dwordx4 v170, s[12:15], s54 offen lds
    s_add_u32 s54, s54, 28672
    s_add_u32 m0, s46, 9216
    s_nop 0
    buffer_load_dwordx4 v170, s[12:15], s54 offen lds
    v_mfma_f32_32x32x16_bf16 v[60:75], v[112:115], a[32:35], v[60:75]
    ds_read_b64_tr_b16 v[108:109], v164 offset:24576
    ds_read_b64_tr_b16 v[110:111], v164 offset:25088
    s_add_u32 s54, s54, 28672
    s_add_u32 m0, s46, 10240
    s_nop 0
    buffer_load_dwordx4 v170, s[12:15], s54 offen lds
    s_add_u32 s54, s54, 28672
    s_add_u32 m0, s46, 11264
    s_nop 0
    buffer_load_dwordx4 v170, s[12:15], s54 offen lds
    v_mfma_f32_32x32x16_bf16 v[44:59], v[116:119], a[36:39], v[44:59]
    ds_read_b64_tr_b16 v[112:113], v167 offset:24576
    ds_read_b64_tr_b16 v[114:115], v167 offset:25088
    s_add_u32 s54, s54, 28672
    s_add_u32 m0, s46, 12288
    s_nop 0
    buffer_load_dwordx4 v170, s[12:15], s54 offen lds
    s_add_u32 s54, s54, 28672
    s_add_u32 m0, s46, 13312
    s_nop 0
    buffer_load_dwordx4 v170, s[12:15], s54 offen lds
    v_mfma_f32_32x32x16_bf16 v[60:75], v[120:123], a[36:39], v[60:75]
    ds_read_b64_tr_b16 v[116:117], v164 offset:26624
    ds_read_b64_tr_b16 v[118:119], v164 offset:27136
    s_add_u32 s54, s54, 28672
    s_add_u32 m0, s46, 14336
    s_nop 0
    buffer_load_dwordx4 v170, s[12:15], s54 offen lds
    s_add_u32 s54, s54, 28672
    s_add_u32 m0, s46, 15360
    s_nop 0
    buffer_load_dwordx4 v170, s[12:15], s54 offen lds
    s_waitcnt lgkmcnt(6)
    v_mfma_f32_32x32x16_bf16 v[44:59], v[124:127], a[40:43], v[44:59]
    ds_read_b64_tr_b16 v[120:121], v167 offset:26624
    ds_read_b64_tr_b16 v[122:123], v167 offset:27136
    v_mfma_f32_32x32x16_bf16 v[60:75], v[128:131], a[40:43], v[60:75]
    ds_read_b64_tr_b16 v[124:125], v164 offset:28672
    ds_read_b64_tr_b16 v[126:127], v164 offset:29184
    v_mfma_f32_32x32x16_bf16 v[44:59], v[132:135], a[44:47], v[44:59]
    ds_read_b64_tr_b16 v[128:129], v167 offset:28672
    ds_read_b64_tr_b16 v[130:131], v167 offset:29184
    s_waitcnt vmcnt(10)
    v_lshl_or_b32 v100, v93, 16, v92
    v_lshl_or_b32 v101, v95, 16, v94
    v_lshl_or_b32 v102, v97, 16, v96
    v_lshl_or_b32 v103, v99, 16, v98
    buffer_store_dwordx4 v[100:103], v1, s[20:23], s67 offen sc0 sc1
    s_add_u32 s64, s70, 1024
    s_lshr_b32 s48, s64, 4
    s_cmp_ge_u32 s48, 112
    s_cselect_b32 s40, s36, s32
    s_cselect_b32 s41, s37, s33
    s_cselect_b32 s42, s38, s34
    s_mov_b32 s43, 0x00020000
    s_cselect_b32 s49, 112, 0
    s_sub_u32 s48, s48, s49
    s_lshl_b32 s48, s48, 14
    s_and_b32 s49, s64, 15
    s_lshl_b32 s49, s49, 6
    s_add_u32 s65, s48, s49
    s_add_u32 s66, s65, 8192
    s_lshl_b32 s67, s64, 10
    s_add_u32 s67, s67, 2359296
    v_mfma_f32_32x32x16_bf16 v[60:75], v[136:139], a[44:47], v[60:75]
    ds_read_b64_tr_b16 v[132:133], v164 offset:30720
    ds_read_b64_tr_b16 v[134:135], v164 offset:31232
    buffer_load_ushort v92, v14, s[40:43], s65 offen
    s_waitcnt lgkmcnt(6)
    v_mfma_f32_32x32x16_bf16 v[44:59], v[108:111], a[48:51], v[44:59]
    ds_read_b64_tr_b16 v[136:137], v167 offset:30720
    ds_read_b64_tr_b16 v[138:139], v167 offset:31232
    buffer_load_ushort v93, v14, s[40:43], s65 offen offset:1024
    s_barrier
    ds_read_b128 a[64:67], v6 offset:16384
    ds_read_b128 a[68:71], v7 offset:16384
    ds_read_b128 a[72:75], v8 offset:16384
    ds_read_b128 a[76:79], v9 offset:16384
    ds_read_b128 a[80:83], v6 offset:20480
    ds_read_b128 a[84:87], v7 offset:20480
    ds_read_b128 a[88:91], v8 offset:20480
    ds_read_b128 a[92:95], v9 offset:20480
    v_mfma_f32_32x32x16_bf16 v[60:75], v[112:115], a[48:51], v[60:75]
    ds_read_b64_tr_b16 v[108:109], v164 offset:57344
    ds_read_b64_tr_b16 v[110:111], v164 offset:57856
    buffer_load_ushort v94, v14, s[40:43], s65 offen offset:2048
    v_mfma_f32_32x32x16_bf16 v[44:59], v[116:119], a[52:55], v[44:59]
    ds_read_b64_tr_b16 v[112:113], v167 offset:57344
    ds_read_b64_tr_b16 v[114:115], v167 offset:57856
    buffer_load_ushort v95, v14, s[40:43], s65 offen offset:3072
    v_mfma_f32_32x32x16_bf16 v[60:75], v[120:123], a[52:55], v[60:75]
    ds_read_b64_tr_b16 v[116:117], v164 offset:59392
    ds_read_b64_tr_b16 v[118:119], v164 offset:59904
    buffer_load_ushort v96, v14, s[40:43], s66 offen
    s_waitcnt lgkmcnt(14)
    v_mfma_f32_32x32x16_bf16 v[44:59], v[124:127], a[56:59], v[44:59]
    ds_read_b64_tr_b16 v[120:121], v167 offset:59392
    ds_read_b64_tr_b16 v[122:123], v167 offset:59904
    buffer_load_ushort v97, v14, s[40:43], s66 offen offset:1024
    v_mfma_f32_32x32x16_bf16 v[60:75], v[128:131], a[56:59], v[60:75]
    ds_read_b64_tr_b16 v[124:125], v165 offset:24576
    ds_read_b64_tr_b16 v[126:127], v165 offset:25088
    buffer_load_ushort v98, v14, s[40:43], s66 offen offset:2048
    v_mfma_f32_32x32x16_bf16 v[44:59], v[132:135], a[60:63], v[44:59]
    ds_read_b64_tr_b16 v[128:129], v168 offset:24576
    ds_read_b64_tr_b16 v[130:131], v168 offset:25088
    buffer_load_ushort v99, v14, s[40:43], s66 offen offset:3072
    v_mfma_f32_32x32x16_bf16 v[60:75], v[136:139], a[60:63], v[60:75]
    ds_read_b64_tr_b16 v[132:133], v165 offset:26624
    ds_read_b64_tr_b16 v[134:135], v165 offset:27136
    s_waitcnt lgkmcnt(6)
    v_mfma_f32_32x32x16_bf16 v[44:59], v[108:111], a[64:67], v[44:59]
    ds_read_b64_tr_b16 v[136:137], v168 offset:26624
    ds_read_b64_tr_b16 v[138:139], v168 offset:27136
    s_add_u32 s54, s54, 28672
    s_add_u32 m0, s46, 16384
    s_nop 0
    buffer_load_dwordx4 v170, s[12:15], s54 offen lds
    s_add_u32 s54, s54, 28672
    s_add_u32 m0, s46, 17408
    s_nop 0
    buffer_load_dwordx4 v170, s[12:15], s54 offen lds
    v_mfma_f32_32x32x16_bf16 v[60:75], v[112:115], a[64:67], v[60:75]
    ds_read_b64_tr_b16 v[108:109], v165 offset:57344
    ds_read_b64_tr_b16 v[110:111], v165 offset:57856
    s_add_u32 s54, s54, 28672
    s_add_u32 m0, s46, 18432
    s_nop 0
    buffer_load_dwordx4 v170, s[12:15], s54 offen lds
    s_add_u32 s54, s54, 28672
    s_add_u32 m0, s46, 19456
    s_nop 0
    buffer_load_dwordx4 v170, s[12:15], s54 offen lds
    v_mfma_f32_32x32x16_bf16 v[44:59], v[116:119], a[68:71], v[44:59]
    ds_read_b64_tr_b16 v[112:113], v168 offset:57344
    ds_read_b64_tr_b16 v[114:115], v168 offset:57856
    s_add_u32 s54, s54, 28672
    s_add_u32 m0, s46, 20480
    s_nop 0
    buffer_load_dwordx4 v170, s[12:15], s54 offen lds
    s_add_u32 s54, s54, 28672
    s_add_u32 m0, s46, 21504
    s_nop 0
    buffer_load_dwordx4 v170, s[12:15], s54 offen lds
    v_mfma_f32_32x32x16_bf16 v[60:75], v[120:123], a[68:71], v[60:75]
    ds_read_b64_tr_b16 v[116:117], v165 offset:59392
    ds_read_b64_tr_b16 v[118:119], v165 offset:59904
    s_add_u32 s54, s54, 28672
    s_add_u32 m0, s46, 22528
    s_nop 0
    buffer_load_dwordx4 v170, s[12:15], s54 offen lds
    s_add_u32 s54, s54, 28672
    s_add_u32 m0, s46, 23552
    s_nop 0
    buffer_load_dwordx4 v170, s[12:15], s54 offen lds
    s_waitcnt lgkmcnt(6)
    v_mfma_f32_32x32x16_bf16 v[44:59], v[124:127], a[72:75], v[44:59]
    ds_read_b64_tr_b16 v[120:121], v168 offset:59392
    ds_read_b64_tr_b16 v[122:123], v168 offset:59904
    v_mfma_f32_32x32x16_bf16 v[60:75], v[128:131], a[72:75], v[60:75]
    ds_read_b64_tr_b16 v[124:125], v166 offset:24576
    ds_read_b64_tr_b16 v[126:127], v166 offset:25088
    v_mfma_f32_32x32x16_bf16 v[44:59], v[132:135], a[76:79], v[44:59]
    ds_read_b64_tr_b16 v[128:129], v169 offset:24576
    ds_read_b64_tr_b16 v[130:131], v169 offset:25088
    v_mfma_f32_32x32x16_bf16 v[60:75], v[136:139], a[76:79], v[60:75]
    ds_read_b64_tr_b16 v[132:133], v166 offset:26624
    ds_read_b64_tr_b16 v[134:135], v166 offset:27136
    s_waitcnt lgkmcnt(6)
    v_mfma_f32_32x32x16_bf16 v[44:59], v[108:111], a[80:83], v[44:59]
    ds_read_b64_tr_b16 v[136:137], v169 offset:26624
    ds_read_b64_tr_b16 v[138:139], v169 offset:27136
    s_waitcnt vmcnt(25)
    s_barrier
    ds_read_b128 a[96:99], v6 offset:0
    ds_read_b128 a[100:103], v7 offset:0
    ds_read_b128 a[104:107], v8 offset:0
    ds_read_b128 a[108:111], v9 offset:0
    ds_read_b128 a[112:115], v6 offset:4096
    ds_read_b128 a[116:119], v7 offset:4096
    ds_read_b128 a[120:123], v8 offset:4096
    ds_read_b128 a[124:127], v9 offset:4096
    v_mfma_f32_32x32x16_bf16 v[60:75], v[112:115], a[80:83], v[60:75]
    ds_read_b64_tr_b16 v[108:109], v164 offset:61440
    ds_read_b64_tr_b16 v[110:111], v164 offset:61952
    v_mfma_f32_32x32x16_bf16 v[44:59], v[116:119], a[84:87], v[44:59]
    ds_read_b64_tr_b16 v[112:113], v167 offset:61440
    ds_read_b64_tr_b16 v[114:115], v167 offset:61952
    s_waitcnt vmcnt(8)
    v_lshl_or_b32 v100, v93, 16, v92
    v_lshl_or_b32 v101, v95, 16, v94
    v_lshl_or_b32 v102, v97, 16, v96
    v_lshl_or_b32 v103, v99, 16, v98
    buffer_store_dwordx4 v[100:103], v1, s[20:23], s67 offen sc0 sc1
    v_mfma_f32_32x32x16_bf16 v[60:75], v[120:123], a[84:87], v[60:75]
    ds_read_b64_tr_b16 v[116:117], v164 offset:63488
    ds_read_b64_tr_b16 v[118:119], v164 offset:64000
    s_waitcnt lgkmcnt(14)
    v_mfma_f32_32x32x16_bf16 v[44:59], v[124:127], a[88:91], v[44:59]
    ds_read_b64_tr_b16 v[120:121], v167 offset:63488
    ds_read_b64_tr_b16 v[122:123], v167 offset:64000
    v_mfma_f32_32x32x16_bf16 v[60:75], v[128:131], a[88:91], v[60:75]
    ds_read_b64_tr_b16 v[124:125], v165 offset:28672
    ds_read_b64_tr_b16 v[126:127], v165 offset:29184
    v_mfma_f32_32x32x16_bf16 v[44:59], v[132:135], a[92:95], v[44:59]
    ds_read_b64_tr_b16 v[128:129], v168 offset:28672
    ds_read_b64_tr_b16 v[130:131], v168 offset:29184
    v_mfma_f32_32x32x16_bf16 v[60:75], v[136:139], a[92:95], v[60:75]
    ds_read_b64_tr_b16 v[132:133], v165 offset:30720
    ds_read_b64_tr_b16 v[134:135], v165 offset:31232
    s_waitcnt lgkmcnt(6)
    v_mfma_f32_32x32x16_bf16 v[44:59], v[108:111], a[96:99], v[44:59]
    ds_read_b64_tr_b16 v[136:137], v168 offset:30720
    ds_read_b64_tr_b16 v[138:139], v168 offset:31232
    s_mov_b32 m0, s46
    s_lshl_b32 s54, s44, 12
    buffer_load_dwordx4 v1, s[28:31], s54 offen lds
    s_add_u32 m0, s46, 1024
    s_add_u32 s54, s54, 1024
    buffer_load_dwordx4 v1, s[28:31], s54 offen lds
    v_mfma_f32_32x32x16_bf16 v[60:75], v[112:115], a[96:99], v[60:75]
    ds_read_b64_tr_b16 v[108:109], v165 offset:61440
    ds_read_b64_tr_b16 v[110:111], v165 offset:61952
    s_add_u32 m0, s46, 2048
    s_add_u32 s54, s54, 1024
    buffer_load_dwordx4 v1, s[28:31], s54 offen lds
    s_add_u32 m0, s46, 3072
    s_add_u32 s54, s54, 1024
    buffer_load_dwordx4 v1, s[28:31], s54 offen lds
    v_mfma_f32_32x32x16_bf16 v[44:59], v[116:119], a[100:103], v[44:59]
    ds_read_b64_tr_b16 v[112:113], v168 offset:61440
    ds_read_b64_tr_b16 v[114:115], v168 offset:61952
    v_mfma_f32_32x32x16_bf16 v[60:75], v[120:123], a[100:103], v[60:75]
    ds_read_b64_tr_b16 v[116:117], v165 offset:63488
    ds_read_b64_tr_b16 v[118:119], v165 offset:64000
    s_waitcnt lgkmcnt(6)
    v_mfma_f32_32x32x16_bf16 v[44:59], v[124:127], a[104:107], v[44:59]
    ds_read_b64_tr_b16 v[120:121], v168 offset:63488
    ds_read_b64_tr_b16 v[122:123], v168 offset:64000
    v_mfma_f32_32x32x16_bf16 v[60:75], v[128:131], a[104:107], v[60:75]
    ds_read_b64_tr_b16 v[124:125], v166 offset:28672
    ds_read_b64_tr_b16 v[126:127], v166 offset:29184
    v_mfma_f32_32x32x16_bf16 v[44:59], v[132:135], a[108:111], v[44:59]
    ds_read_b64_tr_b16 v[128:129], v169 offset:28672
    ds_read_b64_tr_b16 v[130:131], v169 offset:29184
    v_mfma_f32_32x32x16_bf16 v[60:75], v[136:139], a[108:111], v[60:75]
    ds_read_b64_tr_b16 v[132:133], v166 offset:30720
    ds_read_b64_tr_b16 v[134:135], v166 offset:31232
    s_waitcnt lgkmcnt(6)
    v_mfma_f32_32x32x16_bf16 v[44:59], v[108:111], a[112:115], v[44:59]
    ds_read_b64_tr_b16 v[136:137], v169 offset:30720
    ds_read_b64_tr_b16 v[138:139], v169 offset:31232
    s_waitcnt vmcnt(5)
    s_barrier
    v_mfma_f32_32x32x16_bf16 v[60:75], v[112:115], a[112:115], v[60:75]
    ds_read_b64_tr_b16 v[108:109], v164 offset:40960
    ds_read_b64_tr_b16 v[110:111], v164 offset:41472
    v_mfma_f32_32x32x16_bf16 v[44:59], v[116:119], a[116:119], v[44:59]
    ds_read_b64_tr_b16 v[112:113], v164 offset:43008
    ds_read_b64_tr_b16 v[114:115], v164 offset:43520
    v_mfma_f32_32x32x16_bf16 v[60:75], v[120:123], a[116:119], v[60:75]
    ds_read_b64_tr_b16 v[116:117], v164 offset:45056
    ds_read_b64_tr_b16 v[118:119], v164 offset:45568
    s_waitcnt lgkmcnt(6)
    v_mfma_f32_32x32x16_bf16 v[44:59], v[124:127], a[120:123], v[44:59]
    ds_read_b64_tr_b16 v[120:121], v164 offset:47104
    ds_read_b64_tr_b16 v[122:123], v164 offset:47616
    v_mfma_f32_32x32x16_bf16 v[60:75], v[128:131], a[120:123], v[60:75]
    ds_read_b64_tr_b16 v[124:125], v164 offset:49152
    ds_read_b64_tr_b16 v[126:127], v164 offset:49664
    v_mfma_f32_32x32x16_bf16 v[44:59], v[132:135], a[124:127], v[44:59]
    ds_read_b64_tr_b16 v[128:129], v164 offset:51200
    ds_read_b64_tr_b16 v[130:131], v164 offset:51712
    v_mfma_f32_32x32x16_bf16 v[60:75], v[136:139], a[124:127], v[60:75]
    ds_read_b64_tr_b16 v[132:133], v164 offset:53248
    ds_read_b64_tr_b16 v[134:135], v164 offset:53760
    v_mov_b32 v20, v18
    s_nop 1
    v_mfma_f32_32x32x16_bf16 v[140:155], v[20:23], v[24:27], 0
    s_waitcnt lgkmcnt(6)
    v_mfma_f32_32x32x16_bf16 v[140:155], v[108:111], a[0:3], v[140:155]
    ds_read_b64_tr_b16 v[136:137], v164 offset:55296
    ds_read_b64_tr_b16 v[138:139], v164 offset:55808
    v_mul_f32 v84, s60, v44
    v_mul_f32 v85, s60, v45
    v_exp_f32 v84, v84
    v_mfma_f32_32x32x16_bf16 v[140:155], v[112:115], a[4:7], v[140:155]
    ds_read_b64_tr_b16 v[108:109], v165 offset:8192
    ds_read_b64_tr_b16 v[110:111], v165 offset:8704
    v_exp_f32 v85, v85
    v_fma_f32 v86, v84, -0.5, -1.0
    v_fma_f32 v87, v85, -0.5, -1.0
    v_fma_f32 v86, v84, v86, -1.0
    v_mfma_f32_32x32x16_bf16 v[140:155], v[116:119], a[8:11], v[140:155]
    ds_read_b64_tr_b16 v[112:113], v165 offset:10240
    ds_read_b64_tr_b16 v[114:115], v165 offset:10752
    v_fma_f32 v87, v85, v87, -1.0
    v_rcp_f32 v86, v86
    v_rcp_f32 v87, v87
    v_mfma_f32_32x32x16_bf16 v[140:155], v[120:123], a[12:15], v[140:155]
    ds_read_b64_tr_b16 v[116:117], v165 offset:12288
    ds_read_b64_tr_b16 v[118:119], v165 offset:12800
    v_fma_f32 v86, v44, v86, v44
    v_fma_f32 v87, v45, v87, v45
    v_cvt_pk_bf16_f32 v76, v86, v87
    s_waitcnt lgkmcnt(6)
    v_mfma_f32_32x32x16_bf16 v[140:155], v[124:127], a[16:19], v[140:155]
    ds_read_b64_tr_b16 v[120:121], v165 offset:14336
    ds_read_b64_tr_b16 v[122:123], v165 offset:14848
    v_mul_f32 v88, s60, v46
    v_mul_f32 v89, s60, v47
    v_exp_f32 v88, v88
    v_mfma_f32_32x32x16_bf16 v[140:155], v[128:131], a[20:23], v[140:155]
    ds_read_b64_tr_b16 v[124:125], v165 offset:16384
    ds_read_b64_tr_b16 v[126:127], v165 offset:16896
    v_exp_f32 v89, v89
    v_fma_f32 v90, v88, -0.5, -1.0
    v_fma_f32 v91, v89, -0.5, -1.0
    v_fma_f32 v90, v88, v90, -1.0
    v_mfma_f32_32x32x16_bf16 v[140:155], v[132:135], a[24:27], v[140:155]
    ds_read_b64_tr_b16 v[128:129], v165 offset:18432
    ds_read_b64_tr_b16 v[130:131], v165 offset:18944
    v_fma_f32 v91, v89, v91, -1.0
    v_rcp_f32 v90, v90
    v_rcp_f32 v91, v91
    v_mfma_f32_32x32x16_bf16 v[140:155], v[136:139], a[28:31], v[140:155]
    ds_read_b64_tr_b16 v[132:133], v165 offset:20480
    ds_read_b64_tr_b16 v[134:135], v165 offset:20992
    v_fma_f32 v90, v46, v90, v46
    v_fma_f32 v91, v47, v91, v47
    v_cvt_pk_bf16_f32 v77, v90, v91
    s_waitcnt lgkmcnt(6)
    v_mfma_f32_32x32x16_bf16 v[140:155], v[108:111], a[32:35], v[140:155]
    ds_read_b64_tr_b16 v[136:137], v165 offset:22528
    ds_read_b64_tr_b16 v[138:139], v165 offset:23040
    v_mul_f32 v84, s60, v48
    v_mul_f32 v85, s60, v49
    v_exp_f32 v84, v84
    v_mfma_f32_32x32x16_bf16 v[140:155], v[112:115], a[36:39], v[140:155]
    ds_read_b64_tr_b16 v[108:109], v165 offset:40960
    ds_read_b64_tr_b16 v[110:111], v165 offset:41472
    v_exp_f32 v85, v85
    v_fma_f32 v86, v84, -0.5, -1.0
    v_fma_f32 v87, v85, -0.5, -1.0
    v_fma_f32 v86, v84, v86, -1.0
    v_mfma_f32_32x32x16_bf16 v[140:155], v[116:119], a[40:43], v[140:155]
    ds_read_b64_tr_b16 v[112:113], v165 offset:43008
    ds_read_b64_tr_b16 v[114:115], v165 offset:43520
    v_fma_f32 v87, v85, v87, -1.0
    v_rcp_f32 v86, v86
    v_rcp_f32 v87, v87
    v_mfma_f32_32x32x16_bf16 v[140:155], v[120:123], a[44:47], v[140:155]
    ds_read_b64_tr_b16 v[116:117], v165 offset:45056
    ds_read_b64_tr_b16 v[118:119], v165 offset:45568
    v_fma_f32 v86, v48, v86, v48
    v_fma_f32 v87, v49, v87, v49
    v_cvt_pk_bf16_f32 v78, v86, v87
    s_waitcnt lgkmcnt(6)
    v_mfma_f32_32x32x16_bf16 v[140:155], v[124:127], a[48:51], v[140:155]
    ds_read_b64_tr_b16 v[120:121], v165 offset:47104
    ds_read_b64_tr_b16 v[122:123], v165 offset:47616
    v_mul_f32 v88, s60, v50
    v_mul_f32 v89, s60, v51
    v_exp_f32 v88, v88
    v_mfma_f32_32x32x16_bf16 v[140:155], v[128:131], a[52:55], v[140:155]
    ds_read_b64_tr_b16 v[124:125], v165 offset:49152
    ds_read_b64_tr_b16 v[126:127], v165 offset:49664
    v_exp_f32 v89, v89
    v_fma_f32 v90, v88, -0.5, -1.0
    v_fma_f32 v91, v89, -0.5, -1.0
    v_fma_f32 v90, v88, v90, -1.0
    v_mfma_f32_32x32x16_bf16 v[140:155], v[132:135], a[56:59], v[140:155]
    ds_read_b64_tr_b16 v[128:129], v165 offset:51200
    ds_read_b64_tr_b16 v[130:131], v165 offset:51712
    v_fma_f32 v91, v89, v91, -1.0
    v_rcp_f32 v90, v90
    v_rcp_f32 v91, v91
    v_mfma_f32_32x32x16_bf16 v[140:155], v[136:139], a[60:63], v[140:155]
    ds_read_b64_tr_b16 v[132:133], v165 offset:53248
    ds_read_b64_tr_b16 v[134:135], v165 offset:53760
    v_fma_f32 v90, v50, v90, v50
    v_fma_f32 v91, v51, v91, v51
    v_cvt_pk_bf16_f32 v79, v90, v91
    s_add_u32 s69, s57, 0
    buffer_store_dwordx4 v[76:79], v1, s[20:23], s69 offen sc0 sc1
    s_waitcnt lgkmcnt(6)
    v_mfma_f32_32x32x16_bf16 v[140:155], v[108:111], a[64:67], v[140:155]
    ds_read_b64_tr_b16 v[136:137], v165 offset:55296
    ds_read_b64_tr_b16 v[138:139], v165 offset:55808
    v_mul_f32 v84, s60, v52
    v_mul_f32 v85, s60, v53
    v_exp_f32 v84, v84
    v_mfma_f32_32x32x16_bf16 v[140:155], v[112:115], a[68:71], v[140:155]
    ds_read_b64_tr_b16 v[108:109], v166 offset:8192
    ds_read_b64_tr_b16 v[110:111], v166 offset:8704
    v_exp_f32 v85, v85
    v_fma_f32 v86, v84, -0.5, -1.0
    v_fma_f32 v87, v85, -0.5, -1.0
    v_fma_f32 v86, v84, v86, -1.0
    v_mfma_f32_32x32x16_bf16 v[140:155], v[116:119], a[72:75], v[140:155]
    ds_read_b64_tr_b16 v[112:113], v166 offset:10240
    ds_read_b64_tr_b16 v[114:115], v166 offset:10752
    v_fma_f32 v87, v85, v87, -1.0
    v_rcp_f32 v86, v86
    v_rcp_f32 v87, v87
    v_mfma_f32_32x32x16_bf16 v[140:155], v[120:123], a[76:79], v[140:155]
    ds_read_b64_tr_b16 v[116:117], v166 offset:12288
    ds_read_b64_tr_b16 v[118:119], v166 offset:12800
    v_fma_f32 v86, v52, v86, v52
    v_fma_f32 v87, v53, v87, v53
    v_cvt_pk_bf16_f32 v80, v86, v87
    s_waitcnt lgkmcnt(6)
    v_mfma_f32_32x32x16_bf16 v[140:155], v[124:127], a[80:83], v[140:155]
    ds_read_b64_tr_b16 v[120:121], v166 offset:14336
    ds_read_b64_tr_b16 v[122:123], v166 offset:14848
    v_mul_f32 v88, s60, v54
    v_mul_f32 v89, s60, v55
    v_exp_f32 v88, v88
    v_mfma_f32_32x32x16_bf16 v[140:155], v[128:131], a[84:87], v[140:155]
    ds_read_b64_tr_b16 v[124:125], v166 offset:16384
    ds_read_b64_tr_b16 v[126:127], v166 offset:16896
    v_exp_f32 v89, v89
    v_fma_f32 v90, v88, -0.5, -1.0
    v_fma_f32 v91, v89, -0.5, -1.0
    v_fma_f32 v90, v88, v90, -1.0
    v_mfma_f32_32x32x16_bf16 v[140:155], v[132:135], a[88:91], v[140:155]
    ds_read_b64_tr_b16 v[128:129], v166 offset:18432
    ds_read_b64_tr_b16 v[130:131], v166 offset:18944
    v_fma_f32 v91, v89, v91, -1.0
    v_rcp_f32 v90, v90
    v_rcp_f32 v91, v91
    v_mfma_f32_32x32x16_bf16 v[140:155], v[136:139], a[92:95], v[140:155]
    ds_read_b64_tr_b16 v[132:133], v166 offset:20480
    ds_read_b64_tr_b16 v[134:135], v166 offset:20992
    v_fma_f32 v90, v54, v90, v54
    v_fma_f32 v91, v55, v91, v55
    v_cvt_pk_bf16_f32 v81, v90, v91
    s_waitcnt lgkmcnt(6)
    v_mfma_f32_32x32x16_bf16 v[140:155], v[108:111], a[96:99], v[140:155]
    ds_read_b64_tr_b16 v[136:137], v166 offset:22528
    ds_read_b64_tr_b16 v[138:139], v166 offset:23040
    v_mul_f32 v84, s60, v56
    v_mul_f32 v85, s60, v57
    v_exp_f32 v84, v84
    v_mfma_f32_32x32x16_bf16 v[140:155], v[112:115], a[100:103], v[140:155]
    ds_read_b64_tr_b16 v[108:109], v167 offset:40960
    ds_read_b64_tr_b16 v[110:111], v167 offset:41472
    v_exp_f32 v85, v85
    v_fma_f32 v86, v84, -0.5, -1.0
    v_fma_f32 v87, v85, -0.5, -1.0
    v_fma_f32 v86, v84, v86, -1.0
    v_mfma_f32_32x32x16_bf16 v[140:155], v[116:119], a[104:107], v[140:155]
    ds_read_b64_tr_b16 v[112:113], v167 offset:43008
    ds_read_b64_tr_b16 v[114:115], v167 offset:43520
    v_fma_f32 v87, v85, v87, -1.0
    v_rcp_f32 v86, v86
    v_rcp_f32 v87, v87
    v_mfma_f32_32x32x16_bf16 v[140:155], v[120:123], a[108:111], v[140:155]
    ds_read_b64_tr_b16 v[116:117], v167 offset:45056
    ds_read_b64_tr_b16 v[118:119], v167 offset:45568
    v_fma_f32 v86, v56, v86, v56
    v_fma_f32 v87, v57, v87, v57
    v_cvt_pk_bf16_f32 v82, v86, v87
    s_waitcnt lgkmcnt(6)
    v_mfma_f32_32x32x16_bf16 v[140:155], v[124:127], a[112:115], v[140:155]
    ds_read_b64_tr_b16 v[120:121], v167 offset:47104
    ds_read_b64_tr_b16 v[122:123], v167 offset:47616
    v_mul_f32 v88, s60, v58
    v_mul_f32 v89, s60, v59
    v_exp_f32 v88, v88
    v_mfma_f32_32x32x16_bf16 v[140:155], v[128:131], a[116:119], v[140:155]
    ds_read_b64_tr_b16 v[124:125], v167 offset:49152
    ds_read_b64_tr_b16 v[126:127], v167 offset:49664
    v_exp_f32 v89, v89
    v_fma_f32 v90, v88, -0.5, -1.0
    v_fma_f32 v91, v89, -0.5, -1.0
    v_fma_f32 v90, v88, v90, -1.0
    v_mfma_f32_32x32x16_bf16 v[140:155], v[132:135], a[120:123], v[140:155]
    ds_read_b64_tr_b16 v[128:129], v167 offset:51200
    ds_read_b64_tr_b16 v[130:131], v167 offset:51712
    v_fma_f32 v91, v89, v91, -1.0
    v_rcp_f32 v90, v90
    v_rcp_f32 v91, v91
    v_mfma_f32_32x32x16_bf16 v[140:155], v[136:139], a[124:127], v[140:155]
    ds_read_b64_tr_b16 v[132:133], v167 offset:53248
    ds_read_b64_tr_b16 v[134:135], v167 offset:53760
    v_fma_f32 v90, v58, v90, v58
    v_fma_f32 v91, v59, v91, v59
    v_cvt_pk_bf16_f32 v83, v90, v91
    s_add_u32 s69, s57, 1024
    buffer_store_dwordx4 v[80:83], v1, s[20:23], s69 offen sc0 sc1
    v_mov_b32 v20, v19
    s_nop 1
    v_mfma_f32_32x32x16_bf16 v[44:59], v[20:23], v[24:27], 0
    s_waitcnt lgkmcnt(6)
    v_mfma_f32_32x32x16_bf16 v[44:59], v[108:111], a[0:3], v[44:59]
    ds_read_b64_tr_b16 v[136:137], v167 offset:55296
    ds_read_b64_tr_b16 v[138:139], v167 offset:55808
    v_mul_f32 v84, s60, v60
    v_mul_f32 v85, s60, v61
    v_exp_f32 v84, v84
    v_mfma_f32_32x32x16_bf16 v[44:59], v[112:115], a[4:7], v[44:59]
    ds_read_b64_tr_b16 v[108:109], v168 offset:8192
    ds_read_b64_tr_b16 v[110:111], v168 offset:8704
    v_exp_f32 v85, v85
    v_fma_f32 v86, v84, -0.5, -1.0
    v_fma_f32 v87, v85, -0.5, -1.0
    v_fma_f32 v86, v84, v86, -1.0
    v_mfma_f32_32x32x16_bf16 v[44:59], v[116:119], a[8:11], v[44:59]
    ds_read_b64_tr_b16 v[112:113], v168 offset:10240
    ds_read_b64_tr_b16 v[114:115], v168 offset:10752
    v_fma_f32 v87, v85, v87, -1.0
    v_rcp_f32 v86, v86
    v_rcp_f32 v87, v87
    v_mfma_f32_32x32x16_bf16 v[44:59], v[120:123], a[12:15], v[44:59]
    ds_read_b64_tr_b16 v[116:117], v168 offset:12288
    ds_read_b64_tr_b16 v[118:119], v168 offset:12800
    v_fma_f32 v86, v60, v86, v60
    v_fma_f32 v87, v61, v87, v61
    v_cvt_pk_bf16_f32 v76, v86, v87
    s_waitcnt lgkmcnt(6)
    v_mfma_f32_32x32x16_bf16 v[44:59], v[124:127], a[16:19], v[44:59]
    ds_read_b64_tr_b16 v[120:121], v168 offset:14336
    ds_read_b64_tr_b16 v[122:123], v168 offset:14848
    v_mul_f32 v88, s60, v62
    v_mul_f32 v89, s60, v63
    v_exp_f32 v88, v88
    v_mfma_f32_32x32x16_bf16 v[44:59], v[128:131], a[20:23], v[44:59]
    ds_read_b64_tr_b16 v[124:125], v168 offset:16384
    ds_read_b64_tr_b16 v[126:127], v168 offset:16896
    v_exp_f32 v89, v89
    v_fma_f32 v90, v88, -0.5, -1.0
    v_fma_f32 v91, v89, -0.5, -1.0
    v_fma_f32 v90, v88, v90, -1.0
    v_mfma_f32_32x32x16_bf16 v[44:59], v[132:135], a[24:27], v[44:59]
    ds_read_b64_tr_b16 v[128:129], v168 offset:18432
    ds_read_b64_tr_b16 v[130:131], v168 offset:18944
    v_fma_f32 v91, v89, v91, -1.0
    v_rcp_f32 v90, v90
    v_rcp_f32 v91, v91
    v_mfma_f32_32x32x16_bf16 v[44:59], v[136:139], a[28:31], v[44:59]
    ds_read_b64_tr_b16 v[132:133], v168 offset:20480
    ds_read_b64_tr_b16 v[134:135], v168 offset:20992
    v_fma_f32 v90, v62, v90, v62
    v_fma_f32 v91, v63, v91, v63
    v_cvt_pk_bf16_f32 v77, v90, v91
    s_waitcnt lgkmcnt(6)
    v_mfma_f32_32x32x16_bf16 v[44:59], v[108:111], a[32:35], v[44:59]
    ds_read_b64_tr_b16 v[136:137], v168 offset:22528
    ds_read_b64_tr_b16 v[138:139], v168 offset:23040
    v_mul_f32 v84, s60, v64
    v_mul_f32 v85, s60, v65
    v_exp_f32 v84, v84
    v_mfma_f32_32x32x16_bf16 v[44:59], v[112:115], a[36:39], v[44:59]
    ds_read_b64_tr_b16 v[108:109], v168 offset:40960
    ds_read_b64_tr_b16 v[110:111], v168 offset:41472
    v_exp_f32 v85, v85
    v_fma_f32 v86, v84, -0.5, -1.0
    v_fma_f32 v87, v85, -0.5, -1.0
    v_fma_f32 v86, v84, v86, -1.0
    v_mfma_f32_32x32x16_bf16 v[44:59], v[116:119], a[40:43], v[44:59]
    ds_read_b64_tr_b16 v[112:113], v168 offset:43008
    ds_read_b64_tr_b16 v[114:115], v168 offset:43520
    v_fma_f32 v87, v85, v87, -1.0
    v_rcp_f32 v86, v86
    v_rcp_f32 v87, v87
    v_mfma_f32_32x32x16_bf16 v[44:59], v[120:123], a[44:47], v[44:59]
    ds_read_b64_tr_b16 v[116:117], v168 offset:45056
    ds_read_b64_tr_b16 v[118:119], v168 offset:45568
    v_fma_f32 v86, v64, v86, v64
    v_fma_f32 v87, v65, v87, v65
    v_cvt_pk_bf16_f32 v78, v86, v87
    s_waitcnt lgkmcnt(6)
    v_mfma_f32_32x32x16_bf16 v[44:59], v[124:127], a[48:51], v[44:59]
    ds_read_b64_tr_b16 v[120:121], v168 offset:47104
    ds_read_b64_tr_b16 v[122:123], v168 offset:47616
    v_mul_f32 v88, s60, v66
    v_mul_f32 v89, s60, v67
    v_exp_f32 v88, v88
    v_mfma_f32_32x32x16_bf16 v[44:59], v[128:131], a[52:55], v[44:59]
    ds_read_b64_tr_b16 v[124:125], v168 offset:49152
    ds_read_b64_tr_b16 v[126:127], v168 offset:49664
    v_exp_f32 v89, v89
    v_fma_f32 v90, v88, -0.5, -1.0
    v_fma_f32 v91, v89, -0.5, -1.0
    v_fma_f32 v90, v88, v90, -1.0
    v_mfma_f32_32x32x16_bf16 v[44:59], v[132:135], a[56:59], v[44:59]
    ds_read_b64_tr_b16 v[128:129], v168 offset:51200
    ds_read_b64_tr_b16 v[130:131], v168 offset:51712
    v_fma_f32 v91, v89, v91, -1.0
    v_rcp_f32 v90, v90
    v_rcp_f32 v91, v91
    v_mfma_f32_32x32x16_bf16 v[44:59], v[136:139], a[60:63], v[44:59]
    ds_read_b64_tr_b16 v[132:133], v168 offset:53248
    ds_read_b64_tr_b16 v[134:135], v168 offset:53760
    v_fma_f32 v90, v66, v90, v66
    v_fma_f32 v91, v67, v91, v67
    v_cvt_pk_bf16_f32 v79, v90, v91
    s_add_u32 s69, s57, 2048
    buffer_store_dwordx4 v[76:79], v1, s[20:23], s69 offen sc0 sc1
    s_waitcnt lgkmcnt(6)
    v_mfma_f32_32x32x16_bf16 v[44:59], v[108:111], a[64:67], v[44:59]
    ds_read_b64_tr_b16 v[136:137], v168 offset:55296
    ds_read_b64_tr_b16 v[138:139], v168 offset:55808
    v_mul_f32 v84, s60, v68
    v_mul_f32 v85, s60, v69
    v_exp_f32 v84, v84
    v_mfma_f32_32x32x16_bf16 v[44:59], v[112:115], a[68:71], v[44:59]
    ds_read_b64_tr_b16 v[108:109], v169 offset:8192
    ds_read_b64_tr_b16 v[110:111], v169 offset:8704
    v_exp_f32 v85, v85
    v_fma_f32 v86, v84, -0.5, -1.0
    v_fma_f32 v87, v85, -0.5, -1.0
    v_fma_f32 v86, v84, v86, -1.0
    v_mfma_f32_32x32x16_bf16 v[44:59], v[116:119], a[72:75], v[44:59]
    ds_read_b64_tr_b16 v[112:113], v169 offset:10240
    ds_read_b64_tr_b16 v[114:115], v169 offset:10752
    v_fma_f32 v87, v85, v87, -1.0
    v_rcp_f32 v86, v86
    v_rcp_f32 v87, v87
    v_mfma_f32_32x32x16_bf16 v[44:59], v[120:123], a[76:79], v[44:59]
    ds_read_b64_tr_b16 v[116:117], v169 offset:12288
    ds_read_b64_tr_b16 v[118:119], v169 offset:12800
    v_fma_f32 v86, v68, v86, v68
    v_fma_f32 v87, v69, v87, v69
    v_cvt_pk_bf16_f32 v80, v86, v87
    s_waitcnt lgkmcnt(6)
    v_mfma_f32_32x32x16_bf16 v[44:59], v[124:127], a[80:83], v[44:59]
    ds_read_b64_tr_b16 v[120:121], v169 offset:14336
    ds_read_b64_tr_b16 v[122:123], v169 offset:14848
    v_mul_f32 v88, s60, v70
    v_mul_f32 v89, s60, v71
    v_exp_f32 v88, v88
    v_mfma_f32_32x32x16_bf16 v[44:59], v[128:131], a[84:87], v[44:59]
    ds_read_b64_tr_b16 v[124:125], v169 offset:16384
    ds_read_b64_tr_b16 v[126:127], v169 offset:16896
    v_exp_f32 v89, v89
    v_fma_f32 v90, v88, -0.5, -1.0
    v_fma_f32 v91, v89, -0.5, -1.0
    v_fma_f32 v90, v88, v90, -1.0
    v_mfma_f32_32x32x16_bf16 v[44:59], v[132:135], a[88:91], v[44:59]
    ds_read_b64_tr_b16 v[128:129], v169 offset:18432
    ds_read_b64_tr_b16 v[130:131], v169 offset:18944
    v_fma_f32 v91, v89, v91, -1.0
    v_rcp_f32 v90, v90
    v_rcp_f32 v91, v91
    v_mfma_f32_32x32x16_bf16 v[44:59], v[136:139], a[92:95], v[44:59]
    ds_read_b64_tr_b16 v[132:133], v169 offset:20480
    ds_read_b64_tr_b16 v[134:135], v169 offset:20992
    v_fma_f32 v90, v70, v90, v70
    v_fma_f32 v91, v71, v91, v71
    v_cvt_pk_bf16_f32 v81, v90, v91
    s_waitcnt lgkmcnt(6)
    v_mfma_f32_32x32x16_bf16 v[44:59], v[108:111], a[96:99], v[44:59]
    ds_read_b64_tr_b16 v[136:137], v169 offset:22528
    ds_read_b64_tr_b16 v[138:139], v169 offset:23040
    v_mul_f32 v84, s60, v72
    v_mul_f32 v85, s60, v73
    v_exp_f32 v84, v84
    s_waitcnt vmcnt(3)
    s_barrier
    v_mfma_f32_32x32x16_bf16 v[44:59], v[112:115], a[100:103], v[44:59]
    ds_read_b64_tr_b16 v[108:109], v10 offset:32768
    ds_read_b64_tr_b16 v[110:111], v10 offset:32896
    v_exp_f32 v85, v85
    v_fma_f32 v86, v84, -0.5, -1.0
    v_fma_f32 v87, v85, -0.5, -1.0
    v_fma_f32 v86, v84, v86, -1.0
    v_mfma_f32_32x32x16_bf16 v[44:59], v[116:119], a[104:107], v[44:59]
    ds_read_b64_tr_b16 v[112:113], v10 offset:33280
    ds_read_b64_tr_b16 v[114:115], v10 offset:33408
    v_fma_f32 v87, v85, v87, -1.0
    v_rcp_f32 v86, v86
    v_rcp_f32 v87, v87
    v_mfma_f32_32x32x16_bf16 v[44:59], v[120:123], a[108:111], v[44:59]
    ds_read_b64_tr_b16 v[116:117], v10 offset:33792
    ds_read_b64_tr_b16 v[118:119], v10 offset:33920
    v_fma_f32 v86, v72, v86, v72
    v_fma_f32 v87, v73, v87, v73
    v_cvt_pk_bf16_f32 v82, v86, v87
    s_waitcnt lgkmcnt(6)
    v_mfma_f32_32x32x16_bf16 v[44:59], v[124:127], a[112:115], v[44:59]
    ds_read_b64_tr_b16 v[120:121], v10 offset:34304
    ds_read_b64_tr_b16 v[122:123], v10 offset:34432
    v_mul_f32 v88, s60, v74
    v_mul_f32 v89, s60, v75
    v_exp_f32 v88, v88
    v_mfma_f32_32x32x16_bf16 v[44:59], v[128:131], a[116:119], v[44:59]
    ds_read_b64_tr_b16 v[124:125], v10 offset:34816
    ds_read_b64_tr_b16 v[126:127], v10 offset:34944
    v_exp_f32 v89, v89
    v_fma_f32 v90, v88, -0.5, -1.0
    v_fma_f32 v91, v89, -0.5, -1.0
    v_fma_f32 v90, v88, v90, -1.0
    v_mfma_f32_32x32x16_bf16 v[44:59], v[132:135], a[120:123], v[44:59]
    ds_read_b64_tr_b16 v[128:129], v10 offset:35328
    ds_read_b64_tr_b16 v[130:131], v10 offset:35456
    v_fma_f32 v91, v89, v91, -1.0
    v_rcp_f32 v90, v90
    v_rcp_f32 v91, v91
    v_mfma_f32_32x32x16_bf16 v[44:59], v[136:139], a[124:127], v[44:59]
    ds_read_b64_tr_b16 v[132:133], v10 offset:35840
    ds_read_b64_tr_b16 v[134:135], v10 offset:35968
    v_fma_f32 v90, v74, v90, v74
    v_fma_f32 v91, v75, v91, v75
    v_cvt_pk_bf16_f32 v83, v90, v91
    s_add_u32 s69, s57, 3072
    buffer_store_dwordx4 v[80:83], v1, s[20:23], s69 offen sc0 sc1
    s_waitcnt lgkmcnt(6)
    v_mfma_f32_32x32x16_bf16 v[60:75], a[0:3], v[108:111], 0
    ds_read_b64_tr_b16 v[136:137], v10 offset:36352
    ds_read_b64_tr_b16 v[138:139], v10 offset:36480
    v_mul_f32 v84, s60, v140
    v_mul_f32 v85, s60, v141
    v_exp_f32 v84, v84
    v_mfma_f32_32x32x16_bf16 v[60:75], a[4:7], v[112:115], v[60:75]
    ds_read_b64_tr_b16 v[108:109], v11 offset:0
    ds_read_b64_tr_b16 v[110:111], v11 offset:128
    v_exp_f32 v85, v85
    v_fma_f32 v86, v84, -0.5, -1.0
    v_fma_f32 v87, v85, -0.5, -1.0
    v_fma_f32 v86, v84, v86, -1.0
    v_mfma_f32_32x32x16_bf16 v[60:75], a[8:11], v[116:119], v[60:75]
    ds_read_b64_tr_b16 v[112:113], v11 offset:512
    ds_read_b64_tr_b16 v[114:115], v11 offset:640
    v_fma_f32 v87, v85, v87, -1.0
    v_rcp_f32 v86, v86
    v_rcp_f32 v87, v87
    v_mfma_f32_32x32x16_bf16 v[60:75], a[12:15], v[120:123], v[60:75]
    ds_read_b64_tr_b16 v[116:117], v11 offset:1024
    ds_read_b64_tr_b16 v[118:119], v11 offset:1152
    v_fma_f32 v86, v140, v86, v140
    v_fma_f32 v87, v141, v87, v141
    v_cvt_pk_bf16_f32 v76, v86, v87
    s_waitcnt lgkmcnt(6)
    v_mfma_f32_32x32x16_bf16 v[60:75], a[16:19], v[124:127], v[60:75]
    ds_read_b64_tr_b16 v[120:121], v11 offset:1536
    ds_read_b64_tr_b16 v[122:123], v11 offset:1664
    v_mul_f32 v88, s60, v142
    v_mul_f32 v89, s60, v143
    v_exp_f32 v88, v88
    v_mfma_f32_32x32x16_bf16 v[60:75], a[20:23], v[128:131], v[60:75]
    ds_read_b64_tr_b16 v[124:125], v11 offset:2048
    ds_read_b64_tr_b16 v[126:127], v11 offset:2176
    v_exp_f32 v89, v89
    v_fma_f32 v90, v88, -0.5, -1.0
    v_fma_f32 v91, v89, -0.5, -1.0
    v_fma_f32 v90, v88, v90, -1.0
    v_mfma_f32_32x32x16_bf16 v[60:75], a[24:27], v[132:135], v[60:75]
    ds_read_b64_tr_b16 v[128:129], v11 offset:2560
    ds_read_b64_tr_b16 v[130:131], v11 offset:2688
    v_fma_f32 v91, v89, v91, -1.0
    v_rcp_f32 v90, v90
    v_rcp_f32 v91, v91
    v_mfma_f32_32x32x16_bf16 v[60:75], a[28:31], v[136:139], v[60:75]
    ds_read_b64_tr_b16 v[132:133], v11 offset:3072
    ds_read_b64_tr_b16 v[134:135], v11 offset:3200
    v_fma_f32 v90, v142, v90, v142
    v_fma_f32 v91, v143, v91, v143
    v_cvt_pk_bf16_f32 v77, v90, v91
    s_waitcnt lgkmcnt(6)
    v_mfma_f32_32x32x16_bf16 v[60:75], a[32:35], v[108:111], v[60:75]
    ds_read_b64_tr_b16 v[136:137], v11 offset:3584
    ds_read_b64_tr_b16 v[138:139], v11 offset:3712
    v_mul_f32 v84, s60, v144
    v_mul_f32 v85, s60, v145
    v_exp_f32 v84, v84
    v_mfma_f32_32x32x16_bf16 v[60:75], a[36:39], v[112:115], v[60:75]
    ds_read_b64_tr_b16 v[108:109], v11 offset:32768
    ds_read_b64_tr_b16 v[110:111], v11 offset:32896
    v_exp_f32 v85, v85
    v_fma_f32 v86, v84, -0.5, -1.0
    v_fma_f32 v87, v85, -0.5, -1.0
    v_fma_f32 v86, v84, v86, -1.0
    v_mfma_f32_32x32x16_bf16 v[60:75], a[40:43], v[116:119], v[60:75]
    ds_read_b64_tr_b16 v[112:113], v11 offset:33280
    ds_read_b64_tr_b16 v[114:115], v11 offset:33408
    v_fma_f32 v87, v85, v87, -1.0
    v_rcp_f32 v86, v86
    v_rcp_f32 v87, v87
    v_mfma_f32_32x32x16_bf16 v[60:75], a[44:47], v[120:123], v[60:75]
    ds_read_b64_tr_b16 v[116:117], v11 offset:33792
    ds_read_b64_tr_b16 v[118:119], v11 offset:33920
    v_fma_f32 v86, v144, v86, v144
    v_fma_f32 v87, v145, v87, v145
    v_cvt_pk_bf16_f32 v78, v86, v87
    s_waitcnt lgkmcnt(6)
    v_mfma_f32_32x32x16_bf16 v[60:75], a[48:51], v[124:127], v[60:75]
    ds_read_b64_tr_b16 v[120:121], v11 offset:34304
    ds_read_b64_tr_b16 v[122:123], v11 offset:34432
    v_mul_f32 v88, s60, v146
    v_mul_f32 v89, s60, v147
    v_exp_f32 v88, v88
    v_mfma_f32_32x32x16_bf16 v[60:75], a[52:55], v[128:131], v[60:75]
    ds_read_b64_tr_b16 v[124:125], v11 offset:34816
    ds_read_b64_tr_b16 v[126:127], v11 offset:34944
    v_exp_f32 v89, v89
    v_fma_f32 v90, v88, -0.5, -1.0
    v_fma_f32 v91, v89, -0.5, -1.0
    v_fma_f32 v90, v88, v90, -1.0
    v_mfma_f32_32x32x16_bf16 v[60:75], a[56:59], v[132:135], v[60:75]
    ds_read_b64_tr_b16 v[128:129], v11 offset:35328
    ds_read_b64_tr_b16 v[130:131], v11 offset:35456
    v_fma_f32 v91, v89, v91, -1.0
    v_rcp_f32 v90, v90
    v_rcp_f32 v91, v91
    v_mfma_f32_32x32x16_bf16 v[60:75], a[60:63], v[136:139], v[60:75]
    ds_read_b64_tr_b16 v[132:133], v11 offset:35840
    ds_read_b64_tr_b16 v[134:135], v11 offset:35968
    v_fma_f32 v90, v146, v90, v146
    v_fma_f32 v91, v147, v91, v147
    v_cvt_pk_bf16_f32 v79, v90, v91
    s_add_u32 s69, s75, 0
    buffer_store_dwordx4 v[76:79], v1, s[20:23], s69 offen sc0 sc1
    s_waitcnt lgkmcnt(6)
    v_mfma_f32_32x32x16_bf16 v[60:75], a[64:67], v[108:111], v[60:75]
    ds_read_b64_tr_b16 v[136:137], v11 offset:36352
    ds_read_b64_tr_b16 v[138:139], v11 offset:36480
    v_mul_f32 v84, s60, v148
    v_mul_f32 v85, s60, v149
    v_exp_f32 v84, v84
    v_mfma_f32_32x32x16_bf16 v[60:75], a[68:71], v[112:115], v[60:75]
    ds_read_b64_tr_b16 v[108:109], v12 offset:0
    ds_read_b64_tr_b16 v[110:111], v12 offset:128
    v_exp_f32 v85, v85
    v_fma_f32 v86, v84, -0.5, -1.0
    v_fma_f32 v87, v85, -0.5, -1.0
    v_fma_f32 v86, v84, v86, -1.0
    v_mfma_f32_32x32x16_bf16 v[60:75], a[72:75], v[116:119], v[60:75]
    ds_read_b64_tr_b16 v[112:113], v12 offset:512
    ds_read_b64_tr_b16 v[114:115], v12 offset:640
    v_fma_f32 v87, v85, v87, -1.0
    v_rcp_f32 v86, v86
    v_rcp_f32 v87, v87
    v_mfma_f32_32x32x16_bf16 v[60:75], a[76:79], v[120:123], v[60:75]
    ds_read_b64_tr_b16 v[116:117], v12 offset:1024
    ds_read_b64_tr_b16 v[118:119], v12 offset:1152
    v_fma_f32 v86, v148, v86, v148
    v_fma_f32 v87, v149, v87, v149
    v_cvt_pk_bf16_f32 v80, v86, v87
    s_waitcnt lgkmcnt(6)
    v_mfma_f32_32x32x16_bf16 v[60:75], a[80:83], v[124:127], v[60:75]
    ds_read_b64_tr_b16 v[120:121], v12 offset:1536
    ds_read_b64_tr_b16 v[122:123], v12 offset:1664
    v_mul_f32 v88, s60, v150
    v_mul_f32 v89, s60, v151
    v_exp_f32 v88, v88
    v_mfma_f32_32x32x16_bf16 v[60:75], a[84:87], v[128:131], v[60:75]
    ds_read_b64_tr_b16 v[124:125], v12 offset:2048
    ds_read_b64_tr_b16 v[126:127], v12 offset:2176
    v_exp_f32 v89, v89
    v_fma_f32 v90, v88, -0.5, -1.0
    v_fma_f32 v91, v89, -0.5, -1.0
    v_fma_f32 v90, v88, v90, -1.0
    v_mfma_f32_32x32x16_bf16 v[60:75], a[88:91], v[132:135], v[60:75]
    ds_read_b64_tr_b16 v[128:129], v12 offset:2560
    ds_read_b64_tr_b16 v[130:131], v12 offset:2688
    v_fma_f32 v91, v89, v91, -1.0
    v_rcp_f32 v90, v90
    v_rcp_f32 v91, v91
    v_mfma_f32_32x32x16_bf16 v[60:75], a[92:95], v[136:139], v[60:75]
    ds_read_b64_tr_b16 v[132:133], v12 offset:3072
    ds_read_b64_tr_b16 v[134:135], v12 offset:3200
    v_fma_f32 v90, v150, v90, v150
    v_fma_f32 v91, v151, v91, v151
    v_cvt_pk_bf16_f32 v81, v90, v91
    s_waitcnt lgkmcnt(6)
    v_mfma_f32_32x32x16_bf16 v[60:75], a[96:99], v[108:111], v[60:75]
    ds_read_b64_tr_b16 v[136:137], v12 offset:3584
    ds_read_b64_tr_b16 v[138:139], v12 offset:3712
    v_mul_f32 v84, s60, v152
    v_mul_f32 v85, s60, v153
    v_exp_f32 v84, v84
    v_mfma_f32_32x32x16_bf16 v[60:75], a[100:103], v[112:115], v[60:75]
    v_exp_f32 v85, v85
    v_fma_f32 v86, v84, -0.5, -1.0
    v_fma_f32 v87, v85, -0.5, -1.0
    v_fma_f32 v86, v84, v86, -1.0
    v_mfma_f32_32x32x16_bf16 v[60:75], a[104:107], v[116:119], v[60:75]
    v_fma_f32 v87, v85, v87, -1.0
    v_rcp_f32 v86, v86
    v_rcp_f32 v87, v87
    v_mfma_f32_32x32x16_bf16 v[60:75], a[108:111], v[120:123], v[60:75]
    v_fma_f32 v86, v152, v86, v152
    v_fma_f32 v87, v153, v87, v153
    v_cvt_pk_bf16_f32 v82, v86, v87
    s_waitcnt lgkmcnt(0)
    v_mfma_f32_32x32x16_bf16 v[60:75], a[112:115], v[124:127], v[60:75]
    v_mul_f32 v88, s60, v154
    v_mul_f32 v89, s60, v155
    v_exp_f32 v88, v88
    v_mfma_f32_32x32x16_bf16 v[60:75], a[116:119], v[128:131], v[60:75]
    v_exp_f32 v89, v89
    v_fma_f32 v90, v88, -0.5, -1.0
    v_fma_f32 v91, v89, -0.5, -1.0
    v_fma_f32 v90, v88, v90, -1.0
    v_mfma_f32_32x32x16_bf16 v[60:75], a[120:123], v[132:135], v[60:75]
    v_fma_f32 v91, v89, v91, -1.0
    v_rcp_f32 v90, v90
    v_rcp_f32 v91, v91
    v_mfma_f32_32x32x16_bf16 v[60:75], a[124:127], v[136:139], v[60:75]
    v_fma_f32 v90, v154, v90, v154
    v_fma_f32 v91, v155, v91, v155
    v_cvt_pk_bf16_f32 v83, v90, v91
    s_add_u32 s69, s75, 1024
    buffer_store_dwordx4 v[80:83], v1, s[20:23], s69 offen sc0 sc1
    v_mul_f32 v84, s60, v44
    v_mul_f32 v85, s60, v45
    v_exp_f32 v84, v84
    v_exp_f32 v85, v85
    v_fma_f32 v86, v84, -0.5, -1.0
    v_fma_f32 v87, v85, -0.5, -1.0
    v_fma_f32 v86, v84, v86, -1.0
    v_fma_f32 v87, v85, v87, -1.0
    v_rcp_f32 v86, v86
    v_rcp_f32 v87, v87
    v_fma_f32 v86, v44, v86, v44
    v_fma_f32 v87, v45, v87, v45
    v_cvt_pk_bf16_f32 v76, v86, v87
    v_mul_f32 v88, s60, v46
    v_mul_f32 v89, s60, v47
    v_exp_f32 v88, v88
    v_exp_f32 v89, v89
    v_fma_f32 v90, v88, -0.5, -1.0
    v_fma_f32 v91, v89, -0.5, -1.0
    v_fma_f32 v90, v88, v90, -1.0
    v_fma_f32 v91, v89, v91, -1.0
    v_rcp_f32 v90, v90
    v_rcp_f32 v91, v91
    v_fma_f32 v90, v46, v90, v46
    v_fma_f32 v91, v47, v91, v47
    v_cvt_pk_bf16_f32 v77, v90, v91
    v_mul_f32 v84, s60, v48
    v_mul_f32 v85, s60, v49
    v_exp_f32 v84, v84
    v_exp_f32 v85, v85
    v_fma_f32 v86, v84, -0.5, -1.0
    v_fma_f32 v87, v85, -0.5, -1.0
    v_fma_f32 v86, v84, v86, -1.0
    v_fma_f32 v87, v85, v87, -1.0
    v_rcp_f32 v86, v86
    v_rcp_f32 v87, v87
    v_fma_f32 v86, v48, v86, v48
    v_fma_f32 v87, v49, v87, v49
    v_cvt_pk_bf16_f32 v78, v86, v87
    v_mul_f32 v88, s60, v50
    v_mul_f32 v89, s60, v51
    v_exp_f32 v88, v88
    v_exp_f32 v89, v89
    v_fma_f32 v90, v88, -0.5, -1.0
    v_fma_f32 v91, v89, -0.5, -1.0
    v_fma_f32 v90, v88, v90, -1.0
    v_fma_f32 v91, v89, v91, -1.0
    v_rcp_f32 v90, v90
    v_rcp_f32 v91, v91
    v_fma_f32 v90, v50, v90, v50
    v_fma_f32 v91, v51, v91, v51
    v_cvt_pk_bf16_f32 v79, v90, v91
    s_add_u32 s69, s75, 2048
    buffer_store_dwordx4 v[76:79], v1, s[20:23], s69 offen sc0 sc1
    v_mul_f32 v84, s60, v52
    v_mul_f32 v85, s60, v53
    v_exp_f32 v84, v84
    v_exp_f32 v85, v85
    v_fma_f32 v86, v84, -0.5, -1.0
    v_fma_f32 v87, v85, -0.5, -1.0
    v_fma_f32 v86, v84, v86, -1.0
    v_fma_f32 v87, v85, v87, -1.0
    v_rcp_f32 v86, v86
    v_rcp_f32 v87, v87
    v_fma_f32 v86, v52, v86, v52
    v_fma_f32 v87, v53, v87, v53
    v_cvt_pk_bf16_f32 v80, v86, v87
    v_mul_f32 v88, s60, v54
    v_mul_f32 v89, s60, v55
    v_exp_f32 v88, v88
    v_exp_f32 v89, v89
    v_fma_f32 v90, v88, -0.5, -1.0
    v_fma_f32 v91, v89, -0.5, -1.0
    v_fma_f32 v90, v88, v90, -1.0
    v_fma_f32 v91, v89, v91, -1.0
    v_rcp_f32 v90, v90
    v_rcp_f32 v91, v91
    v_fma_f32 v90, v54, v90, v54
    v_fma_f32 v91, v55, v91, v55
    v_cvt_pk_bf16_f32 v81, v90, v91
    v_mul_f32 v84, s60, v56
    v_mul_f32 v85, s60, v57
    v_exp_f32 v84, v84
    v_exp_f32 v85, v85
    v_fma_f32 v86, v84, -0.5, -1.0
    v_fma_f32 v87, v85, -0.5, -1.0
    v_fma_f32 v86, v84, v86, -1.0
    v_fma_f32 v87, v85, v87, -1.0
    v_rcp_f32 v86, v86
    v_rcp_f32 v87, v87
    v_fma_f32 v86, v56, v86, v56
    v_fma_f32 v87, v57, v87, v57
    v_cvt_pk_bf16_f32 v82, v86, v87
    v_mul_f32 v88, s60, v58
    v_mul_f32 v89, s60, v59
    v_exp_f32 v88, v88
    v_exp_f32 v89, v89
    v_fma_f32 v90, v88, -0.5, -1.0
    v_fma_f32 v91, v89, -0.5, -1.0
    v_fma_f32 v90, v88, v90, -1.0
    v_fma_f32 v91, v89, v91, -1.0
    v_rcp_f32 v90, v90
    v_rcp_f32 v91, v91
    v_fma_f32 v90, v58, v90, v58
    v_fma_f32 v91, v59, v91, v59
    v_cvt_pk_bf16_f32 v83, v90, v91
    s_add_u32 s69, s75, 3072
    buffer_store_dwordx4 v[80:83], v1, s[20:23], s69 offen sc0 sc1
    v_cvt_pk_bf16_f32 v76, v60, v61
    v_cvt_pk_bf16_f32 v77, v62, v63
    v_cvt_pk_bf16_f32 v78, v64, v65
    v_cvt_pk_bf16_f32 v79, v66, v67
    v_cvt_pk_bf16_f32 v80, v68, v69
    v_cvt_pk_bf16_f32 v81, v70, v71
    v_cvt_pk_bf16_f32 v82, v72, v73
    v_cvt_pk_bf16_f32 v83, v74, v75
    v_and_b32 v104, 15, v0
    v_lshlrev_b32 v104, 4, v104
    v_lshrrev_b32 v15, 5, v0
    v_lshl_or_b32 v104, v15, 8, v104
    v_bfe_u32 v15, v0, 4, 1
    v_lshl_or_b32 v104, v15, 30, v104
    s_lshl_b32 s69, s45, 10
    s_add_u32 s69, s69, 2162688
    buffer_store_dwordx4 v[76:79], v104, s[20:23], s69 offen sc0 sc1
    buffer_store_dwordx4 v[80:83], v104, s[20:23], s69 offen offset:512 sc0 sc1
    s_endpgm
K1_BG:
    s_sub_u32 s48, s47, 8
    s_lshl_b32 s55, s48, 8
    s_add_u32 s73, s55, 128
    s_mov_b32 m0, s46
    s_nop 0
    buffer_load_dwordx4 v2, s[8:11], s50 offen lds
    s_add_u32 m0, s46, 1024
    s_nop 0
    buffer_load_dwordx4 v3, s[8:11], s51 offen lds
    s_add_u32 m0, s46, 2048
    s_nop 0
    buffer_load_dwordx4 v2, s[8:11], s52 offen lds
    s_add_u32 m0, s46, 3072
    s_nop 0
    buffer_load_dwordx4 v3, s[8:11], s53 offen lds
    s_add_u32 m0, s46, 3968
    s_nop 0
    buffer_load_dwordx4 v2, s[8:11], s50 offen offset:128 lds
    s_add_u32 m0, s46, 4992
    s_nop 0
    buffer_load_dwordx4 v3, s[8:11], s51 offen offset:128 lds
    s_add_u32 m0, s46, 6016
    s_nop 0
    buffer_load_dwordx4 v2, s[8:11], s52 offen offset:128 lds
    s_add_u32 m0, s46, 7040
    s_nop 0
    buffer_load_dwordx4 v3, s[8:11], s53 offen offset:128 lds
    s_add_u32 s54, s55, s59
    s_mov_b32 m0, s82
    s_nop 0
    buffer_load_dwordx4 v170, s[12:15], s54 offen lds
    s_add_u32 s54, s54, 28672
    s_add_u32 m0, s82, 1024
    s_nop 0
    buffer_load_dwordx4 v170, s[12:15], s54 offen lds
    s_add_u32 s54, s54, 28672
    s_add_u32 m0, s82, 2048
    s_nop 0
    buffer_load_dwordx4 v170, s[12:15], s54 offen lds
    s_add_u32 s54, s54, 28672
    s_add_u32 m0, s82, 3072
    s_nop 0
    buffer_load_dwordx4 v170, s[12:15], s54 offen lds
    buffer_load_ushort v16, v13, s[24:27], s55 offen
    buffer_load_ushort v17, v13, s[24:27], s55 offen offset:64
    buffer_load_ushort v18, v13, s[24:27], s73 offen
    buffer_load_ushort v19, v13, s[24:27], s73 offen offset:64
    s_add_u32 m0, s46, 7936
    s_nop 0
    buffer_load_dwordx4 v2, s[8:11], s50 offen offset:256 lds
    s_add_u32 m0, s46, 8960
    s_nop 0
    buffer_load_dwordx4 v3, s[8:11], s51 offen offset:256 lds
    s_add_u32 m0, s46, 9984
    s_nop 0
    buffer_load_dwordx4 v2, s[8:11], s52 offen offset:256 lds
    s_add_u32 m0, s46, 11008
    s_nop 0
    buffer_load_dwordx4 v3, s[8:11], s53 offen offset:256 lds
    s_add_u32 m0, s46, 11904
    s_nop 0
    buffer_load_dwordx4 v2, s[8:11], s50 offen offset:384 lds
    s_add_u32 m0, s46, 12928
    s_nop 0
    buffer_load_dwordx4 v3, s[8:11], s51 offen offset:384 lds
    s_add_u32 m0, s46, 13952
    s_nop 0
    buffer_load_dwordx4 v2, s[8:11], s52 offen offset:384 lds
    s_add_u32 m0, s46, 14976
    s_nop 0
    buffer_load_dwordx4 v3, s[8:11], s53 offen offset:384 lds
    s_add_u32 s54, s55, s59
    s_add_u32 s54, s54, 458752
    s_add_u32 m0, s82, 16384
    s_nop 0
    buffer_load_dwordx4 v170, s[12:15], s54 offen lds
    s_add_u32 s54, s54, 28672
    s_add_u32 m0, s82, 17408
    s_nop 0
    buffer_load_dwordx4 v170, s[12:15], s54 offen lds
    s_add_u32 s54, s54, 28672
    s_add_u32 m0, s82, 18432
    s_nop 0
    buffer_load_dwordx4 v170, s[12:15], s54 offen lds
    s_add_u32 s54, s54, 28672
    s_add_u32 m0, s82, 19456
    s_nop 0
    buffer_load_dwordx4 v170, s[12:15], s54 offen lds
    s_mul_i32 s57, s45, 114688
    s_add_u32 s57, s57, 4718592
    s_lshl_b32 s48, s73, 5
    s_add_u32 s75, s57, s48
    s_lshl_b32 s48, s55, 5
    s_add_u32 s57, s57, s48
    s_mov_b32 s28, s80
    s_mov_b32 s29, s81
    s_mov_b32 s30, 1024
    s_mov_b32 s31, 0x00020000
    v_lshrrev_b32 v15, 5, v0
    v_lshlrev_b32 v15, 4, v15
    v_add_u32 v10, s46, v15
    s_waitcnt vmcnt(12)
    s_barrier
    ds_read_b128 a[0:3], v6 offset:0
    ds_read_b128 a[4:7], v7 offset:0
    ds_read_b128 a[8:11], v8 offset:0
    ds_read_b128 a[12:15], v9 offset:0
    ds_read_b128 a[16:19], v6 offset:4096
    ds_read_b128 a[20:23], v7 offset:4096
    ds_read_b128 a[24:27], v8 offset:4096
    ds_read_b128 a[28:31], v9 offset:4096
    ds_read_b64_tr_b16 v[108:109], v164 offset:0
    ds_read_b64_tr_b16 v[110:111], v164 offset:512
    ds_read_b64_tr_b16 v[112:113], v167 offset:0
    ds_read_b64_tr_b16 v[114:115], v167 offset:512
    ds_read_b64_tr_b16 v[116:117], v164 offset:2048
    ds_read_b64_tr_b16 v[118:119], v164 offset:2560
    ds_read_b64_tr_b16 v[120:121], v167 offset:2048
    ds_read_b64_tr_b16 v[122:123], v167 offset:2560
    ds_read_b64_tr_b16 v[124:125], v164 offset:4096
    ds_read_b64_tr_b16 v[126:127], v164 offset:4608
    ds_read_b64_tr_b16 v[128:129], v167 offset:4096
    ds_read_b64_tr_b16 v[130:131], v167 offset:4608
    ds_read_b64_tr_b16 v[132:133], v164 offset:6144
    ds_read_b64_tr_b16 v[134:135], v164 offset:6656
    v_mov_b32 v20, v16
    s_nop 1
    v_mfma_f32_32x32x16_bf16 v[44:59], v[20:23], v[24:27], 0
    s_waitcnt lgkmcnt(6)
    v_mfma_f32_32x32x16_bf16 v[44:59], v[108:111], a[0:3], v[44:59]
    ds_read_b64_tr_b16 v[136:137], v167 offset:6144
    ds_read_b64_tr_b16 v[138:139], v167 offset:6656
    s_add_u32 m0, s46, 15872
    s_nop 0
    buffer_load_dwordx4 v2, s[8:11], s50 offen offset:512 lds
    s_add_u32 m0, s46, 16896
    s_nop 0
    buffer_load_dwordx4 v3, s[8:11], s51 offen offset:512 lds
    v_mov_b32 v20, v17
    s_nop 1
    v_mfma_f32_32x32x16_bf16 v[60:75], v[20:23], v[24:27], 0
    v_mfma_f32_32x32x16_bf16 v[60:75], v[112:115], a[0:3], v[60:75]
    ds_read_b64_tr_b16 v[108:109], v164 offset:8192
    ds_read_b64_tr_b16 v[110:111], v164 offset:8704
    s_add_u32 m0, s46, 17920
    s_nop 0
    buffer_load_dwordx4 v2, s[8:11], s52 offen offset:512 lds
    s_add_u32 m0, s46, 18944
    s_nop 0
    buffer_load_dwordx4 v3, s[8:11], s53 offen offset:512 lds
    v_mfma_f32_32x32x16_bf16 v[44:59], v[116:119], a[4:7], v[44:59]
    ds_read_b64_tr_b16 v[112:113], v167 offset:8192
    ds_read_b64_tr_b16 v[114:115], v167 offset:8704
    s_add_u32 m0, s46, 19840
    s_nop 0
    buffer_load_dwordx4 v2, s[8:11], s50 offen offset:640 lds
    s_add_u32 m0, s46, 20864
    s_nop 0
    buffer_load_dwordx4 v3, s[8:11], s51 offen offset:640 lds
    s_add_u32 s64, s70, 0
    s_lshr_b32 s48, s64, 4
    s_cmp_ge_u32 s48, 112
    s_cselect_b32 s40, s36, s32
    s_cselect_b32 s41, s37, s33
    s_cselect_b32 s42, s38, s34
    s_mov_b32 s43, 0x00020000
    s_cselect_b32 s49, 112, 0
    s_sub_u32 s48, s48, s49
    s_lshl_b32 s48, s48, 14
    s_and_b32 s49, s64, 15
    s_lshl_b32 s49, s49, 6
    s_add_u32 s65, s48, s49
    s_add_u32 s66, s65, 8192
    s_lshl_b32 s67, s64, 10
    s_add_u32 s67, s67, 2359296
    v_mfma_f32_32x32x16_bf16 v[60:75], v[120:123], a[4:7], v[60:75]
    ds_read_b64_tr_b16 v[116:117], v164 offset:10240
    ds_read_b64_tr_b16 v[118:119], v164 offset:10752
    s_add_u32 m0, s46, 21888
    s_nop 0
    buffer_load_dwordx4 v2, s[8:11], s52 offen offset:640 lds
    s_add_u32 m0, s46, 22912
    s_nop 0
    buffer_load_dwordx4 v3, s[8:11], s53 offen offset:640 lds
    buffer_load_ushort v92, v14, s[40:43], s65 offen
    s_waitcnt lgkmcnt(6)
    v_mfma_f32_32x32x16_bf16 v[44:59], v[124:127], a[8:11], v[44:59]
    ds_read_b64_tr_b16 v[120:121], v167 offset:10240
    ds_read_b64_tr_b16 v[122:123], v167 offset:10752
    s_add_u32 s54, s55, s59
    s_add_u32 s54, s54, 917504
    s_add_u32 m0, s46, 24576
    s_nop 0
    buffer_load_dwordx4 v170, s[12:15], s54 offen lds
    s_add_u32 s54, s54, 28672
    s_add_u32 m0, s46, 25600
    s_nop 0
    buffer_load_dwordx4 v170, s[12:15], s54 offen lds
    buffer_load_ushort v93, v14, s[40:43], s65 offen offset:1024
    v_mfma_f32_32x32x16_bf16 v[60:75], v[128:131], a[8:11], v[60:75]
    ds_read_b64_tr_b16 v[124:125], v164 offset:12288
    ds_read_b64_tr_b16 v[126:127], v164 offset:12800
    s_add_u32 s54, s54, 28672
    s_add_u32 m0, s46, 26624
    s_nop 0
    buffer_load_dwordx4 v170, s[12:15], s54 offen lds
    s_add_u32 s54, s54, 28672
    s_add_u32 m0, s46, 27648
    s_nop 0
    buffer_load_dwordx4 v170, s[12:15], s54 offen lds
    buffer_load_ushort v94, v14, s[40:43], s65 offen offset:2048
    v_mfma_f32_32x32x16_bf16 v[44:59], v[132:135], a[12:15], v[44:59]
    ds_read_b64_tr_b16 v[128:129], v167 offset:12288
    ds_read_b64_tr_b16 v[130:131], v167 offset:12800
    s_sub_u32 m0, s46, 768
    s_nop 0
    buffer_load_dwordx4 v2, s[8:11], s50 offen offset:768 lds
    s_add_u32 m0, s46, 256
    s_nop 0
    buffer_load_dwordx4 v3, s[8:11], s51 offen offset:768 lds
    buffer_load_ushort v95, v14, s[40:43], s65 offen offset:3072
    v_mfma_f32_32x32x16_bf16 v[60:75], v[136:139], a[12:15], v[60:75]
    ds_read_b64_tr_b16 v[132:133], v164 offset:14336
    ds_read_b64_tr_b16 v[134:135], v164 offset:14848
    s_add_u32 m0, s46, 1280
    s_nop 0
    buffer_load_dwordx4 v2, s[8:11], s52 offen offset:768 lds
    s_add_u32 m0, s46, 2304
    s_nop 0
    buffer_load_dwordx4 v3, s[8:11], s53 offen offset:768 lds
    buffer_load_ushort v96, v14, s[40:43], s66 offen
    s_waitcnt lgkmcnt(6)
    v_mfma_f32_32x32x16_bf16 v[44:59], v[108:111], a[16:19], v[44:59]
    ds_read_b64_tr_b16 v[136:137], v167 offset:14336
    ds_read_b64_tr_b16 v[138:139], v167 offset:14848
    s_add_u32 m0, s46, 3200
    s_nop 0
    buffer_load_dwordx4 v2, s[8:11], s50 offen offset:896 lds
    s_add_u32 m0, s46, 4224
    s_nop 0
    buffer_load_dwordx4 v3, s[8:11], s51 offen offset:896 lds
    buffer_load_ushort v97, v14, s[40:43], s66 offen offset:1024
    s_waitcnt vmcnt(24)
    s_barrier
    ds_read_b128 a[32:35], v6 offset:8192
    ds_read_b128 a[36:39], v7 offset:8192
    ds_read_b128 a[40:43], v8 offset:8192
    ds_read_b128 a[44:47], v9 offset:8192
    ds_read_b128 a[48:51], v6 offset:12288
    ds_read_b128 a[52:55], v7 offset:12288
    ds_read_b128 a[56:59], v8 offset:12288
    ds_read_b128 a[60:63], v9 offset:12288
    v_mfma_f32_32x32x16_bf16 v[60:75], v[112:115], a[16:19], v[60:75]
    ds_read_b64_tr_b16 v[108:109], v164 offset:16384
    ds_read_b64_tr_b16 v[110:111], v164 offset:16896
    s_add_u32 m0, s46, 5248
    s_nop 0
    buffer_load_dwordx4 v2, s[8:11], s52 offen offset:896 lds
    s_add_u32 m0, s46, 6272
    s_nop 0
    buffer_load_dwordx4 v3, s[8:11], s53 offen offset:896 lds
    buffer_load_ushort v98, v14, s[40:43], s66 offen offset:2048
    v_mfma_f32_32x32x16_bf16 v[44:59], v[116:119], a[20:23], v[44:59]
    ds_read_b64_tr_b16 v[112:113], v167 offset:16384
    ds_read_b64_tr_b16 v[114:115], v167 offset:16896
    s_add_u32 s54, s55, s59
    s_add_u32 s54, s54, 1376256
    s_add_u32 m0, s46, 28672
    s_nop 0
    buffer_load_dwordx4 v170, s[12:15], s54 offen lds
    s_add_u32 s54, s54, 28672
    s_add_u32 m0, s46, 29696
    s_nop 0
    buffer_load_dwordx4 v170, s[12:15], s54 offen lds
    buffer_load_ushort v99, v14, s[40:43], s66 offen offset:3072
    v_mfma_f32_32x32x16_bf16 v[60:75], v[120:123], a[20:23], v[60:75]
    ds_read_b64_tr_b16 v[116:117], v164 offset:18432
    ds_read_b64_tr_b16 v[118:119], v164 offset:18944
    s_add_u32 s54, s54, 28672
    s_add_u32 m0, s46, 30720
    s_nop 0
    buffer_load_dwordx4 v170, s[12:15], s54 offen lds
    s_add_u32 s54, s54, 28672
    s_add_u32 m0, s46, 31744
    s_nop 0
    buffer_load_dwordx4 v170, s[12:15], s54 offen lds
    s_waitcnt lgkmcnt(14)
    v_mfma_f32_32x32x16_bf16 v[44:59], v[124:127], a[24:27], v[44:59]
    ds_read_b64_tr_b16 v[120:121], v167 offset:18432
    ds_read_b64_tr_b16 v[122:123], v167 offset:18944
    v_mfma_f32_32x32x16_bf16 v[60:75], v[128:131], a[24:27], v[60:75]
    ds_read_b64_tr_b16 v[124:125], v164 offset:20480
    ds_read_b64_tr_b16 v[126:127], v164 offset:20992
    v_mfma_f32_32x32x16_bf16 v[44:59], v[132:135], a[28:31], v[44:59]
    ds_read_b64_tr_b16 v[128:129], v167 offset:20480
    ds_read_b64_tr_b16 v[130:131], v167 offset:20992
    v_mfma_f32_32x32x16_bf16 v[60:75], v[136:139], a[28:31], v[60:75]
    ds_read_b64_tr_b16 v[132:133], v164 offset:22528
    ds_read_b64_tr_b16 v[134:135], v164 offset:23040
    s_waitcnt lgkmcnt(6)
    v_mfma_f32_32x32x16_bf16 v[44:59], v[108:111], a[32:35], v[44:59]
    ds_read_b64_tr_b16 v[136:137], v167 offset:22528
    ds_read_b64_tr_b16 v[138:139], v167 offset:23040
    s_add_u32 s54, s73, s71
    s_add_u32 m0, s46, 8192
    s_nop 0
    buffer_load_dwordx4 v170, s[12:15], s54 offen lds
    s_add_u32 s54, s54, 28672
    s_add_u32 m0, s46, 9216
    s_nop 0
    buffer_load_dwordx4 v170, s[12:15], s54 offen lds
    v_mfma_f32_32x32x16_bf16 v[60:75], v[112:115], a[32:35], v[60:75]
    ds_read_b64_tr_b16 v[108:109], v164 offset:24576
    ds_read_b64_tr_b16 v[110:111], v164 offset:25088
    s_add_u32 s54, s54, 28672
    s_add_u32 m0, s46, 10240
    s_nop 0
    buffer_load_dwordx4 v170, s[12:15], s54 offen lds
    s_add_u32 s54, s54, 28672
    s_add_u32 m0, s46, 11264
    s_nop 0
    buffer_load_dwordx4 v170, s[12:15], s54 offen lds
    v_mfma_f32_32x32x16_bf16 v[44:59], v[116:119], a[36:39], v[44:59]
    ds_read_b64_tr_b16 v[112:113], v167 offset:24576
    ds_read_b64_tr_b16 v[114:115], v167 offset:25088
    s_add_u32 s54, s54, 28672
    s_add_u32 m0, s46, 12288
    s_nop 0
    buffer_load_dwordx4 v170, s[12:15], s54 offen lds
    s_add_u32 s54, s54, 28672
    s_add_u32 m0, s46, 13312
    s_nop 0
    buffer_load_dwordx4 v170, s[12:15], s54 offen lds
    v_mfma_f32_32x32x16_bf16 v[60:75], v[120:123], a[36:39], v[60:75]
    ds_read_b64_tr_b16 v[116:117], v164 offset:26624
    ds_read_b64_tr_b16 v[118:119], v164 offset:27136
    s_add_u32 s54, s54, 28672
    s_add_u32 m0, s46, 14336
    s_nop 0
    buffer_load_dwordx4 v170, s[12:15], s54 offen lds
    s_add_u32 s54, s54, 28672
    s_add_u32 m0, s46, 15360
    s_nop 0
    buffer_load_dwordx4 v170, s[12:15], s54 offen lds
    s_waitcnt lgkmcnt(6)
    v_mfma_f32_32x32x16_bf16 v[44:59], v[124:127], a[40:43], v[44:59]
    ds_read_b64_tr_b16 v[120:121], v167 offset:26624
    ds_read_b64_tr_b16 v[122:123], v167 offset:27136
    v_mfma_f32_32x32x16_bf16 v[60:75], v[128:131], a[40:43], v[60:75]
    ds_read_b64_tr_b16 v[124:125], v164 offset:28672
    ds_read_b64_tr_b16 v[126:127], v164 offset:29184
    v_mfma_f32_32x32x16_bf16 v[44:59], v[132:135], a[44:47], v[44:59]
    ds_read_b64_tr_b16 v[128:129], v167 offset:28672
    ds_read_b64_tr_b16 v[130:131], v167 offset:29184
    s_waitcnt vmcnt(10)
    v_lshl_or_b32 v100, v93, 16, v92
    v_lshl_or_b32 v101, v95, 16, v94
    v_lshl_or_b32 v102, v97, 16, v96
    v_lshl_or_b32 v103, v99, 16, v98
    buffer_store_dwordx4 v[100:103], v1, s[20:23], s67 offen sc0 sc1
    s_add_u32 s64, s70, 1024
    s_lshr_b32 s48, s64, 4
    s_cmp_ge_u32 s48, 112
    s_cselect_b32 s40, s36, s32
    s_cselect_b32 s41, s37, s33
    s_cselect_b32 s42, s38, s34
    s_mov_b32 s43, 0x00020000
    s_cselect_b32 s49, 112, 0
    s_sub_u32 s48, s48, s49
    s_lshl_b32 s48, s48, 14
    s_and_b32 s49, s64, 15
    s_lshl_b32 s49, s49, 6
    s_add_u32 s65, s48, s49
    s_add_u32 s66, s65, 8192
    s_lshl_b32 s67, s64, 10
    s_add_u32 s67, s67, 2359296
    v_mfma_f32_32x32x16_bf16 v[60:75], v[136:139], a[44:47], v[60:75]
    ds_read_b64_tr_b16 v[132:133], v164 offset:30720
    ds_read_b64_tr_b16 v[134:135], v164 offset:31232
    buffer_load_ushort v92, v14, s[40:43], s65 offen
    s_waitcnt lgkmcnt(6)
    v_mfma_f32_32x32x16_bf16 v[44:59], v[108:111], a[48:51], v[44:59]
    ds_read_b64_tr_b16 v[136:137], v167 offset:30720
    ds_read_b64_tr_b16 v[138:139], v167 offset:31232
    buffer_load_ushort v93, v14, s[40:43], s65 offen offset:1024
    s_barrier
    ds_read_b128 a[64:67], v6 offset:16384
    ds_read_b128 a[68:71], v7 offset:16384
    ds_read_b128 a[72:75], v8 offset:16384
    ds_read_b128 a[76:79], v9 offset:16384
    ds_read_b128 a[80:83], v6 offset:20480
    ds_read_b128 a[84:87], v7 offset:20480
    ds_read_b128 a[88:91], v8 offset:20480
    ds_read_b128 a[92:95], v9 offset:20480
    v_mfma_f32_32x32x16_bf16 v[60:75], v[112:115], a[48:51], v[60:75]
    ds_read_b64_tr_b16 v[108:109], v164 offset:57344
    ds_read_b64_tr_b16 v[110:111], v164 offset:57856
    buffer_load_ushort v94, v14, s[40:43], s65 offen offset:2048
    v_mfma_f32_32x32x16_bf16 v[44:59], v[116:119], a[52:55], v[44:59]
    ds_read_b64_tr_b16 v[112:113], v167 offset:57344
    ds_read_b64_tr_b16 v[114:115], v167 offset:57856
    buffer_load_ushort v95, v14, s[40:43], s65 offen offset:3072
    v_mfma_f32_32x32x16_bf16 v[60:75], v[120:123], a[52:55], v[60:75]
    ds_read_b64_tr_b16 v[116:117], v164 offset:59392
    ds_read_b64_tr_b16 v[118:119], v164 offset:59904
    buffer_load_ushort v96, v14, s[40:43], s66 offen
    s_waitcnt lgkmcnt(14)
    v_mfma_f32_32x32x16_bf16 v[44:59], v[124:127], a[56:59], v[44:59]
    ds_read_b64_tr_b16 v[120:121], v167 offset:59392
    ds_read_b64_tr_b16 v[122:123], v167 offset:59904
    buffer_load_ushort v97, v14, s[40:43], s66 offen offset:1024
    v_mfma_f32_32x32x16_bf16 v[60:75], v[128:131], a[56:59], v[60:75]
    ds_read_b64_tr_b16 v[124:125], v165 offset:24576
    ds_read_b64_tr_b16 v[126:127], v165 offset:25088
    buffer_load_ushort v98, v14, s[40:43], s66 offen offset:2048
    v_mfma_f32_32x32x16_bf16 v[44:59], v[132:135], a[60:63], v[44:59]
    ds_read_b64_tr_b16 v[128:129], v168 offset:24576
    ds_read_b64_tr_b16 v[130:131], v168 offset:25088
    buffer_load_ushort v99, v14, s[40:43], s66 offen offset:3072
    v_mfma_f32_32x32x16_bf16 v[60:75], v[136:139], a[60:63], v[60:75]
    ds_read_b64_tr_b16 v[132:133], v165 offset:26624
    ds_read_b64_tr_b16 v[134:135], v165 offset:27136
    s_waitcnt lgkmcnt(6)
    v_mfma_f32_32x32x16_bf16 v[44:59], v[108:111], a[64:67], v[44:59]
    ds_read_b64_tr_b16 v[136:137], v168 offset:26624
    ds_read_b64_tr_b16 v[138:139], v168 offset:27136
    s_add_u32 s54, s54, 28672
    s_add_u32 m0, s46, 16384
    s_nop 0
    buffer_load_dwordx4 v170, s[12:15], s54 offen lds
    s_add_u32 s54, s54, 28672
    s_add_u32 m0, s46, 17408
    s_nop 0
    buffer_load_dwordx4 v170, s[12:15], s54 offen lds
    v_mfma_f32_32x32x16_bf16 v[60:75], v[112:115], a[64:67], v[60:75]
    ds_read_b64_tr_b16 v[108:109], v165 offset:57344
    ds_read_b64_tr_b16 v[110:111], v165 offset:57856
    s_add_u32 s54, s54, 28672
    s_add_u32 m0, s46, 18432
    s_nop 0
    buffer_load_dwordx4 v170, s[12:15], s54 offen lds
    s_add_u32 s54, s54, 28672
    s_add_u32 m0, s46, 19456
    s_nop 0
    buffer_load_dwordx4 v170, s[12:15], s54 offen lds
    v_mfma_f32_32x32x16_bf16 v[44:59], v[116:119], a[68:71], v[44:59]
    ds_read_b64_tr_b16 v[112:113], v168 offset:57344
    ds_read_b64_tr_b16 v[114:115], v168 offset:57856
    s_add_u32 s54, s54, 28672
    s_add_u32 m0, s46, 20480
    s_nop 0
    buffer_load_dwordx4 v170, s[12:15], s54 offen lds
    s_add_u32 s54, s54, 28672
    s_add_u32 m0, s46, 21504
    s_nop 0
    buffer_load_dwordx4 v170, s[12:15], s54 offen lds
    v_mfma_f32_32x32x16_bf16 v[60:75], v[120:123], a[68:71], v[60:75]
    ds_read_b64_tr_b16 v[116:117], v165 offset:59392
    ds_read_b64_tr_b16 v[118:119], v165 offset:59904
    s_add_u32 s54, s54, 28672
    s_add_u32 m0, s46, 22528
    s_nop 0
    buffer_load_dwordx4 v170, s[12:15], s54 offen lds
    s_add_u32 s54, s54, 28672
    s_add_u32 m0, s46, 23552
    s_nop 0
    buffer_load_dwordx4 v170, s[12:15], s54 offen lds
    s_waitcnt lgkmcnt(6)
    v_mfma_f32_32x32x16_bf16 v[44:59], v[124:127], a[72:75], v[44:59]
    ds_read_b64_tr_b16 v[120:121], v168 offset:59392
    ds_read_b64_tr_b16 v[122:123], v168 offset:59904
    v_mfma_f32_32x32x16_bf16 v[60:75], v[128:131], a[72:75], v[60:75]
    ds_read_b64_tr_b16 v[124:125], v166 offset:24576
    ds_read_b64_tr_b16 v[126:127], v166 offset:25088
    v_mfma_f32_32x32x16_bf16 v[44:59], v[132:135], a[76:79], v[44:59]
    ds_read_b64_tr_b16 v[128:129], v169 offset:24576
    ds_read_b64_tr_b16 v[130:131], v169 offset:25088
    v_mfma_f32_32x32x16_bf16 v[60:75], v[136:139], a[76:79], v[60:75]
    ds_read_b64_tr_b16 v[132:133], v166 offset:26624
    ds_read_b64_tr_b16 v[134:135], v166 offset:27136
    s_waitcnt lgkmcnt(6)
    v_mfma_f32_32x32x16_bf16 v[44:59], v[108:111], a[80:83], v[44:59]
    ds_read_b64_tr_b16 v[136:137], v169 offset:26624
    ds_read_b64_tr_b16 v[138:139], v169 offset:27136
    s_waitcnt vmcnt(25)
    s_barrier
    ds_read_b128 a[96:99], v6 offset:0
    ds_read_b128 a[100:103], v7 offset:0
    ds_read_b128 a[104:107], v8 offset:0
    ds_read_b128 a[108:111], v9 offset:0
    ds_read_b128 a[112:115], v6 offset:4096
    ds_read_b128 a[116:119], v7 offset:4096
    ds_read_b128 a[120:123], v8 offset:4096
    ds_read_b128 a[124:127], v9 offset:4096
    v_mfma_f32_32x32x16_bf16 v[60:75], v[112:115], a[80:83], v[60:75]
    ds_read_b64_tr_b16 v[108:109], v164 offset:61440
    ds_read_b64_tr_b16 v[110:111], v164 offset:61952
    v_mfma_f32_32x32x16_bf16 v[44:59], v[116:119], a[84:87], v[44:59]
    ds_read_b64_tr_b16 v[112:113], v167 offset:61440
    ds_read_b64_tr_b16 v[114:115], v167 offset:61952
    s_waitcnt vmcnt(8)
    v_lshl_or_b32 v100, v93, 16, v92
    v_lshl_or_b32 v101, v95, 16, v94
    v_lshl_or_b32 v102, v97, 16, v96
    v_lshl_or_b32 v103, v99, 16, v98
    buffer_store_dwordx4 v[100:103], v1, s[20:23], s67 offen sc0 sc1
    v_mfma_f32_32x32x16_bf16 v[60:75], v[120:123], a[84:87], v[60:75]
    ds_read_b64_tr_b16 v[116:117], v164 offset:63488
    ds_read_b64_tr_b16 v[118:119], v164 offset:64000
    s_waitcnt lgkmcnt(14)
    v_mfma_f32_32x32x16_bf16 v[44:59], v[124:127], a[88:91], v[44:59]
    ds_read_b64_tr_b16 v[120:121], v167 offset:63488
    ds_read_b64_tr_b16 v[122:123], v167 offset:64000
    v_mfma_f32_32x32x16_bf16 v[60:75], v[128:131], a[88:91], v[60:75]
    ds_read_b64_tr_b16 v[124:125], v165 offset:28672
    ds_read_b64_tr_b16 v[126:127], v165 offset:29184
    v_mfma_f32_32x32x16_bf16 v[44:59], v[132:135], a[92:95], v[44:59]
    ds_read_b64_tr_b16 v[128:129], v168 offset:28672
    ds_read_b64_tr_b16 v[130:131], v168 offset:29184
    v_mfma_f32_32x32x16_bf16 v[60:75], v[136:139], a[92:95], v[60:75]
    ds_read_b64_tr_b16 v[132:133], v165 offset:30720
    ds_read_b64_tr_b16 v[134:135], v165 offset:31232
    s_waitcnt lgkmcnt(6)
    v_mfma_f32_32x32x16_bf16 v[44:59], v[108:111], a[96:99], v[44:59]
    ds_read_b64_tr_b16 v[136:137], v168 offset:30720
    ds_read_b64_tr_b16 v[138:139], v168 offset:31232
    s_mov_b32 m0, s46
    s_nop 0
    buffer_load_dwordx4 v1, s[28:31], 0 offen lds
    v_mfma_f32_32x32x16_bf16 v[60:75], v[112:115], a[96:99], v[60:75]
    ds_read_b64_tr_b16 v[108:109], v165 offset:61440
    ds_read_b64_tr_b16 v[110:111], v165 offset:61952
    v_mfma_f32_32x32x16_bf16 v[44:59], v[116:119], a[100:103], v[44:59]
    ds_read_b64_tr_b16 v[112:113], v168 offset:61440
    ds_read_b64_tr_b16 v[114:115], v168 offset:61952
    v_mfma_f32_32x32x16_bf16 v[60:75], v[120:123], a[100:103], v[60:75]
    ds_read_b64_tr_b16 v[116:117], v165 offset:63488
    ds_read_b64_tr_b16 v[118:119], v165 offset:64000
    s_waitcnt lgkmcnt(6)
    v_mfma_f32_32x32x16_bf16 v[44:59], v[124:127], a[104:107], v[44:59]
    ds_read_b64_tr_b16 v[120:121], v168 offset:63488
    ds_read_b64_tr_b16 v[122:123], v168 offset:64000
    v_mfma_f32_32x32x16_bf16 v[60:75], v[128:131], a[104:107], v[60:75]
    ds_read_b64_tr_b16 v[124:125], v166 offset:28672
    ds_read_b64_tr_b16 v[126:127], v166 offset:29184
    v_mfma_f32_32x32x16_bf16 v[44:59], v[132:135], a[108:111], v[44:59]
    ds_read_b64_tr_b16 v[128:129], v169 offset:28672
    ds_read_b64_tr_b16 v[130:131], v169 offset:29184
    v_mfma_f32_32x32x16_bf16 v[60:75], v[136:139], a[108:111], v[60:75]
    ds_read_b64_tr_b16 v[132:133], v166 offset:30720
    ds_read_b64_tr_b16 v[134:135], v166 offset:31232
    s_waitcnt lgkmcnt(6)
    v_mfma_f32_32x32x16_bf16 v[44:59], v[108:111], a[112:115], v[44:59]
    ds_read_b64_tr_b16 v[136:137], v169 offset:30720
    ds_read_b64_tr_b16 v[138:139], v169 offset:31232
    s_waitcnt vmcnt(2)
    s_barrier
    v_mfma_f32_32x32x16_bf16 v[60:75], v[112:115], a[112:115], v[60:75]
    ds_read_b64_tr_b16 v[108:109], v164 offset:40960
    ds_read_b64_tr_b16 v[110:111], v164 offset:41472
    v_mfma_f32_32x32x16_bf16 v[44:59], v[116:119], a[116:119], v[44:59]
    ds_read_b64_tr_b16 v[112:113], v164 offset:43008
    ds_read_b64_tr_b16 v[114:115], v164 offset:43520
    v_mfma_f32_32x32x16_bf16 v[60:75], v[120:123], a[116:119], v[60:75]
    ds_read_b64_tr_b16 v[116:117], v164 offset:45056
    ds_read_b64_tr_b16 v[118:119], v164 offset:45568
    s_waitcnt lgkmcnt(6)
    v_mfma_f32_32x32x16_bf16 v[44:59], v[124:127], a[120:123], v[44:59]
    ds_read_b64_tr_b16 v[120:121], v164 offset:47104
    ds_read_b64_tr_b16 v[122:123], v164 offset:47616
    v_mfma_f32_32x32x16_bf16 v[60:75], v[128:131], a[120:123], v[60:75]
    ds_read_b64_tr_b16 v[124:125], v164 offset:49152
    ds_read_b64_tr_b16 v[126:127], v164 offset:49664
    v_mfma_f32_32x32x16_bf16 v[44:59], v[132:135], a[124:127], v[44:59]
    ds_read_b64_tr_b16 v[128:129], v164 offset:51200
    ds_read_b64_tr_b16 v[130:131], v164 offset:51712
    v_mfma_f32_32x32x16_bf16 v[60:75], v[136:139], a[124:127], v[60:75]
    ds_read_b64_tr_b16 v[132:133], v164 offset:53248
    ds_read_b64_tr_b16 v[134:135], v164 offset:53760
    v_mov_b32 v20, v18
    s_nop 1
    v_mfma_f32_32x32x16_bf16 v[140:155], v[20:23], v[24:27], 0
    s_waitcnt lgkmcnt(6)
    v_mfma_f32_32x32x16_bf16 v[140:155], v[108:111], a[0:3], v[140:155]
    ds_read_b64_tr_b16 v[136:137], v164 offset:55296
    ds_read_b64_tr_b16 v[138:139], v164 offset:55808
    v_mul_f32 v84, s60, v44
    v_mul_f32 v85, s60, v45
    v_exp_f32 v84, v84
    v_mfma_f32_32x32x16_bf16 v[140:155], v[112:115], a[4:7], v[140:155]
    ds_read_b64_tr_b16 v[108:109], v165 offset:8192
    ds_read_b64_tr_b16 v[110:111], v165 offset:8704
    v_exp_f32 v85, v85
    v_fma_f32 v86, v84, -0.5, -1.0
    v_fma_f32 v87, v85, -0.5, -1.0
    v_fma_f32 v86, v84, v86, -1.0
    v_mfma_f32_32x32x16_bf16 v[140:155], v[116:119], a[8:11], v[140:155]
    ds_read_b64_tr_b16 v[112:113], v165 offset:10240
    ds_read_b64_tr_b16 v[114:115], v165 offset:10752
    v_fma_f32 v87, v85, v87, -1.0
    v_rcp_f32 v86, v86
    v_rcp_f32 v87, v87
    v_mfma_f32_32x32x16_bf16 v[140:155], v[120:123], a[12:15], v[140:155]
    ds_read_b64_tr_b16 v[116:117], v165 offset:12288
    ds_read_b64_tr_b16 v[118:119], v165 offset:12800
    v_fma_f32 v86, v44, v86, v44
    v_fma_f32 v87, v45, v87, v45
    v_cvt_pk_bf16_f32 v76, v86, v87
    s_waitcnt lgkmcnt(6)
    v_mfma_f32_32x32x16_bf16 v[140:155], v[124:127], a[16:19], v[140:155]
    ds_read_b64_tr_b16 v[120:121], v165 offset:14336
    ds_read_b64_tr_b16 v[122:123], v165 offset:14848
    v_mul_f32 v88, s60, v46
    v_mul_f32 v89, s60, v47
    v_exp_f32 v88, v88
    v_mfma_f32_32x32x16_bf16 v[140:155], v[128:131], a[20:23], v[140:155]
    ds_read_b64_tr_b16 v[124:125], v165 offset:16384
    ds_read_b64_tr_b16 v[126:127], v165 offset:16896
    v_exp_f32 v89, v89
    v_fma_f32 v90, v88, -0.5, -1.0
    v_fma_f32 v91, v89, -0.5, -1.0
    v_fma_f32 v90, v88, v90, -1.0
    v_mfma_f32_32x32x16_bf16 v[140:155], v[132:135], a[24:27], v[140:155]
    ds_read_b64_tr_b16 v[128:129], v165 offset:18432
    ds_read_b64_tr_b16 v[130:131], v165 offset:18944
    v_fma_f32 v91, v89, v91, -1.0
    v_rcp_f32 v90, v90
    v_rcp_f32 v91, v91
    v_mfma_f32_32x32x16_bf16 v[140:155], v[136:139], a[28:31], v[140:155]
    ds_read_b64_tr_b16 v[132:133], v165 offset:20480
    ds_read_b64_tr_b16 v[134:135], v165 offset:20992
    v_fma_f32 v90, v46, v90, v46
    v_fma_f32 v91, v47, v91, v47
    v_cvt_pk_bf16_f32 v77, v90, v91
    s_waitcnt lgkmcnt(6)
    v_mfma_f32_32x32x16_bf16 v[140:155], v[108:111], a[32:35], v[140:155]
    ds_read_b64_tr_b16 v[136:137], v165 offset:22528
    ds_read_b64_tr_b16 v[138:139], v165 offset:23040
    v_mul_f32 v84, s60, v48
    v_mul_f32 v85, s60, v49
    v_exp_f32 v84, v84
    v_mfma_f32_32x32x16_bf16 v[140:155], v[112:115], a[36:39], v[140:155]
    ds_read_b64_tr_b16 v[108:109], v165 offset:40960
    ds_read_b64_tr_b16 v[110:111], v165 offset:41472
    v_exp_f32 v85, v85
    v_fma_f32 v86, v84, -0.5, -1.0
    v_fma_f32 v87, v85, -0.5, -1.0
    v_fma_f32 v86, v84, v86, -1.0
    v_mfma_f32_32x32x16_bf16 v[140:155], v[116:119], a[40:43], v[140:155]
    ds_read_b64_tr_b16 v[112:113], v165 offset:43008
    ds_read_b64_tr_b16 v[114:115], v165 offset:43520
    v_fma_f32 v87, v85, v87, -1.0
    v_rcp_f32 v86, v86
    v_rcp_f32 v87, v87
    v_mfma_f32_32x32x16_bf16 v[140:155], v[120:123], a[44:47], v[140:155]
    ds_read_b64_tr_b16 v[116:117], v165 offset:45056
    ds_read_b64_tr_b16 v[118:119], v165 offset:45568
    v_fma_f32 v86, v48, v86, v48
    v_fma_f32 v87, v49, v87, v49
    v_cvt_pk_bf16_f32 v78, v86, v87
    s_waitcnt lgkmcnt(6)
    v_mfma_f32_32x32x16_bf16 v[140:155], v[124:127], a[48:51], v[140:155]
    ds_read_b64_tr_b16 v[120:121], v165 offset:47104
    ds_read_b64_tr_b16 v[122:123], v165 offset:47616
    v_mul_f32 v88, s60, v50
    v_mul_f32 v89, s60, v51
    v_exp_f32 v88, v88
    v_mfma_f32_32x32x16_bf16 v[140:155], v[128:131], a[52:55], v[140:155]
    ds_read_b64_tr_b16 v[124:125], v165 offset:49152
    ds_read_b64_tr_b16 v[126:127], v165 offset:49664
    v_exp_f32 v89, v89
    v_fma_f32 v90, v88, -0.5, -1.0
    v_fma_f32 v91, v89, -0.5, -1.0
    v_fma_f32 v90, v88, v90, -1.0
    v_mfma_f32_32x32x16_bf16 v[140:155], v[132:135], a[56:59], v[140:155]
    ds_read_b64_tr_b16 v[128:129], v165 offset:51200
    ds_read_b64_tr_b16 v[130:131], v165 offset:51712
    v_fma_f32 v91, v89, v91, -1.0
    v_rcp_f32 v90, v90
    v_rcp_f32 v91, v91
    v_mfma_f32_32x32x16_bf16 v[140:155], v[136:139], a[60:63], v[140:155]
    ds_read_b64_tr_b16 v[132:133], v165 offset:53248
    ds_read_b64_tr_b16 v[134:135], v165 offset:53760
    v_fma_f32 v90, v50, v90, v50
    v_fma_f32 v91, v51, v91, v51
    v_cvt_pk_bf16_f32 v79, v90, v91
    s_add_u32 s69, s57, 0
    buffer_store_dwordx4 v[76:79], v1, s[20:23], s69 offen sc0 sc1
    s_waitcnt lgkmcnt(6)
    v_mfma_f32_32x32x16_bf16 v[140:155], v[108:111], a[64:67], v[140:155]
    ds_read_b64_tr_b16 v[136:137], v165 offset:55296
    ds_read_b64_tr_b16 v[138:139], v165 offset:55808
    v_mul_f32 v84, s60, v52
    v_mul_f32 v85, s60, v53
    v_exp_f32 v84, v84
    v_mfma_f32_32x32x16_bf16 v[140:155], v[112:115], a[68:71], v[140:155]
    ds_read_b64_tr_b16 v[108:109], v166 offset:8192
    ds_read_b64_tr_b16 v[110:111], v166 offset:8704
    v_exp_f32 v85, v85
    v_fma_f32 v86, v84, -0.5, -1.0
    v_fma_f32 v87, v85, -0.5, -1.0
    v_fma_f32 v86, v84, v86, -1.0
    v_mfma_f32_32x32x16_bf16 v[140:155], v[116:119], a[72:75], v[140:155]
    ds_read_b64_tr_b16 v[112:113], v166 offset:10240
    ds_read_b64_tr_b16 v[114:115], v166 offset:10752
    v_fma_f32 v87, v85, v87, -1.0
    v_rcp_f32 v86, v86
    v_rcp_f32 v87, v87
    v_mfma_f32_32x32x16_bf16 v[140:155], v[120:123], a[76:79], v[140:155]
    ds_read_b64_tr_b16 v[116:117], v166 offset:12288
    ds_read_b64_tr_b16 v[118:119], v166 offset:12800
    v_fma_f32 v86, v52, v86, v52
    v_fma_f32 v87, v53, v87, v53
    v_cvt_pk_bf16_f32 v80, v86, v87
    s_waitcnt lgkmcnt(6)
    v_mfma_f32_32x32x16_bf16 v[140:155], v[124:127], a[80:83], v[140:155]
    ds_read_b64_tr_b16 v[120:121], v166 offset:14336
    ds_read_b64_tr_b16 v[122:123], v166 offset:14848
    v_mul_f32 v88, s60, v54
    v_mul_f32 v89, s60, v55
    v_exp_f32 v88, v88
    v_mfma_f32_32x32x16_bf16 v[140:155], v[128:131], a[84:87], v[140:155]
    ds_read_b64_tr_b16 v[124:125], v166 offset:16384
    ds_read_b64_tr_b16 v[126:127], v166 offset:16896
    v_exp_f32 v89, v89
    v_fma_f32 v90, v88, -0.5, -1.0
    v_fma_f32 v91, v89, -0.5, -1.0
    v_fma_f32 v90, v88, v90, -1.0
    v_mfma_f32_32x32x16_bf16 v[140:155], v[132:135], a[88:91], v[140:155]
    ds_read_b64_tr_b16 v[128:129], v166 offset:18432
    ds_read_b64_tr_b16 v[130:131], v166 offset:18944
    v_fma_f32 v91, v89, v91, -1.0
    v_rcp_f32 v90, v90
    v_rcp_f32 v91, v91
    v_mfma_f32_32x32x16_bf16 v[140:155], v[136:139], a[92:95], v[140:155]
    ds_read_b64_tr_b16 v[132:133], v166 offset:20480
    ds_read_b64_tr_b16 v[134:135], v166 offset:20992
    v_fma_f32 v90, v54, v90, v54
    v_fma_f32 v91, v55, v91, v55
    v_cvt_pk_bf16_f32 v81, v90, v91
    s_waitcnt lgkmcnt(6)
    v_mfma_f32_32x32x16_bf16 v[140:155], v[108:111], a[96:99], v[140:155]
    ds_read_b64_tr_b16 v[136:137], v166 offset:22528
    ds_read_b64_tr_b16 v[138:139], v166 offset:23040
    v_mul_f32 v84, s60, v56
    v_mul_f32 v85, s60, v57
    v_exp_f32 v84, v84
    v_mfma_f32_32x32x16_bf16 v[140:155], v[112:115], a[100:103], v[140:155]
    ds_read_b64_tr_b16 v[108:109], v167 offset:40960
    ds_read_b64_tr_b16 v[110:111], v167 offset:41472
    v_exp_f32 v85, v85
    v_fma_f32 v86, v84, -0.5, -1.0
    v_fma_f32 v87, v85, -0.5, -1.0
    v_fma_f32 v86, v84, v86, -1.0
    v_mfma_f32_32x32x16_bf16 v[140:155], v[116:119], a[104:107], v[140:155]
    ds_read_b64_tr_b16 v[112:113], v167 offset:43008
    ds_read_b64_tr_b16 v[114:115], v167 offset:43520
    v_fma_f32 v87, v85, v87, -1.0
    v_rcp_f32 v86, v86
    v_rcp_f32 v87, v87
    v_mfma_f32_32x32x16_bf16 v[140:155], v[120:123], a[108:111], v[140:155]
    ds_read_b64_tr_b16 v[116:117], v167 offset:45056
    ds_read_b64_tr_b16 v[118:119], v167 offset:45568
    v_fma_f32 v86, v56, v86, v56
    v_fma_f32 v87, v57, v87, v57
    v_cvt_pk_bf16_f32 v82, v86, v87
    s_waitcnt lgkmcnt(6)
    v_mfma_f32_32x32x16_bf16 v[140:155], v[124:127], a[112:115], v[140:155]
    ds_read_b64_tr_b16 v[120:121], v167 offset:47104
    ds_read_b64_tr_b16 v[122:123], v167 offset:47616
    v_mul_f32 v88, s60, v58
    v_mul_f32 v89, s60, v59
    v_exp_f32 v88, v88
    v_mfma_f32_32x32x16_bf16 v[140:155], v[128:131], a[116:119], v[140:155]
    ds_read_b64_tr_b16 v[124:125], v167 offset:49152
    ds_read_b64_tr_b16 v[126:127], v167 offset:49664
    v_exp_f32 v89, v89
    v_fma_f32 v90, v88, -0.5, -1.0
    v_fma_f32 v91, v89, -0.5, -1.0
    v_fma_f32 v90, v88, v90, -1.0
    v_mfma_f32_32x32x16_bf16 v[140:155], v[132:135], a[120:123], v[140:155]
    ds_read_b64_tr_b16 v[128:129], v167 offset:51200
    ds_read_b64_tr_b16 v[130:131], v167 offset:51712
    v_fma_f32 v91, v89, v91, -1.0
    v_rcp_f32 v90, v90
    v_rcp_f32 v91, v91
    v_mfma_f32_32x32x16_bf16 v[140:155], v[136:139], a[124:127], v[140:155]
    ds_read_b64_tr_b16 v[132:133], v167 offset:53248
    ds_read_b64_tr_b16 v[134:135], v167 offset:53760
    v_fma_f32 v90, v58, v90, v58
    v_fma_f32 v91, v59, v91, v59
    v_cvt_pk_bf16_f32 v83, v90, v91
    s_add_u32 s69, s57, 1024
    buffer_store_dwordx4 v[80:83], v1, s[20:23], s69 offen sc0 sc1
    v_mov_b32 v20, v19
    s_nop 1
    v_mfma_f32_32x32x16_bf16 v[44:59], v[20:23], v[24:27], 0
    s_waitcnt lgkmcnt(6)
    v_mfma_f32_32x32x16_bf16 v[44:59], v[108:111], a[0:3], v[44:59]
    ds_read_b64_tr_b16 v[136:137], v167 offset:55296
    ds_read_b64_tr_b16 v[138:139], v167 offset:55808
    v_mul_f32 v84, s60, v60
    v_mul_f32 v85, s60, v61
    v_exp_f32 v84, v84
    v_mfma_f32_32x32x16_bf16 v[44:59], v[112:115], a[4:7], v[44:59]
    ds_read_b64_tr_b16 v[108:109], v168 offset:8192
    ds_read_b64_tr_b16 v[110:111], v168 offset:8704
    v_exp_f32 v85, v85
    v_fma_f32 v86, v84, -0.5, -1.0
    v_fma_f32 v87, v85, -0.5, -1.0
    v_fma_f32 v86, v84, v86, -1.0
    v_mfma_f32_32x32x16_bf16 v[44:59], v[116:119], a[8:11], v[44:59]
    ds_read_b64_tr_b16 v[112:113], v168 offset:10240
    ds_read_b64_tr_b16 v[114:115], v168 offset:10752
    v_fma_f32 v87, v85, v87, -1.0
    v_rcp_f32 v86, v86
    v_rcp_f32 v87, v87
    v_mfma_f32_32x32x16_bf16 v[44:59], v[120:123], a[12:15], v[44:59]
    ds_read_b64_tr_b16 v[116:117], v168 offset:12288
    ds_read_b64_tr_b16 v[118:119], v168 offset:12800
    v_fma_f32 v86, v60, v86, v60
    v_fma_f32 v87, v61, v87, v61
    v_cvt_pk_bf16_f32 v76, v86, v87
    s_waitcnt lgkmcnt(6)
    v_mfma_f32_32x32x16_bf16 v[44:59], v[124:127], a[16:19], v[44:59]
    ds_read_b64_tr_b16 v[120:121], v168 offset:14336
    ds_read_b64_tr_b16 v[122:123], v168 offset:14848
    v_mul_f32 v88, s60, v62
    v_mul_f32 v89, s60, v63
    v_exp_f32 v88, v88
    v_mfma_f32_32x32x16_bf16 v[44:59], v[128:131], a[20:23], v[44:59]
    ds_read_b64_tr_b16 v[124:125], v168 offset:16384
    ds_read_b64_tr_b16 v[126:127], v168 offset:16896
    v_exp_f32 v89, v89
    v_fma_f32 v90, v88, -0.5, -1.0
    v_fma_f32 v91, v89, -0.5, -1.0
    v_fma_f32 v90, v88, v90, -1.0
    v_mfma_f32_32x32x16_bf16 v[44:59], v[132:135], a[24:27], v[44:59]
    ds_read_b64_tr_b16 v[128:129], v168 offset:18432
    ds_read_b64_tr_b16 v[130:131], v168 offset:18944
    v_fma_f32 v91, v89, v91, -1.0
    v_rcp_f32 v90, v90
    v_rcp_f32 v91, v91
    v_mfma_f32_32x32x16_bf16 v[44:59], v[136:139], a[28:31], v[44:59]
    ds_read_b64_tr_b16 v[132:133], v168 offset:20480
    ds_read_b64_tr_b16 v[134:135], v168 offset:20992
    v_fma_f32 v90, v62, v90, v62
    v_fma_f32 v91, v63, v91, v63
    v_cvt_pk_bf16_f32 v77, v90, v91
    s_waitcnt lgkmcnt(6)
    v_mfma_f32_32x32x16_bf16 v[44:59], v[108:111], a[32:35], v[44:59]
    ds_read_b64_tr_b16 v[136:137], v168 offset:22528
    ds_read_b64_tr_b16 v[138:139], v168 offset:23040
    v_mul_f32 v84, s60, v64
    v_mul_f32 v85, s60, v65
    v_exp_f32 v84, v84
    v_mfma_f32_32x32x16_bf16 v[44:59], v[112:115], a[36:39], v[44:59]
    ds_read_b64_tr_b16 v[108:109], v168 offset:40960
    ds_read_b64_tr_b16 v[110:111], v168 offset:41472
    v_exp_f32 v85, v85
    v_fma_f32 v86, v84, -0.5, -1.0
    v_fma_f32 v87, v85, -0.5, -1.0
    v_fma_f32 v86, v84, v86, -1.0
    v_mfma_f32_32x32x16_bf16 v[44:59], v[116:119], a[40:43], v[44:59]
    ds_read_b64_tr_b16 v[112:113], v168 offset:43008
    ds_read_b64_tr_b16 v[114:115], v168 offset:43520
    v_fma_f32 v87, v85, v87, -1.0
    v_rcp_f32 v86, v86
    v_rcp_f32 v87, v87
    v_mfma_f32_32x32x16_bf16 v[44:59], v[120:123], a[44:47], v[44:59]
    ds_read_b64_tr_b16 v[116:117], v168 offset:45056
    ds_read_b64_tr_b16 v[118:119], v168 offset:45568
    v_fma_f32 v86, v64, v86, v64
    v_fma_f32 v87, v65, v87, v65
    v_cvt_pk_bf16_f32 v78, v86, v87
    s_waitcnt lgkmcnt(6)
    v_mfma_f32_32x32x16_bf16 v[44:59], v[124:127], a[48:51], v[44:59]
    ds_read_b64_tr_b16 v[120:121], v168 offset:47104
    ds_read_b64_tr_b16 v[122:123], v168 offset:47616
    v_mul_f32 v88, s60, v66
    v_mul_f32 v89, s60, v67
    v_exp_f32 v88, v88
    v_mfma_f32_32x32x16_bf16 v[44:59], v[128:131], a[52:55], v[44:59]
    ds_read_b64_tr_b16 v[124:125], v168 offset:49152
    ds_read_b64_tr_b16 v[126:127], v168 offset:49664
    v_exp_f32 v89, v89
    v_fma_f32 v90, v88, -0.5, -1.0
    v_fma_f32 v91, v89, -0.5, -1.0
    v_fma_f32 v90, v88, v90, -1.0
    v_mfma_f32_32x32x16_bf16 v[44:59], v[132:135], a[56:59], v[44:59]
    ds_read_b64_tr_b16 v[128:129], v168 offset:51200
    ds_read_b64_tr_b16 v[130:131], v168 offset:51712
    v_fma_f32 v91, v89, v91, -1.0
    v_rcp_f32 v90, v90
    v_rcp_f32 v91, v91
    v_mfma_f32_32x32x16_bf16 v[44:59], v[136:139], a[60:63], v[44:59]
    ds_read_b64_tr_b16 v[132:133], v168 offset:53248
    ds_read_b64_tr_b16 v[134:135], v168 offset:53760
    v_fma_f32 v90, v66, v90, v66
    v_fma_f32 v91, v67, v91, v67
    v_cvt_pk_bf16_f32 v79, v90, v91
    s_add_u32 s69, s57, 2048
    buffer_store_dwordx4 v[76:79], v1, s[20:23], s69 offen sc0 sc1
    s_waitcnt lgkmcnt(6)
    v_mfma_f32_32x32x16_bf16 v[44:59], v[108:111], a[64:67], v[44:59]
    ds_read_b64_tr_b16 v[136:137], v168 offset:55296
    ds_read_b64_tr_b16 v[138:139], v168 offset:55808
    v_mul_f32 v84, s60, v68
    v_mul_f32 v85, s60, v69
    v_exp_f32 v84, v84
    v_mfma_f32_32x32x16_bf16 v[44:59], v[112:115], a[68:71], v[44:59]
    ds_read_b64_tr_b16 v[108:109], v169 offset:8192
    ds_read_b64_tr_b16 v[110:111], v169 offset:8704
    v_exp_f32 v85, v85
    v_fma_f32 v86, v84, -0.5, -1.0
    v_fma_f32 v87, v85, -0.5, -1.0
    v_fma_f32 v86, v84, v86, -1.0
    v_mfma_f32_32x32x16_bf16 v[44:59], v[116:119], a[72:75], v[44:59]
    ds_read_b64_tr_b16 v[112:113], v169 offset:10240
    ds_read_b64_tr_b16 v[114:115], v169 offset:10752
    v_fma_f32 v87, v85, v87, -1.0
    v_rcp_f32 v86, v86
    v_rcp_f32 v87, v87
    v_mfma_f32_32x32x16_bf16 v[44:59], v[120:123], a[76:79], v[44:59]
    ds_read_b64_tr_b16 v[116:117], v169 offset:12288
    ds_read_b64_tr_b16 v[118:119], v169 offset:12800
    v_fma_f32 v86, v68, v86, v68
    v_fma_f32 v87, v69, v87, v69
    v_cvt_pk_bf16_f32 v80, v86, v87
    s_waitcnt lgkmcnt(6)
    v_mfma_f32_32x32x16_bf16 v[44:59], v[124:127], a[80:83], v[44:59]
    ds_read_b64_tr_b16 v[120:121], v169 offset:14336
    ds_read_b64_tr_b16 v[122:123], v169 offset:14848
    v_mul_f32 v88, s60, v70
    v_mul_f32 v89, s60, v71
    v_exp_f32 v88, v88
    v_mfma_f32_32x32x16_bf16 v[44:59], v[128:131], a[84:87], v[44:59]
    ds_read_b64_tr_b16 v[124:125], v169 offset:16384
    ds_read_b64_tr_b16 v[126:127], v169 offset:16896
    v_exp_f32 v89, v89
    v_fma_f32 v90, v88, -0.5, -1.0
    v_fma_f32 v91, v89, -0.5, -1.0
    v_fma_f32 v90, v88, v90, -1.0
    v_mfma_f32_32x32x16_bf16 v[44:59], v[132:135], a[88:91], v[44:59]
    ds_read_b64_tr_b16 v[128:129], v169 offset:18432
    ds_read_b64_tr_b16 v[130:131], v169 offset:18944
    v_fma_f32 v91, v89, v91, -1.0
    v_rcp_f32 v90, v90
    v_rcp_f32 v91, v91
    v_mfma_f32_32x32x16_bf16 v[44:59], v[136:139], a[92:95], v[44:59]
    ds_read_b64_tr_b16 v[132:133], v169 offset:20480
    ds_read_b64_tr_b16 v[134:135], v169 offset:20992
    v_fma_f32 v90, v70, v90, v70
    v_fma_f32 v91, v71, v91, v71
    v_cvt_pk_bf16_f32 v81, v90, v91
    s_waitcnt lgkmcnt(6)
    v_mfma_f32_32x32x16_bf16 v[44:59], v[108:111], a[96:99], v[44:59]
    ds_read_b64_tr_b16 v[136:137], v169 offset:22528
    ds_read_b64_tr_b16 v[138:139], v169 offset:23040
    v_mul_f32 v84, s60, v72
    v_mul_f32 v85, s60, v73
    v_exp_f32 v84, v84
    s_waitcnt vmcnt(3)
    s_barrier
    v_mfma_f32_32x32x16_bf16 v[44:59], v[112:115], a[100:103], v[44:59]
    ds_read_b128 v[108:111], v10 offset:0
    v_exp_f32 v85, v85
    v_fma_f32 v86, v84, -0.5, -1.0
    v_fma_f32 v87, v85, -0.5, -1.0
    v_fma_f32 v86, v84, v86, -1.0
    v_mfma_f32_32x32x16_bf16 v[44:59], v[116:119], a[104:107], v[44:59]
    ds_read_b128 v[112:115], v10 offset:32
    v_fma_f32 v87, v85, v87, -1.0
    v_rcp_f32 v86, v86
    v_rcp_f32 v87, v87
    v_mfma_f32_32x32x16_bf16 v[44:59], v[120:123], a[108:111], v[44:59]
    ds_read_b128 v[116:119], v10 offset:64
    v_fma_f32 v86, v72, v86, v72
    v_fma_f32 v87, v73, v87, v73
    v_cvt_pk_bf16_f32 v82, v86, v87
    s_waitcnt lgkmcnt(3)
    v_mfma_f32_32x32x16_bf16 v[44:59], v[124:127], a[112:115], v[44:59]
    ds_read_b128 v[120:123], v10 offset:96
    v_mul_f32 v88, s60, v74
    v_mul_f32 v89, s60, v75
    v_exp_f32 v88, v88
    v_mfma_f32_32x32x16_bf16 v[44:59], v[128:131], a[116:119], v[44:59]
    ds_read_b128 v[124:127], v10 offset:128
    v_exp_f32 v89, v89
    v_fma_f32 v90, v88, -0.5, -1.0
    v_fma_f32 v91, v89, -0.5, -1.0
    v_fma_f32 v90, v88, v90, -1.0
    v_mfma_f32_32x32x16_bf16 v[44:59], v[132:135], a[120:123], v[44:59]
    ds_read_b128 v[128:131], v10 offset:160
    v_fma_f32 v91, v89, v91, -1.0
    v_rcp_f32 v90, v90
    v_rcp_f32 v91, v91
    v_mfma_f32_32x32x16_bf16 v[44:59], v[136:139], a[124:127], v[44:59]
    ds_read_b128 v[132:135], v10 offset:192
    v_fma_f32 v90, v74, v90, v74
    v_fma_f32 v91, v75, v91, v75
    v_cvt_pk_bf16_f32 v83, v90, v91
    s_add_u32 s69, s57, 3072
    buffer_store_dwordx4 v[80:83], v1, s[20:23], s69 offen sc0 sc1
    s_waitcnt lgkmcnt(3)
    v_mfma_f32_32x32x16_bf16 v[60:75], v[108:111], a[0:3], 0
    ds_read_b128 v[136:139], v10 offset:224
    v_mul_f32 v84, s60, v140
    v_mul_f32 v85, s60, v141
    v_exp_f32 v84, v84
    v_mfma_f32_32x32x16_bf16 v[60:75], v[112:115], a[4:7], v[60:75]
    ds_read_b128 v[108:111], v10 offset:256
    v_exp_f32 v85, v85
    v_fma_f32 v86, v84, -0.5, -1.0
    v_fma_f32 v87, v85, -0.5, -1.0
    v_fma_f32 v86, v84, v86, -1.0
    v_mfma_f32_32x32x16_bf16 v[60:75], v[116:119], a[8:11], v[60:75]
    ds_read_b128 v[112:115], v10 offset:288
    v_fma_f32 v87, v85, v87, -1.0
    v_rcp_f32 v86, v86
    v_rcp_f32 v87, v87
    v_mfma_f32_32x32x16_bf16 v[60:75], v[120:123], a[12:15], v[60:75]
    ds_read_b128 v[116:119], v10 offset:320
    v_fma_f32 v86, v140, v86, v140
    v_fma_f32 v87, v141, v87, v141
    v_cvt_pk_bf16_f32 v76, v86, v87
    s_waitcnt lgkmcnt(3)
    v_mfma_f32_32x32x16_bf16 v[60:75], v[124:127], a[16:19], v[60:75]
    ds_read_b128 v[120:123], v10 offset:352
    v_mul_f32 v88, s60, v142
    v_mul_f32 v89, s60, v143
    v_exp_f32 v88, v88
    v_mfma_f32_32x32x16_bf16 v[60:75], v[128:131], a[20:23], v[60:75]
    ds_read_b128 v[124:127], v10 offset:384
    v_exp_f32 v89, v89
    v_fma_f32 v90, v88, -0.5, -1.0
    v_fma_f32 v91, v89, -0.5, -1.0
    v_fma_f32 v90, v88, v90, -1.0
    v_mfma_f32_32x32x16_bf16 v[60:75], v[132:135], a[24:27], v[60:75]
    ds_read_b128 v[128:131], v10 offset:416
    v_fma_f32 v91, v89, v91, -1.0
    v_rcp_f32 v90, v90
    v_rcp_f32 v91, v91
    v_mfma_f32_32x32x16_bf16 v[60:75], v[136:139], a[28:31], v[60:75]
    ds_read_b128 v[132:135], v10 offset:448
    v_fma_f32 v90, v142, v90, v142
    v_fma_f32 v91, v143, v91, v143
    v_cvt_pk_bf16_f32 v77, v90, v91
    s_waitcnt lgkmcnt(3)
    v_mfma_f32_32x32x16_bf16 v[60:75], v[108:111], a[32:35], v[60:75]
    ds_read_b128 v[136:139], v10 offset:480
    v_mul_f32 v84, s60, v144
    v_mul_f32 v85, s60, v145
    v_exp_f32 v84, v84
    v_mfma_f32_32x32x16_bf16 v[60:75], v[112:115], a[36:39], v[60:75]
    ds_read_b128 v[108:111], v10 offset:512
    v_exp_f32 v85, v85
    v_fma_f32 v86, v84, -0.5, -1.0
    v_fma_f32 v87, v85, -0.5, -1.0
    v_fma_f32 v86, v84, v86, -1.0
    v_mfma_f32_32x32x16_bf16 v[60:75], v[116:119], a[40:43], v[60:75]
    ds_read_b128 v[112:115], v10 offset:544
    v_fma_f32 v87, v85, v87, -1.0
    v_rcp_f32 v86, v86
    v_rcp_f32 v87, v87
    v_mfma_f32_32x32x16_bf16 v[60:75], v[120:123], a[44:47], v[60:75]
    ds_read_b128 v[116:119], v10 offset:576
    v_fma_f32 v86, v144, v86, v144
    v_fma_f32 v87, v145, v87, v145
    v_cvt_pk_bf16_f32 v78, v86, v87
    s_waitcnt lgkmcnt(3)
    v_mfma_f32_32x32x16_bf16 v[60:75], v[124:127], a[48:51], v[60:75]
    ds_read_b128 v[120:123], v10 offset:608
    v_mul_f32 v88, s60, v146
    v_mul_f32 v89, s60, v147
    v_exp_f32 v88, v88
    v_mfma_f32_32x32x16_bf16 v[60:75], v[128:131], a[52:55], v[60:75]
    ds_read_b128 v[124:127], v10 offset:640
    v_exp_f32 v89, v89
    v_fma_f32 v90, v88, -0.5, -1.0
    v_fma_f32 v91, v89, -0.5, -1.0
    v_fma_f32 v90, v88, v90, -1.0
    v_mfma_f32_32x32x16_bf16 v[60:75], v[132:135], a[56:59], v[60:75]
    ds_read_b128 v[128:131], v10 offset:672
    v_fma_f32 v91, v89, v91, -1.0
    v_rcp_f32 v90, v90
    v_rcp_f32 v91, v91
    v_mfma_f32_32x32x16_bf16 v[60:75], v[136:139], a[60:63], v[60:75]
    ds_read_b128 v[132:135], v10 offset:704
    v_fma_f32 v90, v146, v90, v146
    v_fma_f32 v91, v147, v91, v147
    v_cvt_pk_bf16_f32 v79, v90, v91
    s_add_u32 s69, s75, 0
    buffer_store_dwordx4 v[76:79], v1, s[20:23], s69 offen sc0 sc1
    s_waitcnt lgkmcnt(3)
    v_mfma_f32_32x32x16_bf16 v[60:75], v[108:111], a[64:67], v[60:75]
    ds_read_b128 v[136:139], v10 offset:736
    v_mul_f32 v84, s60, v148
    v_mul_f32 v85, s60, v149
    v_exp_f32 v84, v84
    v_mfma_f32_32x32x16_bf16 v[60:75], v[112:115], a[68:71], v[60:75]
    ds_read_b128 v[108:111], v10 offset:768
    v_exp_f32 v85, v85
    v_fma_f32 v86, v84, -0.5, -1.0
    v_fma_f32 v87, v85, -0.5, -1.0
    v_fma_f32 v86, v84, v86, -1.0
    v_mfma_f32_32x32x16_bf16 v[60:75], v[116:119], a[72:75], v[60:75]
    ds_read_b128 v[112:115], v10 offset:800
    v_fma_f32 v87, v85, v87, -1.0
    v_rcp_f32 v86, v86
    v_rcp_f32 v87, v87
    v_mfma_f32_32x32x16_bf16 v[60:75], v[120:123], a[76:79], v[60:75]
    ds_read_b128 v[116:119], v10 offset:832
    v_fma_f32 v86, v148, v86, v148
    v_fma_f32 v87, v149, v87, v149
    v_cvt_pk_bf16_f32 v80, v86, v87
    s_waitcnt lgkmcnt(3)
    v_mfma_f32_32x32x16_bf16 v[60:75], v[124:127], a[80:83], v[60:75]
    ds_read_b128 v[120:123], v10 offset:864
    v_mul_f32 v88, s60, v150
    v_mul_f32 v89, s60, v151
    v_exp_f32 v88, v88
    v_mfma_f32_32x32x16_bf16 v[60:75], v[128:131], a[84:87], v[60:75]
    ds_read_b128 v[124:127], v10 offset:896
    v_exp_f32 v89, v89
    v_fma_f32 v90, v88, -0.5, -1.0
    v_fma_f32 v91, v89, -0.5, -1.0
    v_fma_f32 v90, v88, v90, -1.0
    v_mfma_f32_32x32x16_bf16 v[60:75], v[132:135], a[88:91], v[60:75]
    ds_read_b128 v[128:131], v10 offset:928
    v_fma_f32 v91, v89, v91, -1.0
    v_rcp_f32 v90, v90
    v_rcp_f32 v91, v91
    v_mfma_f32_32x32x16_bf16 v[60:75], v[136:139], a[92:95], v[60:75]
    ds_read_b128 v[132:135], v10 offset:960
    v_fma_f32 v90, v150, v90, v150
    v_fma_f32 v91, v151, v91, v151
    v_cvt_pk_bf16_f32 v81, v90, v91
    s_waitcnt lgkmcnt(3)
    v_mfma_f32_32x32x16_bf16 v[60:75], v[108:111], a[96:99], v[60:75]
    ds_read_b128 v[136:139], v10 offset:992
    v_mul_f32 v84, s60, v152
    v_mul_f32 v85, s60, v153
    v_exp_f32 v84, v84
    v_mfma_f32_32x32x16_bf16 v[60:75], v[112:115], a[100:103], v[60:75]
    v_exp_f32 v85, v85
    v_fma_f32 v86, v84, -0.5, -1.0
    v_fma_f32 v87, v85, -0.5, -1.0
    v_fma_f32 v86, v84, v86, -1.0
    v_mfma_f32_32x32x16_bf16 v[60:75], v[116:119], a[104:107], v[60:75]
    v_fma_f32 v87, v85, v87, -1.0
    v_rcp_f32 v86, v86
    v_rcp_f32 v87, v87
    v_mfma_f32_32x32x16_bf16 v[60:75], v[120:123], a[108:111], v[60:75]
    v_fma_f32 v86, v152, v86, v152
    v_fma_f32 v87, v153, v87, v153
    v_cvt_pk_bf16_f32 v82, v86, v87
    s_waitcnt lgkmcnt(0)
    v_mfma_f32_32x32x16_bf16 v[60:75], v[124:127], a[112:115], v[60:75]
    v_mul_f32 v88, s60, v154
    v_mul_f32 v89, s60, v155
    v_exp_f32 v88, v88
    v_mfma_f32_32x32x16_bf16 v[60:75], v[128:131], a[116:119], v[60:75]
    v_exp_f32 v89, v89
    v_fma_f32 v90, v88, -0.5, -1.0
    v_fma_f32 v91, v89, -0.5, -1.0
    v_fma_f32 v90, v88, v90, -1.0
    v_mfma_f32_32x32x16_bf16 v[60:75], v[132:135], a[120:123], v[60:75]
    v_fma_f32 v91, v89, v91, -1.0
    v_rcp_f32 v90, v90
    v_rcp_f32 v91, v91
    v_mfma_f32_32x32x16_bf16 v[60:75], v[136:139], a[124:127], v[60:75]
    v_fma_f32 v90, v154, v90, v154
    v_fma_f32 v91, v155, v91, v155
    v_cvt_pk_bf16_f32 v83, v90, v91
    s_add_u32 s69, s75, 1024
    buffer_store_dwordx4 v[80:83], v1, s[20:23], s69 offen sc0 sc1
    v_mul_f32 v84, s60, v44
    v_mul_f32 v85, s60, v45
    v_exp_f32 v84, v84
    v_exp_f32 v85, v85
    v_fma_f32 v86, v84, -0.5, -1.0
    v_fma_f32 v87, v85, -0.5, -1.0
    v_fma_f32 v86, v84, v86, -1.0
    v_fma_f32 v87, v85, v87, -1.0
    v_rcp_f32 v86, v86
    v_rcp_f32 v87, v87
    v_fma_f32 v86, v44, v86, v44
    v_fma_f32 v87, v45, v87, v45
    v_cvt_pk_bf16_f32 v76, v86, v87
    v_mul_f32 v88, s60, v46
    v_mul_f32 v89, s60, v47
    v_exp_f32 v88, v88
    v_exp_f32 v89, v89
    v_fma_f32 v90, v88, -0.5, -1.0
    v_fma_f32 v91, v89, -0.5, -1.0
    v_fma_f32 v90, v88, v90, -1.0
    v_fma_f32 v91, v89, v91, -1.0
    v_rcp_f32 v90, v90
    v_rcp_f32 v91, v91
    v_fma_f32 v90, v46, v90, v46
    v_fma_f32 v91, v47, v91, v47
    v_cvt_pk_bf16_f32 v77, v90, v91
    v_mul_f32 v84, s60, v48
    v_mul_f32 v85, s60, v49
    v_exp_f32 v84, v84
    v_exp_f32 v85, v85
    v_fma_f32 v86, v84, -0.5, -1.0
    v_fma_f32 v87, v85, -0.5, -1.0
    v_fma_f32 v86, v84, v86, -1.0
    v_fma_f32 v87, v85, v87, -1.0
    v_rcp_f32 v86, v86
    v_rcp_f32 v87, v87
    v_fma_f32 v86, v48, v86, v48
    v_fma_f32 v87, v49, v87, v49
    v_cvt_pk_bf16_f32 v78, v86, v87
    v_mul_f32 v88, s60, v50
    v_mul_f32 v89, s60, v51
    v_exp_f32 v88, v88
    v_exp_f32 v89, v89
    v_fma_f32 v90, v88, -0.5, -1.0
    v_fma_f32 v91, v89, -0.5, -1.0
    v_fma_f32 v90, v88, v90, -1.0
    v_fma_f32 v91, v89, v91, -1.0
    v_rcp_f32 v90, v90
    v_rcp_f32 v91, v91
    v_fma_f32 v90, v50, v90, v50
    v_fma_f32 v91, v51, v91, v51
    v_cvt_pk_bf16_f32 v79, v90, v91
    s_add_u32 s69, s75, 2048
    buffer_store_dwordx4 v[76:79], v1, s[20:23], s69 offen sc0 sc1
    v_mul_f32 v84, s60, v52
    v_mul_f32 v85, s60, v53
    v_exp_f32 v84, v84
    v_exp_f32 v85, v85
    v_fma_f32 v86, v84, -0.5, -1.0
    v_fma_f32 v87, v85, -0.5, -1.0
    v_fma_f32 v86, v84, v86, -1.0
    v_fma_f32 v87, v85, v87, -1.0
    v_rcp_f32 v86, v86
    v_rcp_f32 v87, v87
    v_fma_f32 v86, v52, v86, v52
    v_fma_f32 v87, v53, v87, v53
    v_cvt_pk_bf16_f32 v80, v86, v87
    v_mul_f32 v88, s60, v54
    v_mul_f32 v89, s60, v55
    v_exp_f32 v88, v88
    v_exp_f32 v89, v89
    v_fma_f32 v90, v88, -0.5, -1.0
    v_fma_f32 v91, v89, -0.5, -1.0
    v_fma_f32 v90, v88, v90, -1.0
    v_fma_f32 v91, v89, v91, -1.0
    v_rcp_f32 v90, v90
    v_rcp_f32 v91, v91
    v_fma_f32 v90, v54, v90, v54
    v_fma_f32 v91, v55, v91, v55
    v_cvt_pk_bf16_f32 v81, v90, v91
    v_mul_f32 v84, s60, v56
    v_mul_f32 v85, s60, v57
    v_exp_f32 v84, v84
    v_exp_f32 v85, v85
    v_fma_f32 v86, v84, -0.5, -1.0
    v_fma_f32 v87, v85, -0.5, -1.0
    v_fma_f32 v86, v84, v86, -1.0
    v_fma_f32 v87, v85, v87, -1.0
    v_rcp_f32 v86, v86
    v_rcp_f32 v87, v87
    v_fma_f32 v86, v56, v86, v56
    v_fma_f32 v87, v57, v87, v57
    v_cvt_pk_bf16_f32 v82, v86, v87
    v_mul_f32 v88, s60, v58
    v_mul_f32 v89, s60, v59
    v_exp_f32 v88, v88
    v_exp_f32 v89, v89
    v_fma_f32 v90, v88, -0.5, -1.0
    v_fma_f32 v91, v89, -0.5, -1.0
    v_fma_f32 v90, v88, v90, -1.0
    v_fma_f32 v91, v89, v91, -1.0
    v_rcp_f32 v90, v90
    v_rcp_f32 v91, v91
    v_fma_f32 v90, v58, v90, v58
    v_fma_f32 v91, v59, v91, v59
    v_cvt_pk_bf16_f32 v83, v90, v91
    s_add_u32 s69, s75, 3072
    buffer_store_dwordx4 v[80:83], v1, s[20:23], s69 offen sc0 sc1
    v_mul_f32 v84, 0xbfb8aa3b, v60
    v_exp_f32 v84, v84
    s_nop 0
    v_add_f32 v84, 1.0, v84
    v_rcp_f32 v84, v84
    v_lshlrev_b32 v104, 2, v0
    v_lshrrev_b32 v15, 5, v0
    v_lshl_or_b32 v104, v15, 30, v104
    s_lshl_b32 s69, s45, 7
    s_add_u32 s69, s69, 2228224
    buffer_store_dword v84, v104, s[20:23], s69 offen sc0 sc1
    s_endpgm
K1_END:
    s_endpgm
.globl gm_k2_kernel
.p2align 8
.type gm_k2_kernel,@function
gm_k2_kernel:
    s_cmp_ge_u32 s2, 256
    s_cbranch_scc1 K2_END
    s_load_dwordx2 s[8:9], s[0:1], 96
    s_mov_b32 s10, 16777216
    s_mov_b32 s11, 0x00020000
    v_lshrrev_b32 v4, 6, v0
    v_and_b32 v0, 63, v0
    v_readfirstlane_b32 s12, v4
    s_and_b32 s15, s2, 7
    s_lshl_b32 s15, s15, 2
    s_lshr_b32 s16, s2, 3
    s_and_b32 s13, s16, 3
    s_add_u32 s13, s13, s15
    s_lshr_b32 s14, s16, 2
    v_lshlrev_b32 v1, 4, v0
    s_waitcnt lgkmcnt(0)
    s_cmp_ge_u32 s12, 4
    s_cbranch_scc1 K2_FFN
    s_lshl_b32 s15, s13, 6
    s_lshl_b32 s16, s14, 2
    s_add_u32 s15, s15, s16
    s_add_u32 s15, s15, s12
    s_lshl_b32 s22, s15, 10
    s_add_u32 s15, s22, 32768
    buffer_load_dwordx4 v[8:11], v1, s[8:11], s22 offen
    buffer_load_dwordx4 v[12:15], v1, s[8:11], s15 offen
    s_add_u32 s22, s22, 12058624
    v_mov_b32 v2, v1
    v_and_b32 v3, 15, v0
    v_lshlrev_b32 v3, 4, v3
    v_lshrrev_b32 v4, 5, v0
    v_lshl_or_b32 v3, v4, 8, v3
    v_add_u32 v3, 0x10000, v3
    s_mov_b32 s20, 0x0000ffff
    s_mov_b32 s21, 0x0000ffff
    v_bfe_u32 v4, v0, 4, 1
    v_mul_u32_u24 v4, 0x3f80, v4
    v_lshl_or_b32 v4, v4, 16, v4
    v_mov_b32 v24, v4
    v_mov_b32 v25, v4
    v_mov_b32 v26, v4
    v_mov_b32 v27, v4
    v_mov_b32 v28, v4
    v_mov_b32 v29, v4
    v_mov_b32 v30, v4
    v_mov_b32 v31, v4
    v_mov_b32 v32, v4
    v_mov_b32 v33, v4
    v_mov_b32 v34, v4
    v_mov_b32 v35, v4
    v_mov_b32 v36, v4
    v_mov_b32 v37, v4
    v_mov_b32 v38, v4
    v_mov_b32 v39, v4
    v_mov_b32 v80, 0
    v_mov_b32 v81, 0
    v_mov_b32 v82, 0
    v_mov_b32 v83, 0
    v_mov_b32 v84, 0
    v_mov_b32 v85, 0
    v_mov_b32 v86, 0
    v_mov_b32 v87, 0
    v_mov_b32 v88, 0
    v_mov_b32 v104, 0
    v_mov_b32 v89, 0
    v_mov_b32 v105, 0
    v_mov_b32 v90, 0
    v_mov_b32 v106, 0
    v_mov_b32 v91, 0
    v_mov_b32 v107, 0
    v_mov_b32 v92, 0
    v_mov_b32 v108, 0
    v_mov_b32 v93, 0
    v_mov_b32 v109, 0
    v_mov_b32 v94, 0
    v_mov_b32 v110, 0
    v_mov_b32 v95, 0
    v_mov_b32 v111, 0
    v_mov_b32 v96, 0
    v_mov_b32 v112, 0
    v_mov_b32 v97, 0
    v_mov_b32 v113, 0
    v_mov_b32 v98, 0
    v_mov_b32 v114, 0
    v_mov_b32 v99, 0
    v_mov_b32 v115, 0
    v_mov_b32 v100, 0
    v_mov_b32 v116, 0
    v_mov_b32 v101, 0
    v_mov_b32 v117, 0
    v_mov_b32 v102, 0
    v_mov_b32 v118, 0
    v_mov_b32 v103, 0
    v_mov_b32 v119, 0
    s_mov_b32 s18, 97
    s_mov_b32 s17, 8
    s_waitcnt vmcnt(0)
    s_barrier
    ds_read_b128 v[16:19], v2
    s_waitcnt lgkmcnt(0)
    v_mfma_f32_32x32x16_bf16 v[40:55], v[16:19], v[8:11], 0
K2_LOOP:
    v_mfma_f32_32x32x16_bf16 v[56:71], v[16:19], v[12:15], 0
    ds_read_b128 v[20:23], v2 offset:1024
    s_mov_b64 exec, s[20:21]
    ds_read_b128 v[24:27], v3 offset:0
    ds_read_b128 v[28:31], v3 offset:512
    s_mov_b64 exec, -1
    s_nop 5
    v_exp_f32 v40, v40
    v_exp_f32 v41, v41
    v_exp_f32 v42, v42
    v_mfma_f32_32x32x16_bf16 v[104:119], v[32:35], v[80:83], v[104:119]
    v_exp_f32 v43, v43
    v_exp_f32 v44, v44
    v_exp_f32 v45, v45
    v_mfma_f32_32x32x16_bf16 v[104:119], v[36:39], v[84:87], v[104:119]
    v_exp_f32 v46, v46
    v_cvt_pk_bf16_f32 v72, v40, v41
    v_exp_f32 v47, v47
    v_cvt_pk_bf16_f32 v73, v42, v43
    v_exp_f32 v48, v48
    v_cvt_pk_bf16_f32 v74, v44, v45
    v_exp_f32 v49, v49
    v_exp_f32 v50, v50
    v_exp_f32 v51, v51
    v_cvt_pk_bf16_f32 v75, v46, v47
    v_exp_f32 v52, v52
    v_cvt_pk_bf16_f32 v76, v48, v49
    v_exp_f32 v53, v53
    v_exp_f32 v54, v54
    v_exp_f32 v55, v55
    v_cvt_pk_bf16_f32 v77, v50, v51
    v_cvt_pk_bf16_f32 v78, v52, v53
    v_cvt_pk_bf16_f32 v79, v54, v55
    s_waitcnt lgkmcnt(0)
    v_mfma_f32_32x32x16_bf16 v[40:55], v[20:23], v[8:11], 0
    v_exp_f32 v56, v56
    v_exp_f32 v57, v57
    v_exp_f32 v58, v58
    v_mfma_f32_32x32x16_bf16 v[88:103], v[24:27], v[72:75], v[88:103]
    v_exp_f32 v59, v59
    v_exp_f32 v60, v60
    v_exp_f32 v61, v61
    v_mfma_f32_32x32x16_bf16 v[88:103], v[28:31], v[76:79], v[88:103]
    v_exp_f32 v62, v62
    v_cvt_pk_bf16_f32 v80, v56, v57
    v_exp_f32 v63, v63
    v_cvt_pk_bf16_f32 v81, v58, v59
    v_exp_f32 v64, v64
    v_cvt_pk_bf16_f32 v82, v60, v61
    v_exp_f32 v65, v65
    v_exp_f32 v66, v66
    v_exp_f32 v67, v67
    v_cvt_pk_bf16_f32 v83, v62, v63
    v_exp_f32 v68, v68
    v_cvt_pk_bf16_f32 v84, v64, v65
    v_exp_f32 v69, v69
    v_exp_f32 v70, v70
    v_exp_f32 v71, v71
    v_cvt_pk_bf16_f32 v85, v66, v67
    v_cvt_pk_bf16_f32 v86, v68, v69
    v_cvt_pk_bf16_f32 v87, v70, v71
    v_mfma_f32_32x32x16_bf16 v[56:71], v[20:23], v[12:15], 0
    ds_read_b128 v[16:19], v2 offset:2048
    s_mov_b64 exec, s[20:21]
    ds_read_b128 v[32:35], v3 offset:1024
    ds_read_b128 v[36:39], v3 offset:1536
    s_mov_b64 exec, -1
    v_exp_f32 v40, v40
    v_exp_f32 v41, v41
    v_exp_f32 v42, v42
    v_mfma_f32_32x32x16_bf16 v[104:119], v[24:27], v[80:83], v[104:119]
    v_exp_f32 v43, v43
    v_exp_f32 v44, v44
    v_exp_f32 v45, v45
    v_mfma_f32_32x32x16_bf16 v[104:119], v[28:31], v[84:87], v[104:119]
    v_exp_f32 v46, v46
    v_cvt_pk_bf16_f32 v72, v40, v41
    v_exp_f32 v47, v47
    v_cvt_pk_bf16_f32 v73, v42, v43
    v_exp_f32 v48, v48
    v_cvt_pk_bf16_f32 v74, v44, v45
    v_exp_f32 v49, v49
    v_exp_f32 v50, v50
    v_exp_f32 v51, v51
    v_cvt_pk_bf16_f32 v75, v46, v47
    v_exp_f32 v52, v52
    v_cvt_pk_bf16_f32 v76, v48, v49
    v_exp_f32 v53, v53
    v_exp_f32 v54, v54
    v_exp_f32 v55, v55
    v_cvt_pk_bf16_f32 v77, v50, v51
    v_cvt_pk_bf16_f32 v78, v52, v53
    v_cvt_pk_bf16_f32 v79, v54, v55
    s_waitcnt lgkmcnt(0)
    v_mfma_f32_32x32x16_bf16 v[40:55], v[16:19], v[8:11], 0
    v_exp_f32 v56, v56
    v_exp_f32 v57, v57
    v_exp_f32 v58, v58
    v_mfma_f32_32x32x16_bf16 v[88:103], v[32:35], v[72:75], v[88:103]
    v_exp_f32 v59, v59
    v_exp_f32 v60, v60
    v_exp_f32 v61, v61
    v_mfma_f32_32x32x16_bf16 v[88:103], v[36:39], v[76:79], v[88:103]
    v_exp_f32 v62, v62
    v_cvt_pk_bf16_f32 v80, v56, v57
    v_exp_f32 v63, v63
    v_cvt_pk_bf16_f32 v81, v58, v59
    v_exp_f32 v64, v64
    v_cvt_pk_bf16_f32 v82, v60, v61
    v_exp_f32 v65, v65
    v_exp_f32 v66, v66
    v_exp_f32 v67, v67
    v_cvt_pk_bf16_f32 v83, v62, v63
    v_exp_f32 v68, v68
    v_cvt_pk_bf16_f32 v84, v64, v65
    v_exp_f32 v69, v69
    v_exp_f32 v70, v70
    v_exp_f32 v71, v71
    v_cvt_pk_bf16_f32 v85, v66, v67
    v_cvt_pk_bf16_f32 v86, v68, v69
    v_cvt_pk_bf16_f32 v87, v70, v71
    v_mfma_f32_32x32x16_bf16 v[56:71], v[16:19], v[12:15], 0
    ds_read_b128 v[20:23], v2 offset:3072
    s_mov_b64 exec, s[20:21]
    ds_read_b128 v[24:27], v3 offset:2048
    ds_read_b128 v[28:31], v3 offset:2560
    s_mov_b64 exec, -1
    v_exp_f32 v40, v40
    v_exp_f32 v41, v41
    v_exp_f32 v42, v42
    v_mfma_f32_32x32x16_bf16 v[104:119], v[32:35], v[80:83], v[104:119]
    v_exp_f32 v43, v43
    v_exp_f32 v44, v44
    v_exp_f32 v45, v45
    v_mfma_f32_32x32x16_bf16 v[104:119], v[36:39], v[84:87], v[104:119]
    v_exp_f32 v46, v46
    v_cvt_pk_bf16_f32 v72, v40, v41
    v_exp_f32 v47, v47
    v_cvt_pk_bf16_f32 v73, v42, v43
    v_exp_f32 v48, v48
    v_cvt_pk_bf16_f32 v74, v44, v45
    v_exp_f32 v49, v49
    v_exp_f32 v50, v50
    v_exp_f32 v51, v51
    v_cvt_pk_bf16_f32 v75, v46, v47
    v_exp_f32 v52, v52
    v_cvt_pk_bf16_f32 v76, v48, v49
    v_exp_f32 v53, v53
    v_exp_f32 v54, v54
    v_exp_f32 v55, v55
    v_cvt_pk_bf16_f32 v77, v50, v51
    v_cvt_pk_bf16_f32 v78, v52, v53
    v_cvt_pk_bf16_f32 v79, v54, v55
    s_waitcnt lgkmcnt(0)
    v_mfma_f32_32x32x16_bf16 v[40:55], v[20:23], v[8:11], 0
    v_exp_f32 v56, v56
    v_exp_f32 v57, v57
    v_exp_f32 v58, v58
    v_mfma_f32_32x32x16_bf16 v[88:103], v[24:27], v[72:75], v[88:103]
    v_exp_f32 v59, v59
    v_exp_f32 v60, v60
    v_exp_f32 v61, v61
    v_mfma_f32_32x32x16_bf16 v[88:103], v[28:31], v[76:79], v[88:103]
    v_exp_f32 v62, v62
    v_cvt_pk_bf16_f32 v80, v56, v57
    v_exp_f32 v63, v63
    v_cvt_pk_bf16_f32 v81, v58, v59
    v_exp_f32 v64, v64
    v_cvt_pk_bf16_f32 v82, v60, v61
    v_exp_f32 v65, v65
    v_exp_f32 v66, v66
    v_exp_f32 v67, v67
    v_cvt_pk_bf16_f32 v83, v62, v63
    v_exp_f32 v68, v68
    v_cvt_pk_bf16_f32 v84, v64, v65
    v_exp_f32 v69, v69
    v_exp_f32 v70, v70
    v_exp_f32 v71, v71
    v_cvt_pk_bf16_f32 v85, v66, v67
    v_cvt_pk_bf16_f32 v86, v68, v69
    v_cvt_pk_bf16_f32 v87, v70, v71
    v_mfma_f32_32x32x16_bf16 v[56:71], v[20:23], v[12:15], 0
    ds_read_b128 v[16:19], v2 offset:4096
    s_mov_b64 exec, s[20:21]
    ds_read_b128 v[32:35], v3 offset:3072
    ds_read_b128 v[36:39], v3 offset:3584
    s_mov_b64 exec, -1
    v_exp_f32 v40, v40
    v_exp_f32 v41, v41
    v_exp_f32 v42, v42
    v_mfma_f32_32x32x16_bf16 v[104:119], v[24:27], v[80:83], v[104:119]
    v_exp_f32 v43, v43
    v_exp_f32 v44, v44
    v_exp_f32 v45, v45
    v_mfma_f32_32x32x16_bf16 v[104:119], v[28:31], v[84:87], v[104:119]
    v_exp_f32 v46, v46
    v_cvt_pk_bf16_f32 v72, v40, v41
    v_exp_f32 v47, v47
    v_cvt_pk_bf16_f32 v73, v42, v43
    v_exp_f32 v48, v48
    v_cvt_pk_bf16_f32 v74, v44, v45
    v_exp_f32 v49, v49
    v_exp_f32 v50, v50
    v_exp_f32 v51, v51
    v_cvt_pk_bf16_f32 v75, v46, v47
    v_exp_f32 v52, v52
    v_cvt_pk_bf16_f32 v76, v48, v49
    v_exp_f32 v53, v53
    v_exp_f32 v54, v54
    v_exp_f32 v55, v55
    v_cvt_pk_bf16_f32 v77, v50, v51
    v_cvt_pk_bf16_f32 v78, v52, v53
    v_cvt_pk_bf16_f32 v79, v54, v55
    s_waitcnt lgkmcnt(0)
    v_mfma_f32_32x32x16_bf16 v[40:55], v[16:19], v[8:11], 0
    v_exp_f32 v56, v56
    v_exp_f32 v57, v57
    v_exp_f32 v58, v58
    v_mfma_f32_32x32x16_bf16 v[88:103], v[32:35], v[72:75], v[88:103]
    v_exp_f32 v59, v59
    v_exp_f32 v60, v60
    v_exp_f32 v61, v61
    v_mfma_f32_32x32x16_bf16 v[88:103], v[36:39], v[76:79], v[88:103]
    v_exp_f32 v62, v62
    v_cvt_pk_bf16_f32 v80, v56, v57
    v_exp_f32 v63, v63
    v_cvt_pk_bf16_f32 v81, v58, v59
    v_exp_f32 v64, v64
    v_cvt_pk_bf16_f32 v82, v60, v61
    v_exp_f32 v65, v65
    v_exp_f32 v66, v66
    v_exp_f32 v67, v67
    v_cvt_pk_bf16_f32 v83, v62, v63
    v_exp_f32 v68, v68
    v_cvt_pk_bf16_f32 v84, v64, v65
    v_exp_f32 v69, v69
    v_exp_f32 v70, v70
    v_exp_f32 v71, v71
    v_cvt_pk_bf16_f32 v85, v66, v67
    v_cvt_pk_bf16_f32 v86, v68, v69
    v_cvt_pk_bf16_f32 v87, v70, v71
    v_mfma_f32_32x32x16_bf16 v[56:71], v[16:19], v[12:15], 0
    ds_read_b128 v[20:23], v2 offset:5120
    s_mov_b64 exec, s[20:21]
    ds_read_b128 v[24:27], v3 offset:4096
    ds_read_b128 v[28:31], v3 offset:4608
    s_mov_b64 exec, -1
    v_exp_f32 v40, v40
    v_exp_f32 v41, v41
    v_exp_f32 v42, v42
    v_mfma_f32_32x32x16_bf16 v[104:119], v[32:35], v[80:83], v[104:119]
    v_exp_f32 v43, v43
    v_exp_f32 v44, v44
    v_exp_f32 v45, v45
    v_mfma_f32_32x32x16_bf16 v[104:119], v[36:39], v[84:87], v[104:119]
    v_exp_f32 v46, v46
    v_cvt_pk_bf16_f32 v72, v40, v41
    v_exp_f32 v47, v47
    v_cvt_pk_bf16_f32 v73, v42, v43
    v_exp_f32 v48, v48
    v_cvt_pk_bf16_f32 v74, v44, v45
    v_exp_f32 v49, v49
    v_exp_f32 v50, v50
    v_exp_f32 v51, v51
    v_cvt_pk_bf16_f32 v75, v46, v47
    v_exp_f32 v52, v52
    v_cvt_pk_bf16_f32 v76, v48, v49
    v_exp_f32 v53, v53
    v_exp_f32 v54, v54
    v_exp_f32 v55, v55
    v_cvt_pk_bf16_f32 v77, v50, v51
    v_cvt_pk_bf16_f32 v78, v52, v53
    v_cvt_pk_bf16_f32 v79, v54, v55
    s_waitcnt lgkmcnt(0)
    v_mfma_f32_32x32x16_bf16 v[40:55], v[20:23], v[8:11], 0
    v_exp_f32 v56, v56
    v_exp_f32 v57, v57
    v_exp_f32 v58, v58
    v_mfma_f32_32x32x16_bf16 v[88:103], v[24:27], v[72:75], v[88:103]
    v_exp_f32 v59, v59
    v_exp_f32 v60, v60
    v_exp_f32 v61, v61
    v_mfma_f32_32x32x16_bf16 v[88:103], v[28:31], v[76:79], v[88:103]
    v_exp_f32 v62, v62
    v_cvt_pk_bf16_f32 v80, v56, v57
    v_exp_f32 v63, v63
    v_cvt_pk_bf16_f32 v81, v58, v59
    v_exp_f32 v64, v64
    v_cvt_pk_bf16_f32 v82, v60, v61
    v_exp_f32 v65, v65
    v_exp_f32 v66, v66
    v_exp_f32 v67, v67
    v_cvt_pk_bf16_f32 v83, v62, v63
    v_exp_f32 v68, v68
    v_cvt_pk_bf16_f32 v84, v64, v65
    v_exp_f32 v69, v69
    v_exp_f32 v70, v70
    v_exp_f32 v71, v71
    v_cvt_pk_bf16_f32 v85, v66, v67
    v_cvt_pk_bf16_f32 v86, v68, v69
    v_cvt_pk_bf16_f32 v87, v70, v71
    v_mfma_f32_32x32x16_bf16 v[56:71], v[20:23], v[12:15], 0
    ds_read_b128 v[16:19], v2 offset:6144
    s_mov_b64 exec, s[20:21]
    ds_read_b128 v[32:35], v3 offset:5120
    ds_read_b128 v[36:39], v3 offset:5632
    s_mov_b64 exec, -1
    v_exp_f32 v40, v40
    v_exp_f32 v41, v41
    v_exp_f32 v42, v42
    v_mfma_f32_32x32x16_bf16 v[104:119], v[24:27], v[80:83], v[104:119]
    v_exp_f32 v43, v43
    v_exp_f32 v44, v44
    v_exp_f32 v45, v45
    v_mfma_f32_32x32x16_bf16 v[104:119], v[28:31], v[84:87], v[104:119]
    v_exp_f32 v46, v46
    v_cvt_pk_bf16_f32 v72, v40, v41
    v_exp_f32 v47, v47
    v_cvt_pk_bf16_f32 v73, v42, v43
    v_exp_f32 v48, v48
    v_cvt_pk_bf16_f32 v74, v44, v45
    v_exp_f32 v49, v49
    v_exp_f32 v50, v50
    v_exp_f32 v51, v51
    v_cvt_pk_bf16_f32 v75, v46, v47
    v_exp_f32 v52, v52
    v_cvt_pk_bf16_f32 v76, v48, v49
    v_exp_f32 v53, v53
    v_exp_f32 v54, v54
    v_exp_f32 v55, v55
    v_cvt_pk_bf16_f32 v77, v50, v51
    v_cvt_pk_bf16_f32 v78, v52, v53
    v_cvt_pk_bf16_f32 v79, v54, v55
    s_waitcnt lgkmcnt(0)
    v_mfma_f32_32x32x16_bf16 v[40:55], v[16:19], v[8:11], 0
    v_exp_f32 v56, v56
    v_exp_f32 v57, v57
    v_exp_f32 v58, v58
    v_mfma_f32_32x32x16_bf16 v[88:103], v[32:35], v[72:75], v[88:103]
    v_exp_f32 v59, v59
    v_exp_f32 v60, v60
    v_exp_f32 v61, v61
    v_mfma_f32_32x32x16_bf16 v[88:103], v[36:39], v[76:79], v[88:103]
    v_exp_f32 v62, v62
    v_cvt_pk_bf16_f32 v80, v56, v57
    v_exp_f32 v63, v63
    v_cvt_pk_bf16_f32 v81, v58, v59
    v_exp_f32 v64, v64
    v_cvt_pk_bf16_f32 v82, v60, v61
    v_exp_f32 v65, v65
    v_exp_f32 v66, v66
    v_exp_f32 v67, v67
    v_cvt_pk_bf16_f32 v83, v62, v63
    v_exp_f32 v68, v68
    v_cvt_pk_bf16_f32 v84, v64, v65
    v_exp_f32 v69, v69
    v_exp_f32 v70, v70
    v_exp_f32 v71, v71
    v_cvt_pk_bf16_f32 v85, v66, v67
    v_cvt_pk_bf16_f32 v86, v68, v69
    v_cvt_pk_bf16_f32 v87, v70, v71
    v_mfma_f32_32x32x16_bf16 v[56:71], v[16:19], v[12:15], 0
    ds_read_b128 v[20:23], v2 offset:7168
    s_mov_b64 exec, s[20:21]
    ds_read_b128 v[24:27], v3 offset:6144
    ds_read_b128 v[28:31], v3 offset:6656
    s_mov_b64 exec, -1
    v_exp_f32 v40, v40
    v_exp_f32 v41, v41
    v_exp_f32 v42, v42
    v_mfma_f32_32x32x16_bf16 v[104:119], v[32:35], v[80:83], v[104:119]
    v_exp_f32 v43, v43
    v_exp_f32 v44, v44
    v_exp_f32 v45, v45
    v_mfma_f32_32x32x16_bf16 v[104:119], v[36:39], v[84:87], v[104:119]
    v_exp_f32 v46, v46
    v_cvt_pk_bf16_f32 v72, v40, v41
    v_exp_f32 v47, v47
    v_cvt_pk_bf16_f32 v73, v42, v43
    v_exp_f32 v48, v48
    v_cvt_pk_bf16_f32 v74, v44, v45
    v_exp_f32 v49, v49
    v_exp_f32 v50, v50
    v_exp_f32 v51, v51
    v_cvt_pk_bf16_f32 v75, v46, v47
    v_exp_f32 v52, v52
    v_cvt_pk_bf16_f32 v76, v48, v49
    v_exp_f32 v53, v53
    v_exp_f32 v54, v54
    v_exp_f32 v55, v55
    v_cvt_pk_bf16_f32 v77, v50, v51
    v_cvt_pk_bf16_f32 v78, v52, v53
    v_cvt_pk_bf16_f32 v79, v54, v55
    s_waitcnt lgkmcnt(0)
    v_mfma_f32_32x32x16_bf16 v[40:55], v[20:23], v[8:11], 0
    v_exp_f32 v56, v56
    v_exp_f32 v57, v57
    v_exp_f32 v58, v58
    v_mfma_f32_32x32x16_bf16 v[88:103], v[24:27], v[72:75], v[88:103]
    v_exp_f32 v59, v59
    v_exp_f32 v60, v60
    v_exp_f32 v61, v61
    v_mfma_f32_32x32x16_bf16 v[88:103], v[28:31], v[76:79], v[88:103]
    v_exp_f32 v62, v62
    v_cvt_pk_bf16_f32 v80, v56, v57
    v_exp_f32 v63, v63
    v_cvt_pk_bf16_f32 v81, v58, v59
    v_exp_f32 v64, v64
    v_cvt_pk_bf16_f32 v82, v60, v61
    v_exp_f32 v65, v65
    v_exp_f32 v66, v66
    v_exp_f32 v67, v67
    v_cvt_pk_bf16_f32 v83, v62, v63
    v_exp_f32 v68, v68
    v_cvt_pk_bf16_f32 v84, v64, v65
    v_exp_f32 v69, v69
    v_exp_f32 v70, v70
    v_exp_f32 v71, v71
    v_cvt_pk_bf16_f32 v85, v66, v67
    v_cvt_pk_bf16_f32 v86, v68, v69
    v_cvt_pk_bf16_f32 v87, v70, v71
    s_bitcmp1_b32 s18, 0
    s_cbranch_scc0 K2_NOBAR
    s_barrier
K2_NOBAR:
    v_mfma_f32_32x32x16_bf16 v[56:71], v[20:23], v[12:15], 0
    ds_read_b128 v[16:19], v2 offset:8192
    s_mov_b64 exec, s[20:21]
    ds_read_b128 v[32:35], v3 offset:7168
    ds_read_b128 v[36:39], v3 offset:7680
    s_mov_b64 exec, -1
    v_exp_f32 v40, v40
    v_exp_f32 v41, v41
    v_exp_f32 v42, v42
    v_mfma_f32_32x32x16_bf16 v[104:119], v[24:27], v[80:83], v[104:119]
    v_exp_f32 v43, v43
    v_exp_f32 v44, v44
    v_exp_f32 v45, v45
    v_mfma_f32_32x32x16_bf16 v[104:119], v[28:31], v[84:87], v[104:119]
    v_exp_f32 v46, v46
    v_cvt_pk_bf16_f32 v72, v40, v41
    v_exp_f32 v47, v47
    v_cvt_pk_bf16_f32 v73, v42, v43
    v_exp_f32 v48, v48
    v_cvt_pk_bf16_f32 v74, v44, v45
    v_exp_f32 v49, v49
    v_exp_f32 v50, v50
    v_exp_f32 v51, v51
    v_cvt_pk_bf16_f32 v75, v46, v47
    v_exp_f32 v52, v52
    v_cvt_pk_bf16_f32 v76, v48, v49
    v_exp_f32 v53, v53
    v_exp_f32 v54, v54
    v_exp_f32 v55, v55
    v_cvt_pk_bf16_f32 v77, v50, v51
    v_cvt_pk_bf16_f32 v78, v52, v53
    v_cvt_pk_bf16_f32 v79, v54, v55
    s_waitcnt lgkmcnt(0)
    v_mfma_f32_32x32x16_bf16 v[40:55], v[16:19], v[8:11], 0
    v_exp_f32 v56, v56
    v_exp_f32 v57, v57
    v_exp_f32 v58, v58
    v_mfma_f32_32x32x16_bf16 v[88:103], v[32:35], v[72:75], v[88:103]
    v_exp_f32 v59, v59
    v_exp_f32 v60, v60
    v_exp_f32 v61, v61
    v_mfma_f32_32x32x16_bf16 v[88:103], v[36:39], v[76:79], v[88:103]
    v_exp_f32 v62, v62
    v_cvt_pk_bf16_f32 v80, v56, v57
    v_exp_f32 v63, v63
    v_cvt_pk_bf16_f32 v81, v58, v59
    v_exp_f32 v64, v64
    v_cvt_pk_bf16_f32 v82, v60, v61
    v_exp_f32 v65, v65
    v_exp_f32 v66, v66
    v_exp_f32 v67, v67
    v_cvt_pk_bf16_f32 v83, v62, v63
    v_exp_f32 v68, v68
    v_cvt_pk_bf16_f32 v84, v64, v65
    v_exp_f32 v69, v69
    v_exp_f32 v70, v70
    v_exp_f32 v71, v71
    v_cvt_pk_bf16_f32 v85, v66, v67
    v_cvt_pk_bf16_f32 v86, v68, v69
    v_cvt_pk_bf16_f32 v87, v70, v71
    v_add_u32 v2, 0x2000, v2
    v_add_u32 v3, 0x2000, v3
    s_lshr_b32 s18, s18, 1
    s_sub_u32 s17, s17, 1
    s_cmp_lg_u32 s17, 0
    s_cbranch_scc1 K2_LOOP
    v_mfma_f32_32x32x16_bf16 v[104:119], v[32:35], v[80:83], v[104:119]
    v_mfma_f32_32x32x16_bf16 v[104:119], v[36:39], v[84:87], v[104:119]
    s_mov_b32 s15, 0x1f800000
    s_mov_b32 s16, 0x5f800000
    v_mul_f32 v4, 0, v88
    v_fma_f32 v4, v89, 0, v4
    v_fma_f32 v4, v90, 0, v4
    v_fma_f32 v4, v91, 0, v4
    v_fma_f32 v4, v92, 0, v4
    v_fma_f32 v4, v93, 0, v4
    v_fma_f32 v4, v94, 0, v4
    v_fma_f32 v4, v95, 0, v4
    v_cmp_le_f32 s[28:29], s15, v96
    v_cmp_ge_f32 s[30:31], s16, v96
    v_cmp_o_f32 s[32:33], v4, v4
    v_mul_f32 v4, 0, v104
    v_fma_f32 v4, v105, 0, v4
    v_fma_f32 v4, v106, 0, v4
    v_fma_f32 v4, v107, 0, v4
    v_fma_f32 v4, v108, 0, v4
    v_fma_f32 v4, v109, 0, v4
    v_fma_f32 v4, v110, 0, v4
    v_fma_f32 v4, v111, 0, v4
    v_cmp_le_f32 s[34:35], s15, v112
    v_cmp_ge_f32 s[36:37], s16, v112
    v_cmp_o_f32 s[38:39], v4, v4
    s_and_b64 s[28:29], s[28:29], s[30:31]
    s_and_b64 s[28:29], s[28:29], s[32:33]
    s_and_b64 s[28:29], s[28:29], s[34:35]
    s_and_b64 s[28:29], s[28:29], s[36:37]
    s_and_b64 s[28:29], s[28:29], s[38:39]
    s_cmp_eq_u64 s[28:29], -1
    s_cbranch_scc0 K2_SLOW
K2_FIN:
    v_rcp_f32 v4, v96
    v_mov_b32 v5, 0
    v_mul_f32 v88, v88, v4
    v_mul_f32 v89, v89, v4
    v_mul_f32 v90, v90, v4
    v_mul_f32 v91, v91, v4
    v_mul_f32 v92, v92, v4
    v_mul_f32 v93, v93, v4
    v_mul_f32 v94, v94, v4
    v_mul_f32 v95, v95, v4
    v_cvt_pk_bf16_f32 v72, v88, v89
    v_cvt_pk_bf16_f32 v73, v90, v91
    v_cvt_pk_bf16_f32 v74, v92, v93
    v_cvt_pk_bf16_f32 v75, v94, v95
    buffer_store_dwordx4 v[72:75], v1, s[8:11], s22 offen sc0 sc1
    v_rcp_f32 v4, v112
    v_mov_b32 v5, 0
    v_mul_f32 v104, v104, v4
    v_mul_f32 v105, v105, v4
    v_mul_f32 v106, v106, v4
    v_mul_f32 v107, v107, v4
    v_mul_f32 v108, v108, v4
    v_mul_f32 v109, v109, v4
    v_mul_f32 v110, v110, v4
    v_mul_f32 v111, v111, v4
    v_cvt_pk_bf16_f32 v80, v104, v105
    v_cvt_pk_bf16_f32 v81, v106, v107
    v_cvt_pk_bf16_f32 v82, v108, v109
    v_cvt_pk_bf16_f32 v83, v110, v111
    s_add_u32 s22, s22, 32768
    buffer_store_dwordx4 v[80:83], v1, s[8:11], s22 offen sc0 sc1
    s_endpgm
K2_SLOW:
    v_subrev_u32 v3, 0x10000, v3
    v_mov_b32 v2, v1
    v_mov_b32 v4, 0xff800000
    v_mov_b32 v5, v2
    s_mov_b32 s17, 64
K2_S1_0:
    ds_read_b128 v[16:19], v5
    v_add_u32 v5, 0x400, v5
    s_waitcnt lgkmcnt(0)
    v_mfma_f32_32x32x16_bf16 v[40:55], v[16:19], v[8:11], 0
    s_nop 11
    v_max3_f32 v4, v40, v41, v4
    v_max3_f32 v4, v42, v43, v4
    v_max3_f32 v4, v44, v45, v4
    v_max3_f32 v4, v46, v47, v4
    v_max3_f32 v4, v48, v49, v4
    v_max3_f32 v4, v50, v51, v4
    v_max3_f32 v4, v52, v53, v4
    v_max3_f32 v4, v54, v55, v4
    s_sub_u32 s17, s17, 1
    s_cmp_lg_u32 s17, 0
    s_cbranch_scc1 K2_S1_0
    v_mov_b32 v5, v4
    s_nop 1
    v_permlane32_swap_b32 v5, v4
    v_max_f32 v4, v4, v5
    v_sub_f32 v120, 0, v4
    v_mov_b32 v88, 0
    v_sub_f32 v121, 0, v4
    v_mov_b32 v89, 0
    v_sub_f32 v122, 0, v4
    v_mov_b32 v90, 0
    v_sub_f32 v123, 0, v4
    v_mov_b32 v91, 0
    v_sub_f32 v124, 0, v4
    v_mov_b32 v92, 0
    v_sub_f32 v125, 0, v4
    v_mov_b32 v93, 0
    v_sub_f32 v126, 0, v4
    v_mov_b32 v94, 0
    v_sub_f32 v127, 0, v4
    v_mov_b32 v95, 0
    v_sub_f32 v128, 0, v4
    v_mov_b32 v96, 0
    v_sub_f32 v129, 0, v4
    v_mov_b32 v97, 0
    v_sub_f32 v130, 0, v4
    v_mov_b32 v98, 0
    v_sub_f32 v131, 0, v4
    v_mov_b32 v99, 0
    v_sub_f32 v132, 0, v4
    v_mov_b32 v100, 0
    v_sub_f32 v133, 0, v4
    v_mov_b32 v101, 0
    v_sub_f32 v134, 0, v4
    v_mov_b32 v102, 0
    v_sub_f32 v135, 0, v4
    v_mov_b32 v103, 0
    v_mov_b32 v5, v2
    v_mov_b32 v6, v3
    s_mov_b32 s17, 64
K2_S2_0:
    ds_read_b128 v[16:19], v5
    s_mov_b64 exec, s[20:21]
    ds_read_b128 v[24:27], v6
    ds_read_b128 v[28:31], v6 offset:512
    s_mov_b64 exec, -1
    v_add_u32 v5, 0x400, v5
    v_add_u32 v6, 0x400, v6
    s_waitcnt lgkmcnt(0)
    v_mfma_f32_32x32x16_bf16 v[40:55], v[16:19], v[8:11], v[120:135]
    s_nop 11
    v_exp_f32 v40, v40
    v_exp_f32 v41, v41
    v_exp_f32 v42, v42
    v_exp_f32 v43, v43
    v_exp_f32 v44, v44
    v_exp_f32 v45, v45
    v_exp_f32 v46, v46
    v_exp_f32 v47, v47
    v_exp_f32 v48, v48
    v_exp_f32 v49, v49
    v_exp_f32 v50, v50
    v_exp_f32 v51, v51
    v_exp_f32 v52, v52
    v_exp_f32 v53, v53
    v_exp_f32 v54, v54
    v_exp_f32 v55, v55
    v_cvt_pk_bf16_f32 v72, v40, v41
    v_cvt_pk_bf16_f32 v73, v42, v43
    v_cvt_pk_bf16_f32 v74, v44, v45
    v_cvt_pk_bf16_f32 v75, v46, v47
    v_cvt_pk_bf16_f32 v76, v48, v49
    v_cvt_pk_bf16_f32 v77, v50, v51
    v_cvt_pk_bf16_f32 v78, v52, v53
    v_cvt_pk_bf16_f32 v79, v54, v55
    v_mfma_f32_32x32x16_bf16 v[88:103], v[24:27], v[72:75], v[88:103]
    s_nop 0
    v_mfma_f32_32x32x16_bf16 v[88:103], v[28:31], v[76:79], v[88:103]
    s_sub_u32 s17, s17, 1
    s_cmp_lg_u32 s17, 0
    s_cbranch_scc1 K2_S2_0
    v_mov_b32 v4, 0xff800000
    v_mov_b32 v5, v2
    s_mov_b32 s17, 64
K2_S1_1:
    ds_read_b128 v[16:19], v5
    v_add_u32 v5, 0x400, v5
    s_waitcnt lgkmcnt(0)
    v_mfma_f32_32x32x16_bf16 v[56:71], v[16:19], v[12:15], 0
    s_nop 11
    v_max3_f32 v4, v56, v57, v4
    v_max3_f32 v4, v58, v59, v4
    v_max3_f32 v4, v60, v61, v4
    v_max3_f32 v4, v62, v63, v4
    v_max3_f32 v4, v64, v65, v4
    v_max3_f32 v4, v66, v67, v4
    v_max3_f32 v4, v68, v69, v4
    v_max3_f32 v4, v70, v71, v4
    s_sub_u32 s17, s17, 1
    s_cmp_lg_u32 s17, 0
    s_cbranch_scc1 K2_S1_1
    v_mov_b32 v5, v4
    s_nop 1
    v_permlane32_swap_b32 v5, v4
    v_max_f32 v4, v4, v5
    v_sub_f32 v120, 0, v4
    v_mov_b32 v104, 0
    v_sub_f32 v121, 0, v4
    v_mov_b32 v105, 0
    v_sub_f32 v122, 0, v4
    v_mov_b32 v106, 0
    v_sub_f32 v123, 0, v4
    v_mov_b32 v107, 0
    v_sub_f32 v124, 0, v4
    v_mov_b32 v108, 0
    v_sub_f32 v125, 0, v4
    v_mov_b32 v109, 0
    v_sub_f32 v126, 0, v4
    v_mov_b32 v110, 0
    v_sub_f32 v127, 0, v4
    v_mov_b32 v111, 0
    v_sub_f32 v128, 0, v4
    v_mov_b32 v112, 0
    v_sub_f32 v129, 0, v4
    v_mov_b32 v113, 0
    v_sub_f32 v130, 0, v4
    v_mov_b32 v114, 0
    v_sub_f32 v131, 0, v4
    v_mov_b32 v115, 0
    v_sub_f32 v132, 0, v4
    v_mov_b32 v116, 0
    v_sub_f32 v133, 0, v4
    v_mov_b32 v117, 0
    v_sub_f32 v134, 0, v4
    v_mov_b32 v118, 0
    v_sub_f32 v135, 0, v4
    v_mov_b32 v119, 0
    v_mov_b32 v5, v2
    v_mov_b32 v6, v3
    s_mov_b32 s17, 64
K2_S2_1:
    ds_read_b128 v[16:19], v5
    s_mov_b64 exec, s[20:21]
    ds_read_b128 v[24:27], v6
    ds_read_b128 v[28:31], v6 offset:512
    s_mov_b64 exec, -1
    v_add_u32 v5, 0x400, v5
    v_add_u32 v6, 0x400, v6
    s_waitcnt lgkmcnt(0)
    v_mfma_f32_32x32x16_bf16 v[56:71], v[16:19], v[12:15], v[120:135]
    s_nop 11
    v_exp_f32 v56, v56
    v_exp_f32 v57, v57
    v_exp_f32 v58, v58
    v_exp_f32 v59, v59
    v_exp_f32 v60, v60
    v_exp_f32 v61, v61
    v_exp_f32 v62, v62
    v_exp_f32 v63, v63
    v_exp_f32 v64, v64
    v_exp_f32 v65, v65
    v_exp_f32 v66, v66
    v_exp_f32 v67, v67
    v_exp_f32 v68, v68
    v_exp_f32 v69, v69
    v_exp_f32 v70, v70
    v_exp_f32 v71, v71
    v_cvt_pk_bf16_f32 v80, v56, v57
    v_cvt_pk_bf16_f32 v81, v58, v59
    v_cvt_pk_bf16_f32 v82, v60, v61
    v_cvt_pk_bf16_f32 v83, v62, v63
    v_cvt_pk_bf16_f32 v84, v64, v65
    v_cvt_pk_bf16_f32 v85, v66, v67
    v_cvt_pk_bf16_f32 v86, v68, v69
    v_cvt_pk_bf16_f32 v87, v70, v71
    v_mfma_f32_32x32x16_bf16 v[104:119], v[24:27], v[80:83], v[104:119]
    s_nop 0
    v_mfma_f32_32x32x16_bf16 v[104:119], v[28:31], v[84:87], v[104:119]
    s_sub_u32 s17, s17, 1
    s_cmp_lg_u32 s17, 0
    s_cbranch_scc1 K2_S2_1
    s_branch K2_FIN
K2_FFN:
    s_setprio 3
    s_sub_u32 s25, s12, 4
    s_lshl_b32 s26, s25, 10
    s_mov_b32 m0, s26
    s_add_u32 s22, s26, 2097152
    buffer_load_dwordx4 v1, s[8:11], s22 offen lds
    s_add_u32 m0, s26, 65536
    s_add_u32 s22, s26, 2162688
    buffer_load_dwordx4 v1, s[8:11], s22 offen lds
    s_add_u32 m0, s26, 4096
    s_add_u32 s22, s26, 2101248
    buffer_load_dwordx4 v1, s[8:11], s22 offen lds
    s_add_u32 m0, s26, 69632
    s_add_u32 s22, s26, 2166784
    buffer_load_dwordx4 v1, s[8:11], s22 offen lds
    s_lshr_b32 s15, s25, 1
    s_and_b32 s16, s25, 1
    s_lshl_b32 s23, s15, 10
    v_add_u32 v2, s23, v1
    v_xor_b32 v3, 0x400, v2
    s_mul_i32 s23, s16, 114688
    v_add_u32 v4, s23, v1
    s_xor_b32 s23, s16, 1
    s_mul_i32 s23, s23, 114688
    v_add_u32 v5, s23, v1
    s_mul_i32 s23, s25, 458752
    s_lshl_b32 s15, s14, 11
    s_add_u32 s23, s23, s15
    s_add_u32 s23, s23, 2359296
    s_mul_i32 s24, s13, 229376
    s_mul_i32 s15, s25, 28672
    s_add_u32 s24, s24, s15
    s_add_u32 s24, s24, 4718592
    s_waitcnt vmcnt(0)
    s_barrier
    s_add_u32 m0, s26, 8192
    s_add_u32 s22, s26, 2105344
    buffer_load_dwordx4 v1, s[8:11], s22 offen lds
    s_add_u32 m0, s26, 73728
    s_add_u32 s22, s26, 2170880
    buffer_load_dwordx4 v1, s[8:11], s22 offen lds
    s_add_u32 m0, s26, 12288
    s_add_u32 s22, s26, 2109440
    buffer_load_dwordx4 v1, s[8:11], s22 offen lds
    s_add_u32 m0, s26, 77824
    s_add_u32 s22, s26, 2174976
    buffer_load_dwordx4 v1, s[8:11], s22 offen lds
    s_add_u32 m0, s26, 16384
    s_add_u32 s22, s26, 2113536
    buffer_load_dwordx4 v1, s[8:11], s22 offen lds
    s_add_u32 m0, s26, 81920
    s_add_u32 s22, s26, 2179072
    buffer_load_dwordx4 v1, s[8:11], s22 offen lds
    s_add_u32 m0, s26, 20480
    s_add_u32 s22, s26, 2117632
    buffer_load_dwordx4 v1, s[8:11], s22 offen lds
    s_add_u32 m0, s26, 86016
    s_add_u32 s22, s26, 2183168
    buffer_load_dwordx4 v1, s[8:11], s22 offen lds
    s_add_u32 m0, s26, 24576
    s_add_u32 s22, s26, 2121728
    buffer_load_dwordx4 v1, s[8:11], s22 offen lds
    s_add_u32 m0, s26, 90112
    s_add_u32 s22, s26, 2187264
    buffer_load_dwordx4 v1, s[8:11], s22 offen lds
    s_add_u32 m0, s26, 28672
    s_add_u32 s22, s26, 2125824
    buffer_load_dwordx4 v1, s[8:11], s22 offen lds
    s_add_u32 m0, s26, 94208
    s_add_u32 s22, s26, 2191360
    buffer_load_dwordx4 v1, s[8:11], s22 offen lds
    s_add_u32 m0, s26, 32768
    s_add_u32 s22, s26, 2129920
    buffer_load_dwordx4 v1, s[8:11], s22 offen lds
    s_add_u32 m0, s26, 98304
    s_add_u32 s22, s26, 2195456
    buffer_load_dwordx4 v1, s[8:11], s22 offen lds
    s_add_u32 m0, s26, 36864
    s_add_u32 s22, s26, 2134016
    buffer_load_dwordx4 v1, s[8:11], s22 offen lds
    s_add_u32 m0, s26, 102400
    s_add_u32 s22, s26, 2199552
    buffer_load_dwordx4 v1, s[8:11], s22 offen lds
    s_add_u32 m0, s26, 40960
    s_add_u32 s22, s26, 2138112
    buffer_load_dwordx4 v1, s[8:11], s22 offen lds
    s_add_u32 m0, s26, 106496
    s_add_u32 s22, s26, 2203648
    buffer_load_dwordx4 v1, s[8:11], s22 offen lds
    s_add_u32 m0, s26, 45056
    s_add_u32 s22, s26, 2142208
    buffer_load_dwordx4 v1, s[8:11], s22 offen lds
    s_add_u32 m0, s26, 110592
    s_add_u32 s22, s26, 2207744
    buffer_load_dwordx4 v1, s[8:11], s22 offen lds
    s_add_u32 m0, s26, 49152
    s_add_u32 s22, s26, 2146304
    buffer_load_dwordx4 v1, s[8:11], s22 offen lds
    s_add_u32 m0, s26, 114688
    s_add_u32 s22, s26, 2211840
    buffer_load_dwordx4 v1, s[8:11], s22 offen lds
    s_add_u32 m0, s26, 53248
    s_add_u32 s22, s26, 2150400
    buffer_load_dwordx4 v1, s[8:11], s22 offen lds
    s_add_u32 m0, s26, 118784
    s_add_u32 s22, s26, 2215936
    buffer_load_dwordx4 v1, s[8:11], s22 offen lds
    s_add_u32 m0, s26, 57344
    s_add_u32 s22, s26, 2154496
    buffer_load_dwordx4 v1, s[8:11], s22 offen lds
    s_add_u32 m0, s26, 122880
    s_add_u32 s22, s26, 2220032
    buffer_load_dwordx4 v1, s[8:11], s22 offen lds
    s_add_u32 m0, s26, 61440
    s_add_u32 s22, s26, 2158592
    buffer_load_dwordx4 v1, s[8:11], s22 offen lds
    s_add_u32 m0, s26, 126976
    s_add_u32 s22, s26, 2224128
    buffer_load_dwordx4 v1, s[8:11], s22 offen lds
    s_waitcnt vmcnt(0)
    s_barrier
    s_setprio 0
    s_mov_b32 s30, s23
    s_mov_b32 s31, s24
    buffer_load_dwordx4 v[8:11], v2, s[8:11], s30 offen
    buffer_load_dwordx4 v[16:19], v4, s[8:11], s31 offen
    buffer_load_dwordx4 v[20:23], v5, s[8:11], s31 offen
    buffer_load_dwordx4 v[12:15], v3, s[8:11], s30 offen
    s_add_u32 s30, s30, 16384
    buffer_load_dwordx4 v[24:27], v2, s[8:11], s30 offen
    buffer_load_dwordx4 v[32:35], v4, s[8:11], s31 offen offset:1024
    buffer_load_dwordx4 v[36:39], v5, s[8:11], s31 offen offset:1024
    buffer_load_dwordx4 v[28:31], v3, s[8:11], s30 offen
    s_add_u32 s30, s30, 16384
    buffer_load_dwordx4 v[40:43], v2, s[8:11], s30 offen
    buffer_load_dwordx4 v[48:51], v4, s[8:11], s31 offen offset:2048
    buffer_load_dwordx4 v[52:55], v5, s[8:11], s31 offen offset:2048
    buffer_load_dwordx4 v[44:47], v3, s[8:11], s30 offen
    s_add_u32 s30, s30, 16384
    buffer_load_dwordx4 v[56:59], v2, s[8:11], s30 offen
    buffer_load_dwordx4 v[64:67], v4, s[8:11], s31 offen offset:3072
    buffer_load_dwordx4 v[68:71], v5, s[8:11], s31 offen offset:3072
    buffer_load_dwordx4 v[60:63], v3, s[8:11], s30 offen
    v_mov_b32 v72, 0
    v_mov_b32 v73, 0
    v_mov_b32 v74, 0
    v_mov_b32 v75, 0
    v_mov_b32 v76, 0
    v_mov_b32 v77, 0
    v_mov_b32 v78, 0
    v_mov_b32 v79, 0
    v_mov_b32 v80, 0
    v_mov_b32 v81, 0
    v_mov_b32 v82, 0
    v_mov_b32 v83, 0
    v_mov_b32 v84, 0
    v_mov_b32 v85, 0
    v_mov_b32 v86, 0
    v_mov_b32 v87, 0
    v_mov_b32 v88, 0
    v_mov_b32 v89, 0
    v_mov_b32 v90, 0
    v_mov_b32 v91, 0
    v_mov_b32 v92, 0
    v_mov_b32 v93, 0
    v_mov_b32 v94, 0
    v_mov_b32 v95, 0
    v_mov_b32 v96, 0
    v_mov_b32 v97, 0
    v_mov_b32 v98, 0
    v_mov_b32 v99, 0
    v_mov_b32 v100, 0
    v_mov_b32 v101, 0
    v_mov_b32 v102, 0
    v_mov_b32 v103, 0
    v_mov_b32 v104, 0
    v_mov_b32 v105, 0
    v_mov_b32 v106, 0
    v_mov_b32 v107, 0
    v_mov_b32 v108, 0
    v_mov_b32 v109, 0
    v_mov_b32 v110, 0
    v_mov_b32 v111, 0
    v_mov_b32 v112, 0
    v_mov_b32 v113, 0
    v_mov_b32 v114, 0
    v_mov_b32 v115, 0
    v_mov_b32 v116, 0
    v_mov_b32 v117, 0
    v_mov_b32 v118, 0
    v_mov_b32 v119, 0
    v_mov_b32 v120, 0
    v_mov_b32 v121, 0
    v_mov_b32 v122, 0
    v_mov_b32 v123, 0
    v_mov_b32 v124, 0
    v_mov_b32 v125, 0
    v_mov_b32 v126, 0
    v_mov_b32 v127, 0
    v_mov_b32 v128, 0
    v_mov_b32 v129, 0
    v_mov_b32 v130, 0
    v_mov_b32 v131, 0
    v_mov_b32 v132, 0
    v_mov_b32 v133, 0
    v_mov_b32 v134, 0
    v_mov_b32 v135, 0
    s_waitcnt vmcnt(12)
    s_add_u32 s30, s30, 16384
    s_add_u32 s31, s31, 4096
    v_mfma_f32_32x32x16_bf16 v[72:87], v[8:11], v[16:19], v[72:87]
    v_mfma_f32_32x32x16_bf16 v[88:103], v[8:11], v[20:23], v[88:103]
    buffer_load_dwordx4 v[8:11], v2, s[8:11], s30 offen
    v_mfma_f32_32x32x16_bf16 v[104:119], v[12:15], v[16:19], v[104:119]
    buffer_load_dwordx4 v[16:19], v4, s[8:11], s31 offen
    v_mfma_f32_32x32x16_bf16 v[120:135], v[12:15], v[20:23], v[120:135]
    buffer_load_dwordx4 v[20:23], v5, s[8:11], s31 offen
    buffer_load_dwordx4 v[12:15], v3, s[8:11], s30 offen
    s_waitcnt vmcnt(12)
    s_add_u32 s30, s30, 16384
    v_mfma_f32_32x32x16_bf16 v[72:87], v[24:27], v[32:35], v[72:87]
    v_mfma_f32_32x32x16_bf16 v[88:103], v[24:27], v[36:39], v[88:103]
    buffer_load_dwordx4 v[24:27], v2, s[8:11], s30 offen
    v_mfma_f32_32x32x16_bf16 v[104:119], v[28:31], v[32:35], v[104:119]
    buffer_load_dwordx4 v[32:35], v4, s[8:11], s31 offen offset:1024
    v_mfma_f32_32x32x16_bf16 v[120:135], v[28:31], v[36:39], v[120:135]
    buffer_load_dwordx4 v[36:39], v5, s[8:11], s31 offen offset:1024
    buffer_load_dwordx4 v[28:31], v3, s[8:11], s30 offen
    s_waitcnt vmcnt(12)
    s_add_u32 s30, s30, 16384
    v_mfma_f32_32x32x16_bf16 v[72:87], v[40:43], v[48:51], v[72:87]
    v_mfma_f32_32x32x16_bf16 v[88:103], v[40:43], v[52:55], v[88:103]
    buffer_load_dwordx4 v[40:43], v2, s[8:11], s30 offen
    v_mfma_f32_32x32x16_bf16 v[104:119], v[44:47], v[48:51], v[104:119]
    buffer_load_dwordx4 v[48:51], v4, s[8:11], s31 offen offset:2048
    v_mfma_f32_32x32x16_bf16 v[120:135], v[44:47], v[52:55], v[120:135]
    buffer_load_dwordx4 v[52:55], v5, s[8:11], s31 offen offset:2048
    buffer_load_dwordx4 v[44:47], v3, s[8:11], s30 offen
    s_waitcnt vmcnt(12)
    s_add_u32 s30, s30, 16384
    v_mfma_f32_32x32x16_bf16 v[72:87], v[56:59], v[64:67], v[72:87]
    v_mfma_f32_32x32x16_bf16 v[88:103], v[56:59], v[68:71], v[88:103]
    buffer_load_dwordx4 v[56:59], v2, s[8:11], s30 offen
    v_mfma_f32_32x32x16_bf16 v[104:119], v[60:63], v[64:67], v[104:119]
    buffer_load_dwordx4 v[64:67], v4, s[8:11], s31 offen offset:3072
    v_mfma_f32_32x32x16_bf16 v[120:135], v[60:63], v[68:71], v[120:135]
    buffer_load_dwordx4 v[68:71], v5, s[8:11], s31 offen offset:3072
    buffer_load_dwordx4 v[60:63], v3, s[8:11], s30 offen
    s_waitcnt vmcnt(12)
    s_add_u32 s30, s30, 16384
    s_add_u32 s31, s31, 4096
    v_mfma_f32_32x32x16_bf16 v[72:87], v[8:11], v[16:19], v[72:87]
    v_mfma_f32_32x32x16_bf16 v[88:103], v[8:11], v[20:23], v[88:103]
    buffer_load_dwordx4 v[8:11], v2, s[8:11], s30 offen
    v_mfma_f32_32x32x16_bf16 v[104:119], v[12:15], v[16:19], v[104:119]
    buffer_load_dwordx4 v[16:19], v4, s[8:11], s31 offen
    v_mfma_f32_32x32x16_bf16 v[120:135], v[12:15], v[20:23], v[120:135]
    buffer_load_dwordx4 v[20:23], v5, s[8:11], s31 offen
    buffer_load_dwordx4 v[12:15], v3, s[8:11], s30 offen
    s_waitcnt vmcnt(12)
    s_add_u32 s30, s30, 16384
    v_mfma_f32_32x32x16_bf16 v[72:87], v[24:27], v[32:35], v[72:87]
    v_mfma_f32_32x32x16_bf16 v[88:103], v[24:27], v[36:39], v[88:103]
    buffer_load_dwordx4 v[24:27], v2, s[8:11], s30 offen
    v_mfma_f32_32x32x16_bf16 v[104:119], v[28:31], v[32:35], v[104:119]
    buffer_load_dwordx4 v[32:35], v4, s[8:11], s31 offen offset:1024
    v_mfma_f32_32x32x16_bf16 v[120:135], v[28:31], v[36:39], v[120:135]
    buffer_load_dwordx4 v[36:39], v5, s[8:11], s31 offen offset:1024
    buffer_load_dwordx4 v[28:31], v3, s[8:11], s30 offen
    s_waitcnt vmcnt(12)
    s_add_u32 s30, s30, 16384
    v_mfma_f32_32x32x16_bf16 v[72:87], v[40:43], v[48:51], v[72:87]
    v_mfma_f32_32x32x16_bf16 v[88:103], v[40:43], v[52:55], v[88:103]
    buffer_load_dwordx4 v[40:43], v2, s[8:11], s30 offen
    v_mfma_f32_32x32x16_bf16 v[104:119], v[44:47], v[48:51], v[104:119]
    buffer_load_dwordx4 v[48:51], v4, s[8:11], s31 offen offset:2048
    v_mfma_f32_32x32x16_bf16 v[120:135], v[44:47], v[52:55], v[120:135]
    buffer_load_dwordx4 v[52:55], v5, s[8:11], s31 offen offset:2048
    buffer_load_dwordx4 v[44:47], v3, s[8:11], s30 offen
    s_waitcnt vmcnt(12)
    s_add_u32 s30, s30, 16384
    v_mfma_f32_32x32x16_bf16 v[72:87], v[56:59], v[64:67], v[72:87]
    v_mfma_f32_32x32x16_bf16 v[88:103], v[56:59], v[68:71], v[88:103]
    buffer_load_dwordx4 v[56:59], v2, s[8:11], s30 offen
    v_mfma_f32_32x32x16_bf16 v[104:119], v[60:63], v[64:67], v[104:119]
    buffer_load_dwordx4 v[64:67], v4, s[8:11], s31 offen offset:3072
    v_mfma_f32_32x32x16_bf16 v[120:135], v[60:63], v[68:71], v[120:135]
    buffer_load_dwordx4 v[68:71], v5, s[8:11], s31 offen offset:3072
    buffer_load_dwordx4 v[60:63], v3, s[8:11], s30 offen
    s_waitcnt vmcnt(12)
    s_add_u32 s30, s30, 16384
    s_add_u32 s31, s31, 4096
    v_mfma_f32_32x32x16_bf16 v[72:87], v[8:11], v[16:19], v[72:87]
    v_mfma_f32_32x32x16_bf16 v[88:103], v[8:11], v[20:23], v[88:103]
    buffer_load_dwordx4 v[8:11], v2, s[8:11], s30 offen
    v_mfma_f32_32x32x16_bf16 v[104:119], v[12:15], v[16:19], v[104:119]
    buffer_load_dwordx4 v[16:19], v4, s[8:11], s31 offen
    v_mfma_f32_32x32x16_bf16 v[120:135], v[12:15], v[20:23], v[120:135]
    buffer_load_dwordx4 v[20:23], v5, s[8:11], s31 offen
    buffer_load_dwordx4 v[12:15], v3, s[8:11], s30 offen
    s_waitcnt vmcnt(12)
    s_add_u32 s30, s30, 16384
    v_mfma_f32_32x32x16_bf16 v[72:87], v[24:27], v[32:35], v[72:87]
    v_mfma_f32_32x32x16_bf16 v[88:103], v[24:27], v[36:39], v[88:103]
    buffer_load_dwordx4 v[24:27], v2, s[8:11], s30 offen
    v_mfma_f32_32x32x16_bf16 v[104:119], v[28:31], v[32:35], v[104:119]
    buffer_load_dwordx4 v[32:35], v4, s[8:11], s31 offen offset:1024
    v_mfma_f32_32x32x16_bf16 v[120:135], v[28:31], v[36:39], v[120:135]
    buffer_load_dwordx4 v[36:39], v5, s[8:11], s31 offen offset:1024
    buffer_load_dwordx4 v[28:31], v3, s[8:11], s30 offen
    s_waitcnt vmcnt(12)
    s_add_u32 s30, s30, 16384
    v_mfma_f32_32x32x16_bf16 v[72:87], v[40:43], v[48:51], v[72:87]
    v_mfma_f32_32x32x16_bf16 v[88:103], v[40:43], v[52:55], v[88:103]
    buffer_load_dwordx4 v[40:43], v2, s[8:11], s30 offen
    v_mfma_f32_32x32x16_bf16 v[104:119], v[44:47], v[48:51], v[104:119]
    buffer_load_dwordx4 v[48:51], v4, s[8:11], s31 offen offset:2048
    v_mfma_f32_32x32x16_bf16 v[120:135], v[44:47], v[52:55], v[120:135]
    buffer_load_dwordx4 v[52:55], v5, s[8:11], s31 offen offset:2048
    buffer_load_dwordx4 v[44:47], v3, s[8:11], s30 offen
    s_waitcnt vmcnt(12)
    s_add_u32 s30, s30, 16384
    v_mfma_f32_32x32x16_bf16 v[72:87], v[56:59], v[64:67], v[72:87]
    v_mfma_f32_32x32x16_bf16 v[88:103], v[56:59], v[68:71], v[88:103]
    buffer_load_dwordx4 v[56:59], v2, s[8:11], s30 offen
    v_mfma_f32_32x32x16_bf16 v[104:119], v[60:63], v[64:67], v[104:119]
    buffer_load_dwordx4 v[64:67], v4, s[8:11], s31 offen offset:3072
    v_mfma_f32_32x32x16_bf16 v[120:135], v[60:63], v[68:71], v[120:135]
    buffer_load_dwordx4 v[68:71], v5, s[8:11], s31 offen offset:3072
    buffer_load_dwordx4 v[60:63], v3, s[8:11], s30 offen
    s_waitcnt vmcnt(12)
    s_add_u32 s30, s30, 16384
    s_add_u32 s31, s31, 4096
    v_mfma_f32_32x32x16_bf16 v[72:87], v[8:11], v[16:19], v[72:87]
    v_mfma_f32_32x32x16_bf16 v[88:103], v[8:11], v[20:23], v[88:103]
    buffer_load_dwordx4 v[8:11], v2, s[8:11], s30 offen
    v_mfma_f32_32x32x16_bf16 v[104:119], v[12:15], v[16:19], v[104:119]
    buffer_load_dwordx4 v[16:19], v4, s[8:11], s31 offen
    v_mfma_f32_32x32x16_bf16 v[120:135], v[12:15], v[20:23], v[120:135]
    buffer_load_dwordx4 v[20:23], v5, s[8:11], s31 offen
    buffer_load_dwordx4 v[12:15], v3, s[8:11], s30 offen
    s_waitcnt vmcnt(12)
    s_add_u32 s30, s30, 16384
    v_mfma_f32_32x32x16_bf16 v[72:87], v[24:27], v[32:35], v[72:87]
    v_mfma_f32_32x32x16_bf16 v[88:103], v[24:27], v[36:39], v[88:103]
    buffer_load_dwordx4 v[24:27], v2, s[8:11], s30 offen
    v_mfma_f32_32x32x16_bf16 v[104:119], v[28:31], v[32:35], v[104:119]
    buffer_load_dwordx4 v[32:35], v4, s[8:11], s31 offen offset:1024
    v_mfma_f32_32x32x16_bf16 v[120:135], v[28:31], v[36:39], v[120:135]
    buffer_load_dwordx4 v[36:39], v5, s[8:11], s31 offen offset:1024
    buffer_load_dwordx4 v[28:31], v3, s[8:11], s30 offen
    s_waitcnt vmcnt(12)
    s_add_u32 s30, s30, 16384
    v_mfma_f32_32x32x16_bf16 v[72:87], v[40:43], v[48:51], v[72:87]
    v_mfma_f32_32x32x16_bf16 v[88:103], v[40:43], v[52:55], v[88:103]
    buffer_load_dwordx4 v[40:43], v2, s[8:11], s30 offen
    v_mfma_f32_32x32x16_bf16 v[104:119], v[44:47], v[48:51], v[104:119]
    buffer_load_dwordx4 v[48:51], v4, s[8:11], s31 offen offset:2048
    v_mfma_f32_32x32x16_bf16 v[120:135], v[44:47], v[52:55], v[120:135]
    buffer_load_dwordx4 v[52:55], v5, s[8:11], s31 offen offset:2048
    buffer_load_dwordx4 v[44:47], v3, s[8:11], s30 offen
    s_waitcnt vmcnt(12)
    s_add_u32 s30, s30, 16384
    v_mfma_f32_32x32x16_bf16 v[72:87], v[56:59], v[64:67], v[72:87]
    v_mfma_f32_32x32x16_bf16 v[88:103], v[56:59], v[68:71], v[88:103]
    buffer_load_dwordx4 v[56:59], v2, s[8:11], s30 offen
    v_mfma_f32_32x32x16_bf16 v[104:119], v[60:63], v[64:67], v[104:119]
    buffer_load_dwordx4 v[64:67], v4, s[8:11], s31 offen offset:3072
    v_mfma_f32_32x32x16_bf16 v[120:135], v[60:63], v[68:71], v[120:135]
    buffer_load_dwordx4 v[68:71], v5, s[8:11], s31 offen offset:3072
    buffer_load_dwordx4 v[60:63], v3, s[8:11], s30 offen
    s_waitcnt vmcnt(12)
    s_add_u32 s30, s30, 16384
    s_add_u32 s31, s31, 4096
    v_mfma_f32_32x32x16_bf16 v[72:87], v[8:11], v[16:19], v[72:87]
    v_mfma_f32_32x32x16_bf16 v[88:103], v[8:11], v[20:23], v[88:103]
    buffer_load_dwordx4 v[8:11], v2, s[8:11], s30 offen
    v_mfma_f32_32x32x16_bf16 v[104:119], v[12:15], v[16:19], v[104:119]
    buffer_load_dwordx4 v[16:19], v4, s[8:11], s31 offen
    v_mfma_f32_32x32x16_bf16 v[120:135], v[12:15], v[20:23], v[120:135]
    buffer_load_dwordx4 v[20:23], v5, s[8:11], s31 offen
    buffer_load_dwordx4 v[12:15], v3, s[8:11], s30 offen
    s_waitcnt vmcnt(12)
    s_add_u32 s30, s30, 16384
    v_mfma_f32_32x32x16_bf16 v[72:87], v[24:27], v[32:35], v[72:87]
    v_mfma_f32_32x32x16_bf16 v[88:103], v[24:27], v[36:39], v[88:103]
    buffer_load_dwordx4 v[24:27], v2, s[8:11], s30 offen
    v_mfma_f32_32x32x16_bf16 v[104:119], v[28:31], v[32:35], v[104:119]
    buffer_load_dwordx4 v[32:35], v4, s[8:11], s31 offen offset:1024
    v_mfma_f32_32x32x16_bf16 v[120:135], v[28:31], v[36:39], v[120:135]
    buffer_load_dwordx4 v[36:39], v5, s[8:11], s31 offen offset:1024
    buffer_load_dwordx4 v[28:31], v3, s[8:11], s30 offen
    s_waitcnt vmcnt(12)
    s_add_u32 s30, s30, 16384
    v_mfma_f32_32x32x16_bf16 v[72:87], v[40:43], v[48:51], v[72:87]
    v_mfma_f32_32x32x16_bf16 v[88:103], v[40:43], v[52:55], v[88:103]
    buffer_load_dwordx4 v[40:43], v2, s[8:11], s30 offen
    v_mfma_f32_32x32x16_bf16 v[104:119], v[44:47], v[48:51], v[104:119]
    buffer_load_dwordx4 v[48:51], v4, s[8:11], s31 offen offset:2048
    v_mfma_f32_32x32x16_bf16 v[120:135], v[44:47], v[52:55], v[120:135]
    buffer_load_dwordx4 v[52:55], v5, s[8:11], s31 offen offset:2048
    buffer_load_dwordx4 v[44:47], v3, s[8:11], s30 offen
    s_waitcnt vmcnt(12)
    s_add_u32 s30, s30, 16384
    v_mfma_f32_32x32x16_bf16 v[72:87], v[56:59], v[64:67], v[72:87]
    v_mfma_f32_32x32x16_bf16 v[88:103], v[56:59], v[68:71], v[88:103]
    buffer_load_dwordx4 v[56:59], v2, s[8:11], s30 offen
    v_mfma_f32_32x32x16_bf16 v[104:119], v[60:63], v[64:67], v[104:119]
    buffer_load_dwordx4 v[64:67], v4, s[8:11], s31 offen offset:3072
    v_mfma_f32_32x32x16_bf16 v[120:135], v[60:63], v[68:71], v[120:135]
    buffer_load_dwordx4 v[68:71], v5, s[8:11], s31 offen offset:3072
    buffer_load_dwordx4 v[60:63], v3, s[8:11], s30 offen
    s_waitcnt vmcnt(12)
    s_add_u32 s30, s30, 16384
    s_add_u32 s31, s31, 4096
    v_mfma_f32_32x32x16_bf16 v[72:87], v[8:11], v[16:19], v[72:87]
    v_mfma_f32_32x32x16_bf16 v[88:103], v[8:11], v[20:23], v[88:103]
    buffer_load_dwordx4 v[8:11], v2, s[8:11], s30 offen
    v_mfma_f32_32x32x16_bf16 v[104:119], v[12:15], v[16:19], v[104:119]
    buffer_load_dwordx4 v[16:19], v4, s[8:11], s31 offen
    v_mfma_f32_32x32x16_bf16 v[120:135], v[12:15], v[20:23], v[120:135]
    buffer_load_dwordx4 v[20:23], v5, s[8:11], s31 offen
    buffer_load_dwordx4 v[12:15], v3, s[8:11], s30 offen
    s_waitcnt vmcnt(12)
    s_add_u32 s30, s30, 16384
    v_mfma_f32_32x32x16_bf16 v[72:87], v[24:27], v[32:35], v[72:87]
    v_mfma_f32_32x32x16_bf16 v[88:103], v[24:27], v[36:39], v[88:103]
    buffer_load_dwordx4 v[24:27], v2, s[8:11], s30 offen
    v_mfma_f32_32x32x16_bf16 v[104:119], v[28:31], v[32:35], v[104:119]
    buffer_load_dwordx4 v[32:35], v4, s[8:11], s31 offen offset:1024
    v_mfma_f32_32x32x16_bf16 v[120:135], v[28:31], v[36:39], v[120:135]
    buffer_load_dwordx4 v[36:39], v5, s[8:11], s31 offen offset:1024
    buffer_load_dwordx4 v[28:31], v3, s[8:11], s30 offen
    s_waitcnt vmcnt(12)
    s_add_u32 s30, s30, 16384
    v_mfma_f32_32x32x16_bf16 v[72:87], v[40:43], v[48:51], v[72:87]
    v_mfma_f32_32x32x16_bf16 v[88:103], v[40:43], v[52:55], v[88:103]
    buffer_load_dwordx4 v[40:43], v2, s[8:11], s30 offen
    v_mfma_f32_32x32x16_bf16 v[104:119], v[44:47], v[48:51], v[104:119]
    buffer_load_dwordx4 v[48:51], v4, s[8:11], s31 offen offset:2048
    v_mfma_f32_32x32x16_bf16 v[120:135], v[44:47], v[52:55], v[120:135]
    buffer_load_dwordx4 v[52:55], v5, s[8:11], s31 offen offset:2048
    buffer_load_dwordx4 v[44:47], v3, s[8:11], s30 offen
    s_waitcnt vmcnt(12)
    s_add_u32 s30, s30, 16384
    v_mfma_f32_32x32x16_bf16 v[72:87], v[56:59], v[64:67], v[72:87]
    v_mfma_f32_32x32x16_bf16 v[88:103], v[56:59], v[68:71], v[88:103]
    buffer_load_dwordx4 v[56:59], v2, s[8:11], s30 offen
    v_mfma_f32_32x32x16_bf16 v[104:119], v[60:63], v[64:67], v[104:119]
    buffer_load_dwordx4 v[64:67], v4, s[8:11], s31 offen offset:3072
    v_mfma_f32_32x32x16_bf16 v[120:135], v[60:63], v[68:71], v[120:135]
    buffer_load_dwordx4 v[68:71], v5, s[8:11], s31 offen offset:3072
    buffer_load_dwordx4 v[60:63], v3, s[8:11], s30 offen
    s_waitcnt vmcnt(12)
    v_mfma_f32_32x32x16_bf16 v[72:87], v[8:11], v[16:19], v[72:87]
    v_mfma_f32_32x32x16_bf16 v[88:103], v[8:11], v[20:23], v[88:103]
    v_mfma_f32_32x32x16_bf16 v[104:119], v[12:15], v[16:19], v[104:119]
    v_mfma_f32_32x32x16_bf16 v[120:135], v[12:15], v[20:23], v[120:135]
    s_waitcnt vmcnt(8)
    v_mfma_f32_32x32x16_bf16 v[72:87], v[24:27], v[32:35], v[72:87]
    v_mfma_f32_32x32x16_bf16 v[88:103], v[24:27], v[36:39], v[88:103]
    v_mfma_f32_32x32x16_bf16 v[104:119], v[28:31], v[32:35], v[104:119]
    v_mfma_f32_32x32x16_bf16 v[120:135], v[28:31], v[36:39], v[120:135]
    s_waitcnt vmcnt(4)
    v_mfma_f32_32x32x16_bf16 v[72:87], v[40:43], v[48:51], v[72:87]
    v_mfma_f32_32x32x16_bf16 v[88:103], v[40:43], v[52:55], v[88:103]
    v_mfma_f32_32x32x16_bf16 v[104:119], v[44:47], v[48:51], v[104:119]
    v_mfma_f32_32x32x16_bf16 v[120:135], v[44:47], v[52:55], v[120:135]
    s_waitcnt vmcnt(0)
    v_mfma_f32_32x32x16_bf16 v[72:87], v[56:59], v[64:67], v[72:87]
    v_mfma_f32_32x32x16_bf16 v[88:103], v[56:59], v[68:71], v[88:103]
    v_mfma_f32_32x32x16_bf16 v[104:119], v[60:63], v[64:67], v[104:119]
    v_mfma_f32_32x32x16_bf16 v[120:135], v[60:63], v[68:71], v[120:135]
    s_lshl_b32 s15, s25, 13
    s_add_u32 s15, s15, 131072
    v_add_u32 v6, s15, v1
    v_xor_b32 v7, 0x4000, v6
    s_nop 6
    ds_write_b128 v6, v[104:107] offset:0
    ds_write_b128 v6, v[108:111] offset:1024
    ds_write_b128 v6, v[112:115] offset:2048
    ds_write_b128 v6, v[116:119] offset:3072
    ds_write_b128 v6, v[120:123] offset:4096
    ds_write_b128 v6, v[124:127] offset:5120
    ds_write_b128 v6, v[128:131] offset:6144
    ds_write_b128 v6, v[132:135] offset:7168
    s_waitcnt lgkmcnt(0)
    s_barrier
    ds_read_b128 v[8:11], v7 offset:0
    ds_read_b128 v[12:15], v7 offset:1024
    ds_read_b128 v[16:19], v7 offset:2048
    ds_read_b128 v[20:23], v7 offset:3072
    ds_read_b128 v[24:27], v7 offset:4096
    ds_read_b128 v[28:31], v7 offset:5120
    ds_read_b128 v[32:35], v7 offset:6144
    ds_read_b128 v[36:39], v7 offset:7168
    s_waitcnt lgkmcnt(0)
    v_pk_add_f32 v[72:73], v[72:73], v[8:9]
    v_pk_add_f32 v[74:75], v[74:75], v[10:11]
    v_pk_add_f32 v[76:77], v[76:77], v[12:13]
    v_pk_add_f32 v[78:79], v[78:79], v[14:15]
    v_pk_add_f32 v[80:81], v[80:81], v[16:17]
    v_pk_add_f32 v[82:83], v[82:83], v[18:19]
    v_pk_add_f32 v[84:85], v[84:85], v[20:21]
    v_pk_add_f32 v[86:87], v[86:87], v[22:23]
    v_pk_add_f32 v[88:89], v[88:89], v[24:25]
    v_pk_add_f32 v[90:91], v[90:91], v[26:27]
    v_pk_add_f32 v[92:93], v[92:93], v[28:29]
    v_pk_add_f32 v[94:95], v[94:95], v[30:31]
    v_pk_add_f32 v[96:97], v[96:97], v[32:33]
    v_pk_add_f32 v[98:99], v[98:99], v[34:35]
    v_pk_add_f32 v[100:101], v[100:101], v[36:37]
    v_pk_add_f32 v[102:103], v[102:103], v[38:39]
    ds_write_b128 v7, v[88:91] offset:0
    ds_write_b128 v7, v[92:95] offset:1024
    ds_write_b128 v7, v[96:99] offset:2048
    ds_write_b128 v7, v[100:103] offset:3072
    v_xor_b32 v6, 0x6000, v6
    s_waitcnt lgkmcnt(0)
    s_barrier
    ds_read_b128 v[8:11], v6 offset:0
    ds_read_b128 v[12:15], v6 offset:1024
    ds_read_b128 v[16:19], v6 offset:2048
    ds_read_b128 v[20:23], v6 offset:3072
    s_and_b32 s15, s25, 1
    s_lshl_b32 s16, s13, 1
    s_add_u32 s15, s15, s16
    s_lshl_b32 s15, s15, 4
    s_lshl_b32 s16, s14, 1
    s_add_u32 s15, s15, s16
    s_lshr_b32 s16, s25, 1
    s_add_u32 s15, s15, s16
    s_lshl_b32 s15, s15, 11
    s_add_u32 s15, s15, 14155776
    s_waitcnt lgkmcnt(0)
    v_pk_add_f32 v[72:73], v[72:73], v[8:9]
    v_pk_add_f32 v[74:75], v[74:75], v[10:11]
    v_pk_add_f32 v[76:77], v[76:77], v[12:13]
    v_pk_add_f32 v[78:79], v[78:79], v[14:15]
    v_pk_add_f32 v[80:81], v[80:81], v[16:17]
    v_pk_add_f32 v[82:83], v[82:83], v[18:19]
    v_pk_add_f32 v[84:85], v[84:85], v[20:21]
    v_pk_add_f32 v[86:87], v[86:87], v[22:23]
    v_cvt_pk_bf16_f32 v24, v72, v73
    v_cvt_pk_bf16_f32 v25, v74, v75
    v_cvt_pk_bf16_f32 v26, v76, v77
    v_cvt_pk_bf16_f32 v27, v78, v79
    v_cvt_pk_bf16_f32 v28, v80, v81
    v_cvt_pk_bf16_f32 v29, v82, v83
    v_cvt_pk_bf16_f32 v30, v84, v85
    v_cvt_pk_bf16_f32 v31, v86, v87
    buffer_store_dwordx4 v[24:27], v1, s[8:11], s15 offen sc0 sc1
    buffer_store_dwordx4 v[28:31], v1, s[8:11], s15 offen offset:1024 sc0 sc1
K2_END:
    s_endpgm
.globl gm_k3_kernel
.p2align 8
.type gm_k3_kernel,@function
gm_k3_kernel:
    s_cmp_ge_u32 s2, 256
    s_cbranch_scc1 K3_END
    s_load_dwordx2 s[8:9], s[0:1], 96
    s_mov_b32 s10, 16777216
    s_mov_b32 s11, 0x00020000
    s_load_dwordx2 s[12:13], s[0:1], 80
    s_mov_b32 s14, 2097152
    s_mov_b32 s15, 0x00020000
    v_lshrrev_b32 v2, 6, v0
    v_and_b32 v0, 63, v0
    v_readfirstlane_b32 s16, v2
    s_and_b32 s19, s2, 7
    s_lshl_b32 s19, s19, 2
    s_lshr_b32 s20, s2, 3
    s_and_b32 s17, s20, 3
    s_add_u32 s17, s17, s19
    s_lshr_b32 s18, s20, 2
    v_lshlrev_b32 v1, 4, v0
    s_and_b32 s19, s16, 1
    s_lshl_b32 s21, s18, 1
    s_add_u32 s21, s21, s19
    s_lshl_b32 s21, s21, 10
    s_add_u32 s21, s21, 4194304
    s_lshl_b32 s22, s17, 1
    s_add_u32 s22, s22, s19
    s_lshl_b32 s22, s22, 15
    s_add_u32 s22, s22, 12058624
    s_cmp_ge_u32 s16, 2
    s_cselect_b32 s23, s22, s21
    s_movk_i32 s24, 0x400
    s_cselect_b32 s24, s24, 16384
    s_cselect_b32 s25, 0x10000, 0
    s_lshl_b32 s19, s19, 10
    s_add_u32 s25, s25, s19
    s_lshr_b32 s26, s16, 1
    s_and_b32 s27, s16, 1
    s_lshl_b32 s19, s26, 10
    v_add_u32 v3, s19, v1
    s_lshl_b32 s19, s27, 10
    s_add_u32 s19, s19, 0x10000
    v_add_u32 v4, s19, v1
    s_lshl_b32 s28, s17, 1
    s_add_u32 s28, s28, s27
    s_lshl_b32 s29, s18, 1
    s_add_u32 s29, s29, s26
    s_lshl_b32 s19, s28, 4
    s_add_u32 s19, s19, s29
    s_lshl_b32 s19, s19, 11
    s_add_u32 s30, s19, 14155776
    s_lshl_b32 s31, s28, 7
    s_add_u32 s31, s31, 2228224
    v_and_b32 v2, 31, v0
    v_lshlrev_b32 v6, 2, v2
    v_lshlrev_b32 v5, 10, v2
    v_lshrrev_b32 v2, 5, v0
    v_lshl_or_b32 v5, v2, 4, v5
    s_lshl_b32 s32, s28, 15
    s_lshl_b32 s19, s29, 6
    s_add_u32 s32, s32, s19
    s_waitcnt lgkmcnt(0)
    s_mov_b32 m0, s25
    s_nop 0
    buffer_load_dwordx4 v1, s[8:11], s23 offen lds
    s_add_u32 m0, s25, 2048
    s_add_u32 s23, s23, s24
    buffer_load_dwordx4 v1, s[8:11], s23 offen lds
    s_add_u32 m0, s25, 4096
    s_add_u32 s23, s23, s24
    buffer_load_dwordx4 v1, s[8:11], s23 offen lds
    s_add_u32 m0, s25, 6144
    s_add_u32 s23, s23, s24
    buffer_load_dwordx4 v1, s[8:11], s23 offen lds
    s_add_u32 m0, s25, 8192
    s_add_u32 s23, s23, s24
    buffer_load_dwordx4 v1, s[8:11], s23 offen lds
    s_add_u32 m0, s25, 10240
    s_add_u32 s23, s23, s24
    buffer_load_dwordx4 v1, s[8:11], s23 offen lds
    s_add_u32 m0, s25, 12288
    s_add_u32 s23, s23, s24
    buffer_load_dwordx4 v1, s[8:11], s23 offen lds
    s_add_u32 m0, s25, 14336
    s_add_u32 s23, s23, s24
    buffer_load_dwordx4 v1, s[8:11], s23 offen lds
    buffer_load_dwordx4 v[8:11], v1, s[8:11], s30 offen
    buffer_load_dwordx4 v[12:15], v1, s[8:11], s30 offen offset:1024
    buffer_load_dword v7, v6, s[8:11], s31 offen
    s_add_u32 m0, s25, 16384
    s_add_u32 s23, s23, s24
    buffer_load_dwordx4 v1, s[8:11], s23 offen lds
    s_add_u32 m0, s25, 18432
    s_add_u32 s23, s23, s24
    buffer_load_dwordx4 v1, s[8:11], s23 offen lds
    s_add_u32 m0, s25, 20480
    s_add_u32 s23, s23, s24
    buffer_load_dwordx4 v1, s[8:11], s23 offen lds
    s_add_u32 m0, s25, 22528
    s_add_u32 s23, s23, s24
    buffer_load_dwordx4 v1, s[8:11], s23 offen lds
    s_add_u32 m0, s25, 24576
    s_add_u32 s23, s23, s24
    buffer_load_dwordx4 v1, s[8:11], s23 offen lds
    s_add_u32 m0, s25, 26624
    s_add_u32 s23, s23, s24
    buffer_load_dwordx4 v1, s[8:11], s23 offen lds
    s_add_u32 m0, s25, 28672
    s_add_u32 s23, s23, s24
    buffer_load_dwordx4 v1, s[8:11], s23 offen lds
    s_add_u32 m0, s25, 30720
    s_add_u32 s23, s23, s24
    buffer_load_dwordx4 v1, s[8:11], s23 offen lds
    s_add_u32 m0, s25, 32768
    s_add_u32 s23, s23, s24
    buffer_load_dwordx4 v1, s[8:11], s23 offen lds
    s_add_u32 m0, s25, 34816
    s_add_u32 s23, s23, s24
    buffer_load_dwordx4 v1, s[8:11], s23 offen lds
    s_add_u32 m0, s25, 36864
    s_add_u32 s23, s23, s24
    buffer_load_dwordx4 v1, s[8:11], s23 offen lds
    s_add_u32 m0, s25, 38912
    s_add_u32 s23, s23, s24
    buffer_load_dwordx4 v1, s[8:11], s23 offen lds
    s_add_u32 m0, s25, 40960
    s_add_u32 s23, s23, s24
    buffer_load_dwordx4 v1, s[8:11], s23 offen lds
    s_add_u32 m0, s25, 43008
    s_add_u32 s23, s23, s24
    buffer_load_dwordx4 v1, s[8:11], s23 offen lds
    s_add_u32 m0, s25, 45056
    s_add_u32 s23, s23, s24
    buffer_load_dwordx4 v1, s[8:11], s23 offen lds
    s_add_u32 m0, s25, 47104
    s_add_u32 s23, s23, s24
    buffer_load_dwordx4 v1, s[8:11], s23 offen lds
    v_and_b32 v2, 31, v0
    v_lshrrev_b32 v96, 5, v0
    s_lshl_b32 s19, s26, 2
    v_add_u32 v96, s19, v96
    v_and_b32 v97, 7, v0
    v_xor_b32 v96, v96, v97
    v_lshlrev_b32 v96, 4, v96
    v_lshl_or_b32 v96, v2, 7, v96
    s_lshl_b32 s19, s27, 12
    s_add_u32 s19, s19, 131072
    v_add_u32 v112, s19, v96
    v_xor_b32 v113, 32, v112
    v_lshrrev_b32 v96, 3, v0
    v_xor_b32 v97, v97, v96
    v_lshlrev_b32 v97, 4, v97
    v_lshl_or_b32 v97, v96, 7, v97
    s_lshl_b32 s19, s16, 11
    s_add_u32 s19, s19, 131072
    v_add_u32 v114, s19, v97
    v_and_b32 v97, 7, v0
    v_lshlrev_b32 v97, 4, v97
    v_lshl_or_b32 v5, v96, 10, v97
    s_lshl_b32 s32, s17, 16
    s_lshl_b32 s19, s16, 14
    s_add_u32 s32, s32, s19
    s_lshl_b32 s19, s18, 7
    s_add_u32 s32, s32, s19
    s_add_u32 s33, s32, 8192
    s_waitcnt vmcnt(19)
    s_barrier
    ds_read_b128 v[32:35], v3 offset:0
    ds_read_b128 v[36:39], v4 offset:0
    ds_read_b128 v[40:43], v3 offset:2048
    ds_read_b128 v[44:47], v4 offset:2048
    ds_read_b128 v[48:51], v3 offset:4096
    ds_read_b128 v[52:55], v4 offset:4096
    ds_read_b128 v[56:59], v3 offset:6144
    ds_read_b128 v[60:63], v4 offset:6144
    ds_read_b128 v[64:67], v3 offset:8192
    ds_read_b128 v[68:71], v4 offset:8192
    ds_read_b128 v[72:75], v3 offset:10240
    ds_read_b128 v[76:79], v4 offset:10240
    ds_read_b128 v[80:83], v3 offset:12288
    ds_read_b128 v[84:87], v4 offset:12288
    ds_read_b128 v[88:91], v3 offset:14336
    ds_read_b128 v[92:95], v4 offset:14336
    s_waitcnt lgkmcnt(14)
    v_mfma_f32_32x32x16_bf16 v[16:31], v[32:35], v[36:39], 0
    s_add_u32 m0, s25, 49152
    s_add_u32 s23, s23, s24
    buffer_load_dwordx4 v1, s[8:11], s23 offen lds
    s_waitcnt lgkmcnt(12)
    v_mfma_f32_32x32x16_bf16 v[16:31], v[40:43], v[44:47], v[16:31]
    s_add_u32 m0, s25, 51200
    s_add_u32 s23, s23, s24
    buffer_load_dwordx4 v1, s[8:11], s23 offen lds
    s_waitcnt lgkmcnt(10)
    v_mfma_f32_32x32x16_bf16 v[16:31], v[48:51], v[52:55], v[16:31]
    s_add_u32 m0, s25, 53248
    s_add_u32 s23, s23, s24
    buffer_load_dwordx4 v1, s[8:11], s23 offen lds
    s_waitcnt lgkmcnt(8)
    v_mfma_f32_32x32x16_bf16 v[16:31], v[56:59], v[60:63], v[16:31]
    s_add_u32 m0, s25, 55296
    s_add_u32 s23, s23, s24
    buffer_load_dwordx4 v1, s[8:11], s23 offen lds
    s_waitcnt lgkmcnt(6)
    v_mfma_f32_32x32x16_bf16 v[16:31], v[64:67], v[68:71], v[16:31]
    s_add_u32 m0, s25, 57344
    s_add_u32 s23, s23, s24
    buffer_load_dwordx4 v1, s[8:11], s23 offen lds
    s_waitcnt lgkmcnt(4)
    v_mfma_f32_32x32x16_bf16 v[16:31], v[72:75], v[76:79], v[16:31]
    s_add_u32 m0, s25, 59392
    s_add_u32 s23, s23, s24
    buffer_load_dwordx4 v1, s[8:11], s23 offen lds
    s_waitcnt lgkmcnt(2)
    v_mfma_f32_32x32x16_bf16 v[16:31], v[80:83], v[84:87], v[16:31]
    s_add_u32 m0, s25, 61440
    s_add_u32 s23, s23, s24
    buffer_load_dwordx4 v1, s[8:11], s23 offen lds
    s_waitcnt lgkmcnt(0)
    v_mfma_f32_32x32x16_bf16 v[16:31], v[88:91], v[92:95], v[16:31]
    s_add_u32 m0, s25, 63488
    s_add_u32 s23, s23, s24
    buffer_load_dwordx4 v1, s[8:11], s23 offen lds
    s_waitcnt vmcnt(24)
    v_sub_f32 v2, 1.0, v7
    v_lshlrev_b32 v96, 16, v8
    v_and_b32 v97, 0xffff0000, v8
    v_lshlrev_b32 v98, 16, v9
    v_and_b32 v99, 0xffff0000, v9
    v_lshlrev_b32 v100, 16, v10
    v_and_b32 v101, 0xffff0000, v10
    v_lshlrev_b32 v102, 16, v11
    v_and_b32 v103, 0xffff0000, v11
    v_lshlrev_b32 v104, 16, v12
    v_and_b32 v105, 0xffff0000, v12
    v_lshlrev_b32 v106, 16, v13
    v_and_b32 v107, 0xffff0000, v13
    v_lshlrev_b32 v108, 16, v14
    v_and_b32 v109, 0xffff0000, v14
    v_lshlrev_b32 v110, 16, v15
    v_and_b32 v111, 0xffff0000, v15
    v_mul_f32 v96, v2, v96
    v_mul_f32 v97, v2, v97
    v_mul_f32 v98, v2, v98
    v_mul_f32 v99, v2, v99
    v_mul_f32 v100, v2, v100
    v_mul_f32 v101, v2, v101
    v_mul_f32 v102, v2, v102
    v_mul_f32 v103, v2, v103
    v_mul_f32 v104, v2, v104
    v_mul_f32 v105, v2, v105
    v_mul_f32 v106, v2, v106
    v_mul_f32 v107, v2, v107
    v_mul_f32 v108, v2, v108
    v_mul_f32 v109, v2, v109
    v_mul_f32 v110, v2, v110
    v_mul_f32 v111, v2, v111
    s_waitcnt vmcnt(16)
    s_barrier
    ds_read_b128 v[32:35], v3 offset:16384
    ds_read_b128 v[36:39], v4 offset:16384
    ds_read_b128 v[40:43], v3 offset:18432
    ds_read_b128 v[44:47], v4 offset:18432
    ds_read_b128 v[48:51], v3 offset:20480
    ds_read_b128 v[52:55], v4 offset:20480
    ds_read_b128 v[56:59], v3 offset:22528
    ds_read_b128 v[60:63], v4 offset:22528
    ds_read_b128 v[64:67], v3 offset:24576
    ds_read_b128 v[68:71], v4 offset:24576
    ds_read_b128 v[72:75], v3 offset:26624
    ds_read_b128 v[76:79], v4 offset:26624
    ds_read_b128 v[80:83], v3 offset:28672
    ds_read_b128 v[84:87], v4 offset:28672
    ds_read_b128 v[88:91], v3 offset:30720
    ds_read_b128 v[92:95], v4 offset:30720
    s_waitcnt lgkmcnt(14)
    v_mfma_f32_32x32x16_bf16 v[16:31], v[32:35], v[36:39], v[16:31]
    s_waitcnt lgkmcnt(12)
    v_mfma_f32_32x32x16_bf16 v[16:31], v[40:43], v[44:47], v[16:31]
    s_waitcnt lgkmcnt(10)
    v_mfma_f32_32x32x16_bf16 v[16:31], v[48:51], v[52:55], v[16:31]
    s_waitcnt lgkmcnt(8)
    v_mfma_f32_32x32x16_bf16 v[16:31], v[56:59], v[60:63], v[16:31]
    s_waitcnt lgkmcnt(6)
    v_mfma_f32_32x32x16_bf16 v[16:31], v[64:67], v[68:71], v[16:31]
    s_waitcnt lgkmcnt(4)
    v_mfma_f32_32x32x16_bf16 v[16:31], v[72:75], v[76:79], v[16:31]
    s_waitcnt lgkmcnt(2)
    v_mfma_f32_32x32x16_bf16 v[16:31], v[80:83], v[84:87], v[16:31]
    s_waitcnt lgkmcnt(0)
    v_mfma_f32_32x32x16_bf16 v[16:31], v[88:91], v[92:95], v[16:31]
    s_waitcnt vmcnt(8)
    s_barrier
    ds_read_b128 v[32:35], v3 offset:32768
    ds_read_b128 v[36:39], v4 offset:32768
    ds_read_b128 v[40:43], v3 offset:34816
    ds_read_b128 v[44:47], v4 offset:34816
    ds_read_b128 v[48:51], v3 offset:36864
    ds_read_b128 v[52:55], v4 offset:36864
    ds_read_b128 v[56:59], v3 offset:38912
    ds_read_b128 v[60:63], v4 offset:38912
    ds_read_b128 v[64:67], v3 offset:40960
    ds_read_b128 v[68:71], v4 offset:40960
    ds_read_b128 v[72:75], v3 offset:43008
    ds_read_b128 v[76:79], v4 offset:43008
    ds_read_b128 v[80:83], v3 offset:45056
    ds_read_b128 v[84:87], v4 offset:45056
    ds_read_b128 v[88:91], v3 offset:47104
    ds_read_b128 v[92:95], v4 offset:47104
    s_waitcnt lgkmcnt(14)
    v_mfma_f32_32x32x16_bf16 v[16:31], v[32:35], v[36:39], v[16:31]
    s_waitcnt lgkmcnt(12)
    v_mfma_f32_32x32x16_bf16 v[16:31], v[40:43], v[44:47], v[16:31]
    s_waitcnt lgkmcnt(10)
    v_mfma_f32_32x32x16_bf16 v[16:31], v[48:51], v[52:55], v[16:31]
    s_waitcnt lgkmcnt(8)
    v_mfma_f32_32x32x16_bf16 v[16:31], v[56:59], v[60:63], v[16:31]
    s_waitcnt lgkmcnt(6)
    v_mfma_f32_32x32x16_bf16 v[16:31], v[64:67], v[68:71], v[16:31]
    s_waitcnt lgkmcnt(4)
    v_mfma_f32_32x32x16_bf16 v[16:31], v[72:75], v[76:79], v[16:31]
    s_waitcnt lgkmcnt(2)
    v_mfma_f32_32x32x16_bf16 v[16:31], v[80:83], v[84:87], v[16:31]
    s_waitcnt lgkmcnt(0)
    v_mfma_f32_32x32x16_bf16 v[16:31], v[88:91], v[92:95], v[16:31]
    s_waitcnt vmcnt(0)
    s_barrier
    ds_read_b128 v[32:35], v3 offset:49152
    ds_read_b128 v[36:39], v4 offset:49152
    ds_read_b128 v[40:43], v3 offset:51200
    ds_read_b128 v[44:47], v4 offset:51200
    ds_read_b128 v[48:51], v3 offset:53248
    ds_read_b128 v[52:55], v4 offset:53248
    ds_read_b128 v[56:59], v3 offset:55296
    ds_read_b128 v[60:63], v4 offset:55296
    ds_read_b128 v[64:67], v3 offset:57344
    ds_read_b128 v[68:71], v4 offset:57344
    ds_read_b128 v[72:75], v3 offset:59392
    ds_read_b128 v[76:79], v4 offset:59392
    ds_read_b128 v[80:83], v3 offset:61440
    ds_read_b128 v[84:87], v4 offset:61440
    ds_read_b128 v[88:91], v3 offset:63488
    ds_read_b128 v[92:95], v4 offset:63488
    s_waitcnt lgkmcnt(14)
    v_mfma_f32_32x32x16_bf16 v[16:31], v[32:35], v[36:39], v[16:31]
    s_waitcnt lgkmcnt(12)
    v_mfma_f32_32x32x16_bf16 v[16:31], v[40:43], v[44:47], v[16:31]
    s_waitcnt lgkmcnt(10)
    v_mfma_f32_32x32x16_bf16 v[16:31], v[48:51], v[52:55], v[16:31]
    s_waitcnt lgkmcnt(8)
    v_mfma_f32_32x32x16_bf16 v[16:31], v[56:59], v[60:63], v[16:31]
    s_waitcnt lgkmcnt(6)
    v_mfma_f32_32x32x16_bf16 v[16:31], v[64:67], v[68:71], v[16:31]
    s_waitcnt lgkmcnt(4)
    v_mfma_f32_32x32x16_bf16 v[16:31], v[72:75], v[76:79], v[16:31]
    s_waitcnt lgkmcnt(2)
    v_mfma_f32_32x32x16_bf16 v[16:31], v[80:83], v[84:87], v[16:31]
    s_waitcnt lgkmcnt(0)
    v_mfma_f32_32x32x16_bf16 v[16:31], v[88:91], v[92:95], v[16:31]
    s_nop 11
    v_fma_f32 v16, v7, v16, v96
    v_fma_f32 v17, v7, v17, v97
    v_fma_f32 v18, v7, v18, v98
    v_fma_f32 v19, v7, v19, v99
    v_fma_f32 v20, v7, v20, v100
    v_fma_f32 v21, v7, v21, v101
    v_fma_f32 v22, v7, v22, v102
    v_fma_f32 v23, v7, v23, v103
    v_fma_f32 v24, v7, v24, v104
    v_fma_f32 v25, v7, v25, v105
    v_fma_f32 v26, v7, v26, v106
    v_fma_f32 v27, v7, v27, v107
    v_fma_f32 v28, v7, v28, v108
    v_fma_f32 v29, v7, v29, v109
    v_fma_f32 v30, v7, v30, v110
    v_fma_f32 v31, v7, v31, v111
    v_cvt_pk_bf16_f32 v32, v16, v17
    v_cvt_pk_bf16_f32 v33, v18, v19
    v_cvt_pk_bf16_f32 v34, v20, v21
    v_cvt_pk_bf16_f32 v35, v22, v23
    v_cvt_pk_bf16_f32 v36, v24, v25
    v_cvt_pk_bf16_f32 v37, v26, v27
    v_cvt_pk_bf16_f32 v38, v28, v29
    v_cvt_pk_bf16_f32 v39, v30, v31
    v_permlane32_swap_b32 v32, v34
    v_permlane32_swap_b32 v33, v35
    v_permlane32_swap_b32 v36, v38
    v_permlane32_swap_b32 v37, v39
    ds_write_b128 v112, v[32:35]
    ds_write_b128 v113, v[36:39]
    s_waitcnt lgkmcnt(0)
    s_barrier
    ds_read_b128 v[40:43], v114
    ds_read_b128 v[44:47], v114 offset:1024
    s_waitcnt lgkmcnt(1)
    buffer_store_dwordx4 v[40:43], v5, s[12:15], s32 offen sc0 sc1
    s_waitcnt lgkmcnt(0)
    buffer_store_dwordx4 v[44:47], v5, s[12:15], s33 offen sc0 sc1
K3_END:
    s_endpgm
.section .rodata,"a"
.p2align 6
.amdhsa_kernel gm_k1_kernel
  .amdhsa_next_free_vgpr 300
  .amdhsa_next_free_sgpr 102
  .amdhsa_accum_offset 172
  .amdhsa_group_segment_fixed_size 0
  .amdhsa_kernarg_size 104
  .amdhsa_user_sgpr_count 2
  .amdhsa_user_sgpr_kernarg_segment_ptr 1
  .amdhsa_system_sgpr_workgroup_id_x 1
.end_amdhsa_kernel

.p2align 6
.amdhsa_kernel gm_k2_kernel
  .amdhsa_next_free_vgpr 256
  .amdhsa_next_free_sgpr 102
  .amdhsa_accum_offset 256
  .amdhsa_group_segment_fixed_size 0
  .amdhsa_kernarg_size 104
  .amdhsa_user_sgpr_count 2
  .amdhsa_user_sgpr_kernarg_segment_ptr 1
  .amdhsa_system_sgpr_workgroup_id_x 1
.end_amdhsa_kernel

.p2align 6
.amdhsa_kernel gm_k3_kernel
  .amdhsa_next_free_vgpr 120
  .amdhsa_next_free_sgpr 102
  .amdhsa_accum_offset 120
  .amdhsa_group_segment_fixed_size 0
  .amdhsa_kernarg_size 104
  .amdhsa_user_sgpr_count 2
  .amdhsa_user_sgpr_kernarg_segment_ptr 1
  .amdhsa_system_sgpr_workgroup_id_x 1
.end_amdhsa_kernel
```
